```python
import torch

def _softmax(x, axis=-1):
    return torch.softmax(x, dim=axis)
def _gelu(x):
    return torch.nn.functional.gelu(x, approximate="tanh")
def _silu(x):
    return torch.nn.functional.silu(x)
def _sigmoid(x):
    return torch.sigmoid(x)
def _layernorm(x, axis=-1, eps=1e-5):
    m = x.mean(dim=axis, keepdim=True)
    v = x.var(dim=axis, keepdim=True, unbiased=False)
    return (x - m) / torch.sqrt(v + eps)
def _scatter_add(tgt, idx, src, axis=0):
    return tgt.clone().index_add_(axis, idx, src)
def _segment_sum(src, seg, n):
    out = torch.zeros((n,) + src.shape[1:], dtype=src.dtype)
    return out.index_add_(0, seg, src)
def _pad(x, pw):
    flat = tuple(v for pair in reversed(pw) for v in pair)
    return torch.nn.functional.pad(x, flat)

kernel_name = 'concat_heads__mha_block_cached__gqa_block_cached__near_ridge'

def setup_inputs():

    _w = (lambda a: (lambda t: t.to(torch.bfloat16) if t.is_floating_point() else t)(torch.as_tensor(a)))
    def _A_setup():
        B, Sq, D = 16, 32, 1024
        H, Sk, Dh = 32, 32, 128
        return {
            "x": _w((lambda *s: torch.randn(*s, dtype=torch.bfloat16) * 0.8)(B, Sq, D)),
            "k_cache": _w((lambda *s: torch.randn(*s, dtype=torch.bfloat16) * 0.8)(B, H, Sk, Dh)),
            "v_cache": _w((lambda *s: torch.randn(*s, dtype=torch.bfloat16) * 0.05)(B, H, Sk, Dh)),
            "wq": _w((lambda *s: torch.randn(*s, dtype=torch.bfloat16) * 0.8)(D, H * Dh) * (D ** -0.5)),
            "wo": _w((lambda *s: torch.randn(*s, dtype=torch.bfloat16) * 0.05)(H * Dh, D) * ((H * Dh) ** -0.5)),
        }
    _A_in = _A_setup()

    def _B_setup():
        B, Sq, D = 16, 32, 1024
        Hq, Hkv, Sk, Dh = 32, 32, 32, 128
        assert Hq % Hkv == 0, (Hq, Hkv)
        return {
            "x": _w((lambda *s: torch.randn(*s, dtype=torch.bfloat16) * 0.8)(B, Sq, D)),
            "k_cache": _w((lambda *s: torch.randn(*s, dtype=torch.bfloat16) * 0.8)(B, Hkv, Sk, Dh)),
            "v_cache": _w((lambda *s: torch.randn(*s, dtype=torch.bfloat16) * 0.05)(B, Hkv, Sk, Dh)),
            "wq": _w((lambda *s: torch.randn(*s, dtype=torch.bfloat16) * 0.8)(D, Hq * Dh) * (D ** -0.5)),
            "wo": _w((lambda *s: torch.randn(*s, dtype=torch.bfloat16) * 0.05)(Hq * Dh, D) * ((Hq * Dh) ** -0.5)),
        }
    _B_in = _B_setup()

    return {
        "A_x": _A_in["x"],
        "A_k_cache": _A_in["k_cache"],
        "A_v_cache": _A_in["v_cache"],
        "A_wq": _A_in["wq"],
        "A_wo": _A_in["wo"],
        "B_x": _B_in["x"],
        "B_k_cache": _B_in["k_cache"],
        "B_v_cache": _B_in["v_cache"],
        "B_wq": _B_in["wq"],
        "B_wo": _B_in["wo"],
    }

def reference(A_x, A_k_cache, A_v_cache, A_wq, A_wo, B_x, B_k_cache, B_v_cache, B_wq, B_wo):
    def _A_ref(x, k_cache, v_cache, wq, wo):
        B, Sq, D = x.shape
        H, Dh = 32, 128
        q = (lambda x, *d: x.permute(*d))((x @ wq).reshape(B, Sq, H, Dh), 0, 2, 1, 3)
        scores = torch.einsum("bhqd,bhkd->bhqk", q, k_cache) * (Dh ** -0.5)
        p = _softmax(scores, axis=-1)
        o = torch.einsum("bhqk,bhkd->bhqd", p, v_cache)
        return (lambda x, *d: x.permute(*d))(o, 0, 2, 1, 3).reshape(B, Sq, H * Dh) @ wo

    def _B_ref(x, k_cache, v_cache, wq, wo):
        B, Sq, D = x.shape
        Hq, Dh = 32, 128
        Hkv = k_cache.shape[1]
        rep = Hq // Hkv
        q = (lambda x, *d: x.permute(*d))((x @ wq).reshape(B, Sq, Hq, Dh), 0, 2, 1, 3)
        k = (lambda x, n, axis: torch.repeat_interleave(x, n, dim=axis))(k_cache, rep, axis=1)
        v = (lambda x, n, axis: torch.repeat_interleave(x, n, dim=axis))(v_cache, rep, axis=1)
        scores = torch.einsum("bhqd,bhkd->bhqk", q, k) * (Dh ** -0.5)
        p = _softmax(scores, axis=-1)
        o = torch.einsum("bhqk,bhkd->bhqd", p, v)
        return (lambda x, *d: x.permute(*d))(o, 0, 2, 1, 3).reshape(B, Sq, Hq * Dh) @ wo

    a = _A_ref(A_x, A_k_cache, A_v_cache, A_wq, A_wo)
    b = _B_ref(B_x, B_k_cache, B_v_cache, B_wq, B_wo)
    return torch.concatenate([a, b], axis=-1)
```

```asm
; @launch grid=(256,1,1) block=(256,1,1) lds=163840
.amdgcn_target "amdgcn-amd-amdhsa--gfx950"
.text
.globl concat_heads__mha_block_cached__gqa_block_cached__near_ridge_kernel
.p2align 8
.type concat_heads__mha_block_cached__gqa_block_cached__near_ridge_kernel,@function
concat_heads__mha_block_cached__gqa_block_cached__near_ridge_kernel:
    s_cmp_ge_u32 s2, 256
    s_cbranch_scc1 L_end
    s_load_dwordx16 s[4:19], s[0:1], 0
    s_load_dwordx4 s[20:23], s[0:1], 64
    s_load_dwordx4 s[24:27], s[0:1], 80
    s_load_dwordx2 s[28:29], s[0:1], 96
    s_memrealtime s[76:77]
    s_getpc_b64 s[98:99]
L_pc:
    s_lshr_b32 s70, s2, 3
    v_lshrrev_b32 v240, 4, v0
    v_lshl_add_u32 v240, s70, 4, v240
    v_lshlrev_b32 v240, 7, v240
    v_min_u32 v240, L_codeend-L_pc-4, v240
    v_mov_b32 v241, s99
    v_add_co_u32 v240, vcc, s98, v240
    s_nop 1
    v_addc_co_u32 v241, vcc, 0, v241, vcc
    global_load_dword v241, v[240:241], off
    v_lshrrev_b32 v2, 6, v0
    v_and_b32 v0, 63, v0
    v_readfirstlane_b32 s64, v2
    s_and_b32 s70, s2, 7
    s_lshr_b32 s71, s2, 3
    s_lshr_b32 s65, s70, 2
    s_and_b32 s66, s70, 3
    s_and_b32 s67, s71, 7
    s_lshr_b32 s68, s71, 3
    s_lshl_b32 s69, s68, 2
    s_add_u32 s69, s69, s64
    s_lshl_b32 s74, s66, 3
    s_add_u32 s74, s74, s67
    s_lshl_b32 s70, s64, 17
    s_lshl_b32 s71, s74, 8
    s_add_u32 s70, s70, s71
    s_lshl_b32 s71, s69, 16
    s_lshr_b32 s72, s67, 2
    s_lshl_b32 s73, s72, 22
    s_add_u32 s88, s70, s73
    s_xor_b32 s73, s73, 4194304
    s_add_u32 s89, s70, s73
    s_lshl_b32 s73, s72, 10
    s_add_u32 s92, s71, s73
    s_xor_b32 s73, s73, 1024
    s_add_u32 s93, s71, s73
    s_add_u32 s79, s68, s67
    s_and_b32 s79, s79, 3
    s_lshl_b32 s72, s79, 2
    s_lshr_b32 s72, 528, s72
    s_and_b32 s72, s72, 15
    s_lshl_b32 s73, s72, 19
    s_add_u32 s90, s88, s73
    s_lshl_b32 s73, s72, 7
    s_add_u32 s94, s92, s73
    s_lshl_b32 s72, s79, 2
    s_lshr_b32 s72, 12289, s72
    s_and_b32 s72, s72, 15
    s_lshl_b32 s73, s72, 19
    s_add_u32 s91, s88, s73
    s_lshl_b32 s73, s72, 7
    s_add_u32 s95, s92, s73
    s_lshl_b32 s81, s64, 12
    s_lshl_b32 s78, s64, 14
    s_add_u32 s78, s78, 65536
    v_lshrrev_b32 v242, 4, v0
    v_bfe_u32 v243, v0, 2, 2
    v_xor_b32 v243, v243, v242
    v_lshlrev_b32 v243, 6, v243
    v_lshl_add_u32 v224, v242, 13, v243
    v_and_b32 v243, 3, v0
    v_lshl_add_u32 v224, v243, 4, v224
    v_add_u32 v225, 31744, v224
    v_xor_b32 v242, 32, v224
    v_add_u32 v226, 63488, v242
    v_add_u32 v227, 95232, v242
    v_lshrrev_b32 v242, 3, v0
    v_lshrrev_b32 v243, 4, v0
    v_and_b32 v254, 7, v0
    v_xor_b32 v254, v254, v243
    v_lshlrev_b32 v254, 4, v254
    v_lshl_add_u32 v228, v242, 11, v254
    v_xor_b32 v254, 64, v228
    v_add_u32 v229, 15360, v254
    v_add_u32 v230, 30720, v228
    v_add_u32 v231, 46080, v254
    s_mov_b32 s34, 1048576
    s_mov_b32 s35, 0x20000
    s_mov_b32 s46, 8388608
    s_mov_b32 s47, 0x20000
    s_waitcnt lgkmcnt(0)
    s_cmp_eq_u32 s65, 0
    s_cselect_b32 s32, s4, s14
    s_cselect_b32 s33, s5, s15
    s_cselect_b32 s44, s10, s20
    s_cselect_b32 s45, s11, s21
    s_cselect_b32 s36, s6, s16
    s_cselect_b32 s37, s7, s17
    s_cselect_b32 s40, s8, s18
    s_cselect_b32 s41, s9, s19
    s_cselect_b32 s48, s12, s22
    s_cselect_b32 s49, s13, s23
    s_add_u32 m0, s78, 0
    s_mov_b32 s87, s94
    buffer_load_dwordx4 v228, s[32:35], s87 offen offset:0 lds
    buffer_load_dwordx4 v229, s[32:35], s87 offen offset:1024 lds
    buffer_load_dwordx4 v230, s[32:35], s87 offen offset:2048 lds
    buffer_load_dwordx4 v231, s[32:35], s87 offen offset:3072 lds
    s_add_u32 m0, s81, 0
    s_mov_b32 s87, s90
    buffer_load_dwordx4 v224, s[44:47], s87 offen offset:0 lds
    buffer_load_dwordx4 v225, s[44:47], s87 offen offset:1024 lds
    buffer_load_dwordx4 v226, s[44:47], s87 offen offset:2048 lds
    buffer_load_dwordx4 v227, s[44:47], s87 offen offset:3072 lds
    v_bfe_u32 v251, v0, 2, 2
    v_lshrrev_b32 v242, 4, v0
    v_lshl_add_u32 v243, v242, 3, v251
    v_lshlrev_b32 v243, 8, v243
    v_and_b32 v254, 1, v242
    v_lshl_add_u32 v243, v254, 5, v243
    v_and_b32 v254, 3, v0
    v_lshl_add_u32 v243, v254, 3, v243
    v_lshl_add_u32 v8, v251, 6, v243
    v_xor_b32 v9, 32, v8
    v_xor_b32 v10, 64, v8
    v_xor_b32 v11, 96, v8
    v_xor_b32 v12, 128, v8
    v_xor_b32 v13, 160, v8
    v_xor_b32 v14, 192, v8
    v_xor_b32 v15, 224, v8
    v_bfe_u32 v254, v0, 1, 3
    v_xor_b32 v242, v242, v254
    v_lshlrev_b32 v242, 4, v242
    v_and_b32 v243, 15, v0
    v_lshl_add_u32 v242, v243, 7, v242
    v_add_u32 v232, s78, v242
    v_xor_b32 v242, 64, v242
    v_add_u32 v233, s78, v242
    s_mov_b32 s56, s24
    s_mov_b32 s57, s25
    s_mov_b32 s60, s26
    s_mov_b32 s61, s27
    s_mov_b32 s52, s28
    s_mov_b32 s53, s29
    s_mov_b32 s38, 4194304
    s_mov_b32 s39, 0x20000
    s_mov_b32 s42, 4194304
    s_mov_b32 s43, 0x20000
    s_mov_b32 s50, 8388608
    s_mov_b32 s51, 0x20000
    s_mov_b32 s54, 33554432
    s_mov_b32 s55, 0x20000
    s_mov_b32 s58, 2097152
    s_mov_b32 s59, 0x20000
    s_mov_b32 s62, 256
    s_mov_b32 s63, 0x20000
    s_lshl_b32 s80, s69, 5
    s_add_u32 s80, s80, s74
    s_lshl_b32 s80, s80, 13
    s_lshl_b32 s82, s64, 13
    s_add_u32 m0, s78, 4096
    s_mov_b32 s87, s95
    buffer_load_dwordx4 v228, s[32:35], s87 offen offset:0 lds
    buffer_load_dwordx4 v229, s[32:35], s87 offen offset:1024 lds
    buffer_load_dwordx4 v230, s[32:35], s87 offen offset:2048 lds
    buffer_load_dwordx4 v231, s[32:35], s87 offen offset:3072 lds
    s_add_u32 m0, s81, 16384
    s_mov_b32 s87, s91
    buffer_load_dwordx4 v224, s[44:47], s87 offen offset:0 lds
    buffer_load_dwordx4 v225, s[44:47], s87 offen offset:1024 lds
    buffer_load_dwordx4 v226, s[44:47], s87 offen offset:2048 lds
    buffer_load_dwordx4 v227, s[44:47], s87 offen offset:3072 lds
    s_or_b32 s70, s2, s64
    s_or_b32 s76, s76, 1
    s_mul_i32 s76, s76, 0x9e3779b1
    v_or_b32 v243, s70, v0
    v_lshlrev_b32 v243, 8, v243
    v_mov_b32 v242, s76
    buffer_store_dword v242, v243, s[60:63], 0 offen sc1
    v_lshrrev_b32 v254, 4, v0
    v_and_b32 v255, 15, v0
    v_xor_b32 v255, v255, v254
    v_lshlrev_b32 v255, 4, v255
    v_lshl_add_u32 v2, v254, 8, v255
    v_lshrrev_b32 v254, 4, v0
    v_bfe_u32 v255, v0, 2, 2
    v_xor_b32 v255, v255, v254
    v_lshlrev_b32 v255, 6, v255
    v_lshl_add_u32 v3, v254, 8, v255
    v_and_b32 v255, 3, v0
    v_lshl_add_u32 v3, v255, 4, v3
    s_cmp_eq_u32 s79, 1
    s_cbranch_scc1 L_p1_1
    s_cmp_eq_u32 s79, 2
    s_cbranch_scc1 L_p1_2
    s_cmp_eq_u32 s79, 3
    s_cbranch_scc1 L_p1_3
L_p1_0:
    s_waitcnt vmcnt(9)
    s_barrier
    ds_read_b128 v[112:115], v232 offset:0
    ds_read_b128 v[116:119], v232 offset:2048
    s_add_u32 m0, s78, 8192
    s_add_u32 s87, s92, 512
    buffer_load_dwordx4 v228, s[32:35], s87 offen offset:0 lds
    ds_read_b64_tr_b16 v[80:81], v8 offset:0
    buffer_load_dwordx4 v229, s[32:35], s87 offen offset:1024 lds
    ds_read_b64_tr_b16 v[82:83], v8 offset:1024
    buffer_load_dwordx4 v230, s[32:35], s87 offen offset:2048 lds
    ds_read_b64_tr_b16 v[84:85], v9 offset:0
    v_lshrrev_b32 v254, 4, v0
    v_bfe_u32 v255, v0, 2, 2
    v_xor_b32 v255, v255, v254
    ds_read_b64_tr_b16 v[86:87], v9 offset:1024
    v_lshlrev_b32 v255, 6, v255
    v_lshl_add_u32 v4, v254, 11, v255
    v_and_b32 v255, 3, v0
    ds_read_b64_tr_b16 v[88:89], v10 offset:0
    buffer_load_dwordx4 v231, s[32:35], s87 offen offset:3072 lds
    ds_read_b64_tr_b16 v[90:91], v10 offset:1024
    v_lshl_add_u32 v4, v255, 4, v4
    v_add_u32 v5, 31744, v4
    v_add_u32 v6, 6144, v4
    ds_read_b64_tr_b16 v[92:93], v11 offset:0
    s_add_u32 m0, s81, 32768
    s_add_u32 s87, s88, 2097152
    buffer_load_dwordx4 v224, s[44:47], s87 offen offset:0 lds
    ds_read_b64_tr_b16 v[94:95], v11 offset:1024
    ds_read_b64_tr_b16 v[96:97], v12 offset:0
    v_add_u32 v7, 37888, v4
    v_bfe_u32 v251, v0, 2, 2
    v_lshrrev_b32 v254, 5, v0
    ds_read_b64_tr_b16 v[98:99], v12 offset:1024
    v_lshl_add_u32 v254, v254, 3, v251
    v_lshlrev_b32 v250, 8, v254
    v_bfe_u32 v254, v0, 4, 1
    ds_read_b64_tr_b16 v[100:101], v13 offset:0
    buffer_load_dwordx4 v225, s[44:47], s87 offen offset:1024 lds
    ds_read_b64_tr_b16 v[102:103], v13 offset:1024
    v_lshl_add_u32 v250, v254, 5, v250
    v_and_b32 v254, 1, v0
    v_lshl_add_u32 v250, v254, 4, v250
    ds_read_b64_tr_b16 v[104:105], v14 offset:0
    v_bfe_u32 v254, v0, 1, 1
    v_lshl_add_u32 v250, v254, 3, v250
    s_add_u32 s100, s64, 0
    s_waitcnt lgkmcnt(7)
    ds_read_b64_tr_b16 v[106:107], v14 offset:1024
    buffer_load_dwordx4 v226, s[44:47], s87 offen offset:2048 lds
    ds_read_b64_tr_b16 v[108:109], v15 offset:0
    s_and_b32 s100, s100, 3
    v_xor_b32 v254, s100, v251
    v_lshl_add_u32 v244, v254, 6, v250
    ds_read_b64_tr_b16 v[110:111], v15 offset:1024
    buffer_load_dwordx4 v227, s[44:47], s87 offen offset:3072 lds
    v_mfma_f32_16x16x32_bf16 v[16:19], v[80:83], v[112:115], 0
    ds_read_b128 v[152:155], v233 offset:0
    ds_read_b128 v[156:159], v233 offset:2048
    s_add_u32 s100, s64, 1
    v_mfma_f32_16x16x32_bf16 v[20:23], v[80:83], v[116:119], 0
    ds_read_b64_tr_b16 v[120:121], v8 offset:8192
    s_and_b32 s100, s100, 3
    v_mfma_f32_16x16x32_bf16 v[24:27], v[84:87], v[112:115], 0
    ds_read_b64_tr_b16 v[122:123], v8 offset:9216
    ds_read_b64_tr_b16 v[124:125], v9 offset:8192
    s_add_u32 m0, s82, 131072
    s_add_u32 s87, s80, 0
    v_xor_b32 v240, 0, v2
    buffer_load_dwordx4 v240, s[36:39], s87 offen offset:0 nt lds
    v_mfma_f32_16x16x32_bf16 v[28:31], v[84:87], v[116:119], 0
    s_waitcnt lgkmcnt(7)
    ds_read_b64_tr_b16 v[126:127], v9 offset:9216
    v_xor_b32 v254, s100, v251
    v_mfma_f32_16x16x32_bf16 v[32:35], v[88:91], v[112:115], 0
    ds_read_b64_tr_b16 v[128:129], v10 offset:8192
    ds_read_b64_tr_b16 v[130:131], v10 offset:9216
    v_lshl_add_u32 v245, v254, 6, v250
    v_mfma_f32_16x16x32_bf16 v[36:39], v[88:91], v[116:119], 0
    ds_read_b64_tr_b16 v[132:133], v11 offset:8192
    v_xor_b32 v240, 64, v2
    buffer_load_dwordx4 v240, s[36:39], s87 offen offset:1024 nt lds
    v_mfma_f32_16x16x32_bf16 v[40:43], v[92:95], v[112:115], 0
    ds_read_b64_tr_b16 v[134:135], v11 offset:9216
    ds_read_b64_tr_b16 v[136:137], v12 offset:8192
    s_add_u32 s100, s64, 2
    v_mfma_f32_16x16x32_bf16 v[44:47], v[92:95], v[116:119], 0
    ds_read_b64_tr_b16 v[138:139], v12 offset:9216
    v_xor_b32 v240, 128, v2
    buffer_load_dwordx4 v240, s[36:39], s87 offen offset:2048 nt lds
    v_mfma_f32_16x16x32_bf16 v[48:51], v[96:99], v[112:115], 0
    ds_read_b64_tr_b16 v[140:141], v13 offset:8192
    s_waitcnt lgkmcnt(7)
    ds_read_b64_tr_b16 v[142:143], v13 offset:9216
    s_and_b32 s100, s100, 3
    v_mfma_f32_16x16x32_bf16 v[52:55], v[96:99], v[116:119], 0
    ds_read_b64_tr_b16 v[144:145], v14 offset:8192
    v_xor_b32 v254, s100, v251
    v_mfma_f32_16x16x32_bf16 v[56:59], v[100:103], v[112:115], 0
    ds_read_b64_tr_b16 v[146:147], v14 offset:9216
    ds_read_b64_tr_b16 v[148:149], v15 offset:8192
    v_xor_b32 v240, 192, v2
    buffer_load_dwordx4 v240, s[36:39], s87 offen offset:3072 nt lds
    v_mfma_f32_16x16x32_bf16 v[60:63], v[100:103], v[116:119], 0
    ds_read_b64_tr_b16 v[150:151], v15 offset:9216
    v_lshl_add_u32 v246, v254, 6, v250
    v_mfma_f32_16x16x32_bf16 v[64:67], v[104:107], v[112:115], 0
    s_add_u32 s100, s64, 3
    v_mfma_f32_16x16x32_bf16 v[68:71], v[104:107], v[116:119], 0
    s_add_u32 m0, s82, 135168
    s_add_u32 s87, s80, 4096
    v_xor_b32 v240, 0, v2
    buffer_load_dwordx4 v240, s[36:39], s87 offen offset:0 nt lds
    v_mfma_f32_16x16x32_bf16 v[72:75], v[108:111], v[112:115], 0
    s_and_b32 s100, s100, 3
    v_mfma_f32_16x16x32_bf16 v[76:79], v[108:111], v[116:119], 0
    v_xor_b32 v240, 64, v2
    buffer_load_dwordx4 v240, s[36:39], s87 offen offset:1024 nt lds
    s_waitcnt lgkmcnt(0)
    s_waitcnt vmcnt(15)
    s_barrier
    v_mfma_f32_16x16x32_bf16 v[16:19], v[120:123], v[152:155], v[16:19]
    ds_read_b128 v[112:115], v232 offset:4096
    ds_read_b128 v[116:119], v232 offset:6144
    v_xor_b32 v254, s100, v251
    v_mfma_f32_16x16x32_bf16 v[20:23], v[120:123], v[156:159], v[20:23]
    ds_read_b64_tr_b16 v[80:81], v8 offset:16384
    v_lshl_add_u32 v247, v254, 6, v250
    v_mfma_f32_16x16x32_bf16 v[24:27], v[124:127], v[152:155], v[24:27]
    ds_read_b64_tr_b16 v[82:83], v8 offset:17408
    v_xor_b32 v240, 128, v2
    buffer_load_dwordx4 v240, s[36:39], s87 offen offset:2048 nt lds
    v_mfma_f32_16x16x32_bf16 v[28:31], v[124:127], v[156:159], v[28:31]
    ds_read_b64_tr_b16 v[84:85], v9 offset:16384
    v_and_b32 v254, 3, v0
    v_mfma_f32_16x16x32_bf16 v[32:35], v[128:131], v[152:155], v[32:35]
    ds_read_b64_tr_b16 v[86:87], v9 offset:17408
    v_lshl_add_u32 v254, v251, 3, v254
    v_mfma_f32_16x16x32_bf16 v[36:39], v[128:131], v[156:159], v[36:39]
    ds_read_b64_tr_b16 v[88:89], v10 offset:16384
    v_xor_b32 v240, 192, v2
    buffer_load_dwordx4 v240, s[36:39], s87 offen offset:3072 nt lds
    v_mfma_f32_16x16x32_bf16 v[40:43], v[132:135], v[152:155], v[40:43]
    ds_read_b64_tr_b16 v[90:91], v10 offset:17408
    v_and_b32 v255, 15, v254
    v_mfma_f32_16x16x32_bf16 v[44:47], v[132:135], v[156:159], v[44:47]
    ds_read_b64_tr_b16 v[92:93], v11 offset:16384
    s_add_u32 m0, s78, 12288
    s_add_u32 s87, s92, 256
    buffer_load_dwordx4 v228, s[32:35], s87 offen offset:0 lds
    v_mfma_f32_16x16x32_bf16 v[48:51], v[136:139], v[152:155], v[48:51]
    ds_read_b64_tr_b16 v[94:95], v11 offset:17408
    ds_read_b64_tr_b16 v[96:97], v12 offset:16384
    v_lshrrev_b32 v248, 5, v0
    v_mfma_f32_16x16x32_bf16 v[52:55], v[136:139], v[156:159], v[52:55]
    ds_read_b64_tr_b16 v[98:99], v12 offset:17408
    v_xor_b32 v255, v255, v248
    v_mfma_f32_16x16x32_bf16 v[56:59], v[140:143], v[152:155], v[56:59]
    ds_read_b64_tr_b16 v[100:101], v13 offset:16384
    buffer_load_dwordx4 v229, s[32:35], s87 offen offset:1024 lds
    v_mfma_f32_16x16x32_bf16 v[60:63], v[140:143], v[156:159], v[60:63]
    ds_read_b64_tr_b16 v[102:103], v13 offset:17408
    v_lshlrev_b32 v255, 4, v255
    v_mfma_f32_16x16x32_bf16 v[64:67], v[144:147], v[152:155], v[64:67]
    ds_read_b64_tr_b16 v[104:105], v14 offset:16384
    v_lshl_add_u32 v254, v254, 8, v255
    v_mfma_f32_16x16x32_bf16 v[68:71], v[144:147], v[156:159], v[68:71]
    s_waitcnt lgkmcnt(7)
    ds_read_b64_tr_b16 v[106:107], v14 offset:17408
    buffer_load_dwordx4 v230, s[32:35], s87 offen offset:2048 lds
    v_mfma_f32_16x16x32_bf16 v[72:75], v[148:151], v[152:155], v[72:75]
    ds_read_b64_tr_b16 v[108:109], v15 offset:16384
    v_bfe_u32 v255, v0, 4, 1
    v_mfma_f32_16x16x32_bf16 v[76:79], v[148:151], v[156:159], v[76:79]
    ds_read_b64_tr_b16 v[110:111], v15 offset:17408
    buffer_load_dwordx4 v231, s[32:35], s87 offen offset:3072 lds
    v_mfma_f32_16x16x32_bf16 v[16:19], v[80:83], v[112:115], v[16:19]
    ds_read_b128 v[152:155], v233 offset:4096
    ds_read_b128 v[156:159], v233 offset:6144
    v_lshl_add_u32 v254, v255, 3, v254
    v_mfma_f32_16x16x32_bf16 v[20:23], v[80:83], v[116:119], v[20:23]
    ds_read_b64_tr_b16 v[120:121], v8 offset:24576
    s_add_u32 s100, s82, 131072
    v_mfma_f32_16x16x32_bf16 v[24:27], v[84:87], v[112:115], v[24:27]
    ds_read_b64_tr_b16 v[122:123], v8 offset:25600
    ds_read_b64_tr_b16 v[124:125], v9 offset:24576
    s_add_u32 m0, s81, 49152
    s_add_u32 s87, s88, 1048576
    buffer_load_dwordx4 v224, s[44:47], s87 offen offset:0 lds
    v_mfma_f32_16x16x32_bf16 v[28:31], v[84:87], v[116:119], v[28:31]
    s_waitcnt lgkmcnt(7)
    ds_read_b64_tr_b16 v[126:127], v9 offset:25600
    v_add_u32 v248, s100, v254
    v_mfma_f32_16x16x32_bf16 v[32:35], v[88:91], v[112:115], v[32:35]
    ds_read_b64_tr_b16 v[128:129], v10 offset:24576
    ds_read_b64_tr_b16 v[130:131], v10 offset:25600
    v_lshlrev_b32 v249, 4, v0
    v_mfma_f32_16x16x32_bf16 v[36:39], v[88:91], v[116:119], v[36:39]
    ds_read_b64_tr_b16 v[132:133], v11 offset:24576
    buffer_load_dwordx4 v225, s[44:47], s87 offen offset:1024 lds
    v_mfma_f32_16x16x32_bf16 v[40:43], v[92:95], v[112:115], v[40:43]
    ds_read_b64_tr_b16 v[134:135], v11 offset:25600
    ds_read_b64_tr_b16 v[136:137], v12 offset:24576
    v_mov_b32 v241, 0
    v_mfma_f32_16x16x32_bf16 v[44:47], v[92:95], v[116:119], v[44:47]
    ds_read_b64_tr_b16 v[138:139], v12 offset:25600
    buffer_load_dwordx4 v226, s[44:47], s87 offen offset:2048 lds
    v_mfma_f32_16x16x32_bf16 v[48:51], v[96:99], v[112:115], v[48:51]
    ds_read_b64_tr_b16 v[140:141], v13 offset:24576
    s_waitcnt lgkmcnt(7)
    ds_read_b64_tr_b16 v[142:143], v13 offset:25600
    s_lshl_b32 s98, s66, 2
    v_mfma_f32_16x16x32_bf16 v[52:55], v[96:99], v[116:119], v[52:55]
    ds_read_b64_tr_b16 v[144:145], v14 offset:24576
    s_add_u32 s98, s98, s64
    v_mfma_f32_16x16x32_bf16 v[56:59], v[100:103], v[112:115], v[56:59]
    ds_read_b64_tr_b16 v[146:147], v14 offset:25600
    ds_read_b64_tr_b16 v[148:149], v15 offset:24576
    buffer_load_dwordx4 v227, s[44:47], s87 offen offset:3072 lds
    v_mfma_f32_16x16x32_bf16 v[60:63], v[100:103], v[116:119], v[60:63]
    ds_read_b64_tr_b16 v[150:151], v15 offset:25600
    s_lshl_b32 s99, s98, 19
    v_mfma_f32_16x16x32_bf16 v[64:67], v[104:107], v[112:115], v[64:67]
    s_add_u32 s83, s67, 1
    v_mfma_f32_16x16x32_bf16 v[68:71], v[104:107], v[116:119], v[68:71]
    s_add_u32 m0, s78, 0
    s_add_u32 s87, s92, 384
    buffer_load_dwordx4 v228, s[32:35], s87 offen offset:0 lds
    v_mfma_f32_16x16x32_bf16 v[72:75], v[108:111], v[112:115], v[72:75]
    s_and_b32 s83, s83, 7
    v_mfma_f32_16x16x32_bf16 v[76:79], v[108:111], v[116:119], v[76:79]
    buffer_load_dwordx4 v229, s[32:35], s87 offen offset:1024 lds
    s_waitcnt lgkmcnt(0)
    s_waitcnt vmcnt(18)
    s_barrier
    v_mfma_f32_16x16x32_bf16 v[16:19], v[120:123], v[152:155], v[16:19]
    ds_read_b128 v[112:115], v232 offset:8192
    ds_read_b128 v[116:119], v232 offset:10240
    s_lshl_b32 s100, s83, 8
    v_mfma_f32_16x16x32_bf16 v[20:23], v[120:123], v[156:159], v[20:23]
    ds_read_b64_tr_b16 v[80:81], v8 offset:32768
    s_add_u32 s99, s99, s100
    v_mfma_f32_16x16x32_bf16 v[24:27], v[124:127], v[152:155], v[24:27]
    ds_read_b64_tr_b16 v[82:83], v8 offset:33792
    buffer_load_dwordx4 v230, s[32:35], s87 offen offset:2048 lds
    v_mfma_f32_16x16x32_bf16 v[28:31], v[124:127], v[156:159], v[28:31]
    ds_read_b64_tr_b16 v[84:85], v9 offset:32768
    s_add_u32 s100, s79, 0
    v_mfma_f32_16x16x32_bf16 v[32:35], v[128:131], v[152:155], v[32:35]
    ds_read_b64_tr_b16 v[86:87], v9 offset:33792
    s_and_b32 s100, s100, 3
    v_mfma_f32_16x16x32_bf16 v[36:39], v[128:131], v[156:159], v[36:39]
    ds_read_b64_tr_b16 v[88:89], v10 offset:32768
    buffer_load_dwordx4 v231, s[32:35], s87 offen offset:3072 lds
    v_mfma_f32_16x16x32_bf16 v[40:43], v[132:135], v[152:155], v[40:43]
    ds_read_b64_tr_b16 v[90:91], v10 offset:33792
    s_lshl_b32 s101, s100, 17
    v_mfma_f32_16x16x32_bf16 v[44:47], v[132:135], v[156:159], v[44:47]
    ds_read_b64_tr_b16 v[92:93], v11 offset:32768
    s_add_u32 m0, s81, 0
    s_add_u32 s87, s88, 1572864
    buffer_load_dwordx4 v224, s[44:47], s87 offen offset:0 lds
    v_mfma_f32_16x16x32_bf16 v[48:51], v[136:139], v[152:155], v[48:51]
    ds_read_b64_tr_b16 v[94:95], v11 offset:33792
    ds_read_b64_tr_b16 v[96:97], v12 offset:32768
    s_add_u32 s4, s99, s101
    v_mfma_f32_16x16x32_bf16 v[52:55], v[136:139], v[156:159], v[52:55]
    ds_read_b64_tr_b16 v[98:99], v12 offset:33792
    s_lshl_b32 s8, s100, 12
    v_mfma_f32_16x16x32_bf16 v[56:59], v[140:143], v[152:155], v[56:59]
    ds_read_b64_tr_b16 v[100:101], v13 offset:32768
    buffer_load_dwordx4 v225, s[44:47], s87 offen offset:1024 lds
    v_mfma_f32_16x16x32_bf16 v[60:63], v[140:143], v[156:159], v[60:63]
    ds_read_b64_tr_b16 v[102:103], v13 offset:33792
    s_add_u32 s12, s66, 1
    v_mfma_f32_16x16x32_bf16 v[64:67], v[144:147], v[152:155], v[64:67]
    ds_read_b64_tr_b16 v[104:105], v14 offset:32768
    s_and_b32 s12, s12, 3
    v_mfma_f32_16x16x32_bf16 v[68:71], v[144:147], v[156:159], v[68:71]
    s_waitcnt lgkmcnt(7)
    ds_read_b64_tr_b16 v[106:107], v14 offset:33792
    buffer_load_dwordx4 v226, s[44:47], s87 offen offset:2048 lds
    v_mfma_f32_16x16x32_bf16 v[72:75], v[148:151], v[152:155], v[72:75]
    ds_read_b64_tr_b16 v[108:109], v15 offset:32768
    s_add_u32 s100, s79, 1
    v_mfma_f32_16x16x32_bf16 v[76:79], v[148:151], v[156:159], v[76:79]
    ds_read_b64_tr_b16 v[110:111], v15 offset:33792
    buffer_load_dwordx4 v227, s[44:47], s87 offen offset:3072 lds
    v_mfma_f32_16x16x32_bf16 v[16:19], v[80:83], v[112:115], v[16:19]
    ds_read_b128 v[152:155], v233 offset:8192
    ds_read_b128 v[156:159], v233 offset:10240
    s_and_b32 s100, s100, 3
    v_mfma_f32_16x16x32_bf16 v[20:23], v[80:83], v[116:119], v[20:23]
    ds_read_b64_tr_b16 v[120:121], v8 offset:40960
    s_lshl_b32 s101, s100, 17
    v_mfma_f32_16x16x32_bf16 v[24:27], v[84:87], v[112:115], v[24:27]
    ds_read_b64_tr_b16 v[122:123], v8 offset:41984
    ds_read_b64_tr_b16 v[124:125], v9 offset:40960
    s_add_u32 m0, s78, 4096
    s_add_u32 s87, s92, 640
    buffer_load_dwordx4 v228, s[32:35], s87 offen offset:0 lds
    v_mfma_f32_16x16x32_bf16 v[28:31], v[84:87], v[116:119], v[28:31]
    s_waitcnt lgkmcnt(7)
    ds_read_b64_tr_b16 v[126:127], v9 offset:41984
    s_add_u32 s5, s99, s101
    v_mfma_f32_16x16x32_bf16 v[32:35], v[88:91], v[112:115], v[32:35]
    ds_read_b64_tr_b16 v[128:129], v10 offset:40960
    ds_read_b64_tr_b16 v[130:131], v10 offset:41984
    s_lshl_b32 s9, s100, 12
    v_mfma_f32_16x16x32_bf16 v[36:39], v[88:91], v[116:119], v[36:39]
    ds_read_b64_tr_b16 v[132:133], v11 offset:40960
    buffer_load_dwordx4 v229, s[32:35], s87 offen offset:1024 lds
    v_mfma_f32_16x16x32_bf16 v[40:43], v[92:95], v[112:115], v[40:43]
    ds_read_b64_tr_b16 v[134:135], v11 offset:41984
    ds_read_b64_tr_b16 v[136:137], v12 offset:40960
    s_add_u32 s13, s66, 2
    v_mfma_f32_16x16x32_bf16 v[44:47], v[92:95], v[116:119], v[44:47]
    ds_read_b64_tr_b16 v[138:139], v12 offset:41984
    s_and_b32 s13, s13, 3
    v_mfma_f32_16x16x32_bf16 v[48:51], v[96:99], v[112:115], v[48:51]
    ds_read_b64_tr_b16 v[140:141], v13 offset:40960
    s_waitcnt lgkmcnt(7)
    ds_read_b64_tr_b16 v[142:143], v13 offset:41984
    buffer_load_dwordx4 v230, s[32:35], s87 offen offset:2048 lds
    v_mfma_f32_16x16x32_bf16 v[52:55], v[96:99], v[116:119], v[52:55]
    ds_read_b64_tr_b16 v[144:145], v14 offset:40960
    s_add_u32 s100, s79, 2
    v_mfma_f32_16x16x32_bf16 v[56:59], v[100:103], v[112:115], v[56:59]
    ds_read_b64_tr_b16 v[146:147], v14 offset:41984
    ds_read_b64_tr_b16 v[148:149], v15 offset:40960
    buffer_load_dwordx4 v231, s[32:35], s87 offen offset:3072 lds
    v_mfma_f32_16x16x32_bf16 v[60:63], v[100:103], v[116:119], v[60:63]
    ds_read_b64_tr_b16 v[150:151], v15 offset:41984
    s_and_b32 s100, s100, 3
    v_mfma_f32_16x16x32_bf16 v[64:67], v[104:107], v[112:115], v[64:67]
    s_lshl_b32 s101, s100, 17
    v_mfma_f32_16x16x32_bf16 v[68:71], v[104:107], v[116:119], v[68:71]
    s_add_u32 m0, s81, 16384
    s_add_u32 s87, s88, 2621440
    buffer_load_dwordx4 v224, s[44:47], s87 offen offset:0 lds
    v_mfma_f32_16x16x32_bf16 v[72:75], v[108:111], v[112:115], v[72:75]
    s_add_u32 s6, s99, s101
    v_mfma_f32_16x16x32_bf16 v[76:79], v[108:111], v[116:119], v[76:79]
    s_lshl_b32 s10, s100, 12
    s_waitcnt lgkmcnt(0)
    s_waitcnt vmcnt(13)
    s_barrier
    v_mfma_f32_16x16x32_bf16 v[16:19], v[120:123], v[152:155], v[16:19]
    ds_read_b128 v[112:115], v232 offset:12288
    ds_read_b128 v[116:119], v232 offset:14336
    buffer_load_dwordx4 v225, s[44:47], s87 offen offset:1024 lds
    v_mfma_f32_16x16x32_bf16 v[20:23], v[120:123], v[156:159], v[20:23]
    ds_read_b64_tr_b16 v[80:81], v8 offset:49152
    v_xor_b32 v253, 0, v248
    ds_read_b64 v[160:161], v253 offset:0
    v_mfma_f32_16x16x32_bf16 v[24:27], v[124:127], v[152:155], v[24:27]
    ds_read_b64_tr_b16 v[82:83], v8 offset:50176
    buffer_load_dwordx4 v226, s[44:47], s87 offen offset:2048 lds
    v_mfma_f32_16x16x32_bf16 v[28:31], v[124:127], v[156:159], v[28:31]
    ds_read_b64_tr_b16 v[84:85], v9 offset:49152
    v_xor_b32 v253, 32, v248
    ds_read_b64 v[162:163], v253 offset:0
    v_mfma_f32_16x16x32_bf16 v[32:35], v[128:131], v[152:155], v[32:35]
    ds_read_b64_tr_b16 v[86:87], v9 offset:50176
    v_xor_b32 v253, 64, v248
    ds_read_b64 v[164:165], v253 offset:0
    v_mfma_f32_16x16x32_bf16 v[36:39], v[128:131], v[156:159], v[36:39]
    ds_read_b64_tr_b16 v[88:89], v10 offset:49152
    buffer_load_dwordx4 v227, s[44:47], s87 offen offset:3072 lds
    v_mfma_f32_16x16x32_bf16 v[40:43], v[132:135], v[152:155], v[40:43]
    ds_read_b64_tr_b16 v[90:91], v10 offset:50176
    v_xor_b32 v253, 96, v248
    ds_read_b64 v[166:167], v253 offset:0
    v_mfma_f32_16x16x32_bf16 v[44:47], v[132:135], v[156:159], v[44:47]
    ds_read_b64_tr_b16 v[92:93], v11 offset:49152
    s_add_u32 s14, s66, 3
    v_mfma_f32_16x16x32_bf16 v[48:51], v[136:139], v[152:155], v[48:51]
    ds_read_b64_tr_b16 v[94:95], v11 offset:50176
    ds_read_b64_tr_b16 v[96:97], v12 offset:49152
    s_add_u32 m0, s78, 8192
    s_add_u32 s87, s93, 0
    buffer_load_dwordx4 v228, s[32:35], s87 offen offset:0 lds
    v_xor_b32 v253, 128, v248
    s_waitcnt lgkmcnt(7)
    ds_read_b64 v[168:169], v253 offset:0
    v_mfma_f32_16x16x32_bf16 v[52:55], v[136:139], v[156:159], v[52:55]
    ds_read_b64_tr_b16 v[98:99], v12 offset:50176
    v_xor_b32 v253, 160, v248
    ds_read_b64 v[170:171], v253 offset:0
    v_mfma_f32_16x16x32_bf16 v[56:59], v[140:143], v[152:155], v[56:59]
    ds_read_b64_tr_b16 v[100:101], v13 offset:49152
    buffer_load_dwordx4 v229, s[32:35], s87 offen offset:1024 lds
    v_mfma_f32_16x16x32_bf16 v[60:63], v[140:143], v[156:159], v[60:63]
    ds_read_b64_tr_b16 v[102:103], v13 offset:50176
    v_xor_b32 v253, 192, v248
    ds_read_b64 v[172:173], v253 offset:0
    v_mfma_f32_16x16x32_bf16 v[64:67], v[144:147], v[152:155], v[64:67]
    ds_read_b64_tr_b16 v[104:105], v14 offset:49152
    v_xor_b32 v253, 224, v248
    ds_read_b64 v[174:175], v253 offset:0
    v_mfma_f32_16x16x32_bf16 v[68:71], v[144:147], v[156:159], v[68:71]
    s_waitcnt lgkmcnt(7)
    ds_read_b64_tr_b16 v[106:107], v14 offset:50176
    buffer_load_dwordx4 v230, s[32:35], s87 offen offset:2048 lds
    v_mfma_f32_16x16x32_bf16 v[72:75], v[148:151], v[152:155], v[72:75]
    ds_read_b64_tr_b16 v[108:109], v15 offset:49152
    v_xor_b32 v253, 64, v248
    ds_read_b64 v[176:177], v253 offset:1024
    v_mfma_f32_16x16x32_bf16 v[76:79], v[148:151], v[156:159], v[76:79]
    ds_read_b64_tr_b16 v[110:111], v15 offset:50176
    s_and_b32 s14, s14, 3
    v_mfma_f32_16x16x32_bf16 v[16:19], v[80:83], v[112:115], v[16:19]
    ds_read_b128 v[152:155], v233 offset:12288
    ds_read_b128 v[156:159], v233 offset:14336
    buffer_load_dwordx4 v231, s[32:35], s87 offen offset:3072 lds
    v_xor_b32 v253, 96, v248
    ds_read_b64 v[178:179], v253 offset:1024
    v_mfma_f32_16x16x32_bf16 v[20:23], v[80:83], v[116:119], v[20:23]
    ds_read_b64_tr_b16 v[120:121], v8 offset:57344
    v_xor_b32 v253, 0, v248
    s_waitcnt lgkmcnt(7)
    ds_read_b64 v[180:181], v253 offset:1024
    v_mfma_f32_16x16x32_bf16 v[24:27], v[84:87], v[112:115], v[24:27]
    ds_read_b64_tr_b16 v[122:123], v8 offset:58368
    ds_read_b64_tr_b16 v[124:125], v9 offset:57344
    s_add_u32 m0, s81, 32768
    s_add_u32 s87, s89, 0
    buffer_load_dwordx4 v224, s[44:47], s87 offen offset:0 lds
    v_mfma_f32_16x16x32_bf16 v[28:31], v[84:87], v[116:119], v[28:31]
    ds_read_b64_tr_b16 v[126:127], v9 offset:58368
    v_xor_b32 v253, 32, v248
    ds_read_b64 v[182:183], v253 offset:1024
    v_mfma_f32_16x16x32_bf16 v[32:35], v[88:91], v[112:115], v[32:35]
    ds_read_b64_tr_b16 v[128:129], v10 offset:57344
    ds_read_b64_tr_b16 v[130:131], v10 offset:58368
    s_add_u32 s100, s79, 3
    v_mfma_f32_16x16x32_bf16 v[36:39], v[88:91], v[116:119], v[36:39]
    ds_read_b64_tr_b16 v[132:133], v11 offset:57344
    buffer_load_dwordx4 v225, s[44:47], s87 offen offset:1024 lds
    v_xor_b32 v253, 192, v248
    s_waitcnt lgkmcnt(7)
    ds_read_b64 v[184:185], v253 offset:1024
    v_mfma_f32_16x16x32_bf16 v[40:43], v[92:95], v[112:115], v[40:43]
    ds_read_b64_tr_b16 v[134:135], v11 offset:58368
    ds_read_b64_tr_b16 v[136:137], v12 offset:57344
    v_xor_b32 v253, 224, v248
    ds_read_b64 v[186:187], v253 offset:1024
    v_mfma_f32_16x16x32_bf16 v[44:47], v[92:95], v[116:119], v[44:47]
    ds_read_b64_tr_b16 v[138:139], v12 offset:58368
    s_and_b32 s100, s100, 3
    v_mfma_f32_16x16x32_bf16 v[48:51], v[96:99], v[112:115], v[48:51]
    ds_read_b64_tr_b16 v[140:141], v13 offset:57344
    ds_read_b64_tr_b16 v[142:143], v13 offset:58368
    buffer_load_dwordx4 v226, s[44:47], s87 offen offset:2048 lds
    v_xor_b32 v253, 128, v248
    ds_read_b64 v[188:189], v253 offset:1024
    v_mfma_f32_16x16x32_bf16 v[52:55], v[96:99], v[116:119], v[52:55]
    s_waitcnt lgkmcnt(7)
    ds_read_b64_tr_b16 v[144:145], v14 offset:57344
    v_xor_b32 v253, 160, v248
    ds_read_b64 v[190:191], v253 offset:1024
    v_mfma_f32_16x16x32_bf16 v[56:59], v[100:103], v[112:115], v[56:59]
    ds_read_b64_tr_b16 v[146:147], v14 offset:58368
    ds_read_b64_tr_b16 v[148:149], v15 offset:57344
    buffer_load_dwordx4 v227, s[44:47], s87 offen offset:3072 lds
    v_mfma_f32_16x16x32_bf16 v[60:63], v[100:103], v[116:119], v[60:63]
    ds_read_b64_tr_b16 v[150:151], v15 offset:58368
    s_lshl_b32 s101, s100, 17
    v_mfma_f32_16x16x32_bf16 v[64:67], v[104:107], v[112:115], v[64:67]
    s_add_u32 s7, s99, s101
    v_mfma_f32_16x16x32_bf16 v[68:71], v[104:107], v[116:119], v[68:71]
    s_lshl_b32 s11, s100, 12
    v_mfma_f32_16x16x32_bf16 v[72:75], v[108:111], v[112:115], v[72:75]
    s_add_u32 s15, s66, 4
    v_mfma_f32_16x16x32_bf16 v[76:79], v[108:111], v[116:119], v[76:79]
    s_and_b32 s15, s15, 3
    s_waitcnt lgkmcnt(0)
    s_waitcnt vmcnt(16)
    s_barrier
    v_mfma_f32_16x16x32_bf16 v[16:19], v[120:123], v[152:155], v[16:19]
    ds_read_b128 v[112:115], v232 offset:0
    ds_read_b128 v[116:119], v232 offset:2048
    s_add_u32 m0, s82, 131072
    s_add_u32 s87, s80, 0
    buffer_load_dwordx4 v3, s[40:43], s87 offen offset:0 nt lds
    v_mfma_f32_16x16x32_bf16 v[20:23], v[120:123], v[156:159], v[20:23]
    ds_read_b64_tr_b16 v[80:81], v8 offset:0
    buffer_load_dwordx4 v3, s[40:43], s87 offen offset:1024 nt lds
    v_mfma_f32_16x16x32_bf16 v[24:27], v[124:127], v[152:155], v[24:27]
    ds_read_b64_tr_b16 v[82:83], v8 offset:1024
    v_xor_b32 v240, 32, v3
    buffer_load_dwordx4 v240, s[40:43], s87 offen offset:2048 nt lds
    v_mfma_f32_16x16x32_bf16 v[28:31], v[124:127], v[156:159], v[28:31]
    ds_read_b64_tr_b16 v[84:85], v9 offset:0
    s_lshl_b32 s99, s65, 2
    v_mfma_f32_16x16x32_bf16 v[32:35], v[128:131], v[152:155], v[32:35]
    ds_read_b64_tr_b16 v[86:87], v9 offset:1024
    s_add_u32 s99, s99, s68
    v_mfma_f32_16x16x32_bf16 v[36:39], v[128:131], v[156:159], v[36:39]
    ds_read_b64_tr_b16 v[88:89], v10 offset:0
    buffer_load_dwordx4 v240, s[40:43], s87 offen offset:3072 nt lds
    v_mfma_f32_16x16x32_bf16 v[40:43], v[132:135], v[152:155], v[40:43]
    ds_read_b64_tr_b16 v[90:91], v10 offset:1024
    s_lshl_b32 s99, s99, 21
    v_mfma_f32_16x16x32_bf16 v[44:47], v[132:135], v[156:159], v[44:47]
    ds_read_b64_tr_b16 v[92:93], v11 offset:0
    s_lshl_b32 s100, s98, 14
    v_mfma_f32_16x16x32_bf16 v[48:51], v[136:139], v[152:155], v[48:51]
    ds_read_b64_tr_b16 v[94:95], v11 offset:1024
    ds_read_b64_tr_b16 v[96:97], v12 offset:0
    s_add_u32 m0, s82, 135168
    s_add_u32 s87, s80, 4096
    buffer_load_dwordx4 v3, s[40:43], s87 offen offset:0 nt lds
    v_mfma_f32_16x16x32_bf16 v[52:55], v[136:139], v[156:159], v[52:55]
    ds_read_b64_tr_b16 v[98:99], v12 offset:1024
    s_add_u32 s16, s99, s100
    v_mfma_f32_16x16x32_bf16 v[56:59], v[140:143], v[152:155], v[56:59]
    ds_read_b64_tr_b16 v[100:101], v13 offset:0
    buffer_load_dwordx4 v3, s[40:43], s87 offen offset:1024 nt lds
    v_mfma_f32_16x16x32_bf16 v[60:63], v[140:143], v[156:159], v[60:63]
    ds_read_b64_tr_b16 v[102:103], v13 offset:1024
    s_and_b32 s100, s80, 0xfffff
    v_mfma_f32_16x16x32_bf16 v[64:67], v[144:147], v[152:155], v[64:67]
    ds_read_b64_tr_b16 v[104:105], v14 offset:0
    s_add_u32 s22, s99, s100
    v_mfma_f32_16x16x32_bf16 v[68:71], v[144:147], v[156:159], v[68:71]
    s_waitcnt lgkmcnt(7)
    ds_read_b64_tr_b16 v[106:107], v14 offset:1024
    v_xor_b32 v240, 32, v3
    buffer_load_dwordx4 v240, s[40:43], s87 offen offset:2048 nt lds
    v_mfma_f32_16x16x32_bf16 v[72:75], v[148:151], v[152:155], v[72:75]
    ds_read_b64_tr_b16 v[108:109], v15 offset:0
    s_add_u32 s23, s22, 4096
    v_mfma_f32_16x16x32_bf16 v[76:79], v[148:151], v[156:159], v[76:79]
    ds_read_b64_tr_b16 v[110:111], v15 offset:1024
    s_add_u32 s99, s99, 1048576
    v_mfma_f32_16x16x32_bf16 v[16:19], v[80:83], v[112:115], v[16:19]
    ds_read_b128 v[152:155], v233 offset:0
    ds_read_b128 v[156:159], v233 offset:2048
    buffer_load_dwordx4 v240, s[40:43], s87 offen offset:3072 nt lds
    v_mfma_f32_16x16x32_bf16 v[20:23], v[80:83], v[116:119], v[20:23]
    ds_read_b64_tr_b16 v[120:121], v8 offset:8192
    s_mul_i32 s100, s66, 40960
    v_mfma_f32_16x16x32_bf16 v[24:27], v[84:87], v[112:115], v[24:27]
    ds_read_b64_tr_b16 v[122:123], v8 offset:9216
    ds_read_b64_tr_b16 v[124:125], v9 offset:8192
    s_add_u32 m0, s78, 12288
    s_add_u32 s87, s92, 768
    buffer_load_dwordx4 v228, s[32:35], s87 offen offset:0 lds
    v_mfma_f32_16x16x32_bf16 v[28:31], v[84:87], v[116:119], v[28:31]
    s_waitcnt lgkmcnt(7)
    ds_read_b64_tr_b16 v[126:127], v9 offset:9216
    s_add_u32 s100, s100, s99
    v_mfma_f32_16x16x32_bf16 v[32:35], v[88:91], v[112:115], v[32:35]
    ds_read_b64_tr_b16 v[128:129], v10 offset:8192
    ds_read_b64_tr_b16 v[130:131], v10 offset:9216
    s_lshl_b32 s101, s64, 10
    v_mfma_f32_16x16x32_bf16 v[36:39], v[88:91], v[116:119], v[36:39]
    ds_read_b64_tr_b16 v[132:133], v11 offset:8192
    buffer_load_dwordx4 v229, s[32:35], s87 offen offset:1024 lds
    v_mfma_f32_16x16x32_bf16 v[40:43], v[92:95], v[112:115], v[40:43]
    ds_read_b64_tr_b16 v[134:135], v11 offset:9216
    ds_read_b64_tr_b16 v[136:137], v12 offset:8192
    s_add_u32 s19, s100, s101
    v_mfma_f32_16x16x32_bf16 v[44:47], v[92:95], v[116:119], v[44:47]
    ds_read_b64_tr_b16 v[138:139], v12 offset:9216
    buffer_load_dwordx4 v230, s[32:35], s87 offen offset:2048 lds
    v_mfma_f32_16x16x32_bf16 v[48:51], v[96:99], v[112:115], v[48:51]
    ds_read_b64_tr_b16 v[140:141], v13 offset:8192
    s_waitcnt lgkmcnt(7)
    ds_read_b64_tr_b16 v[142:143], v13 offset:9216
    s_lshl_b32 s101, s67, 2
    v_mfma_f32_16x16x32_bf16 v[52:55], v[96:99], v[116:119], v[52:55]
    ds_read_b64_tr_b16 v[144:145], v14 offset:8192
    s_add_u32 s101, s101, s64
    v_mfma_f32_16x16x32_bf16 v[56:59], v[100:103], v[112:115], v[56:59]
    ds_read_b64_tr_b16 v[146:147], v14 offset:9216
    ds_read_b64_tr_b16 v[148:149], v15 offset:8192
    buffer_load_dwordx4 v231, s[32:35], s87 offen offset:3072 lds
    v_mfma_f32_16x16x32_bf16 v[60:63], v[100:103], v[116:119], v[60:63]
    ds_read_b64_tr_b16 v[150:151], v15 offset:9216
    s_lshl_b32 s101, s101, 7
    v_mfma_f32_16x16x32_bf16 v[64:67], v[104:107], v[112:115], v[64:67]
    s_add_u32 s18, s100, s101
    v_mfma_f32_16x16x32_bf16 v[68:71], v[104:107], v[116:119], v[68:71]
    s_add_u32 m0, s81, 49152
    s_add_u32 s87, s88, 3145728
    buffer_load_dwordx4 v224, s[44:47], s87 offen offset:0 lds
    v_mfma_f32_16x16x32_bf16 v[72:75], v[108:111], v[112:115], v[72:75]
    s_lshl_b32 s100, s83, 17
    v_mfma_f32_16x16x32_bf16 v[76:79], v[108:111], v[116:119], v[76:79]
    buffer_load_dwordx4 v225, s[44:47], s87 offen offset:1024 lds
    s_waitcnt lgkmcnt(0)
    s_waitcnt vmcnt(22)
    s_barrier
    v_mfma_f32_16x16x32_bf16 v[16:19], v[120:123], v[152:155], v[16:19]
    ds_read_b128 v[112:115], v232 offset:4096
    ds_read_b128 v[116:119], v232 offset:6144
    s_add_u32 s100, s100, s99
    v_mfma_f32_16x16x32_bf16 v[20:23], v[120:123], v[156:159], v[20:23]
    ds_read_b64_tr_b16 v[80:81], v8 offset:16384
    s_lshl_b32 s101, s98, 11
    v_mfma_f32_16x16x32_bf16 v[24:27], v[124:127], v[152:155], v[24:27]
    ds_read_b64_tr_b16 v[82:83], v8 offset:17408
    buffer_load_dwordx4 v226, s[44:47], s87 offen offset:2048 lds
    v_mfma_f32_16x16x32_bf16 v[28:31], v[124:127], v[156:159], v[28:31]
    ds_read_b64_tr_b16 v[84:85], v9 offset:16384
    s_add_u32 s17, s100, s101
    v_mfma_f32_16x16x32_bf16 v[32:35], v[128:131], v[152:155], v[32:35]
    ds_read_b64_tr_b16 v[86:87], v9 offset:17408
    s_lshl_b32 s101, s66, 15
    v_mfma_f32_16x16x32_bf16 v[36:39], v[128:131], v[156:159], v[36:39]
    ds_read_b64_tr_b16 v[88:89], v10 offset:16384
    buffer_load_dwordx4 v227, s[44:47], s87 offen offset:3072 lds
    v_mfma_f32_16x16x32_bf16 v[40:43], v[132:135], v[152:155], v[40:43]
    ds_read_b64_tr_b16 v[90:91], v10 offset:17408
    s_add_u32 s21, s100, s101
    v_mfma_f32_16x16x32_bf16 v[44:47], v[132:135], v[156:159], v[44:47]
    ds_read_b64_tr_b16 v[92:93], v11 offset:16384
    s_add_u32 m0, s78, 0
    s_add_u32 s87, s92, 896
    buffer_load_dwordx4 v228, s[32:35], s87 offen offset:0 lds
    v_mfma_f32_16x16x32_bf16 v[48:51], v[136:139], v[152:155], v[48:51]
    ds_read_b64_tr_b16 v[94:95], v11 offset:17408
    ds_read_b64_tr_b16 v[96:97], v12 offset:16384
    s_lshl_b32 s101, s64, 11
    v_mfma_f32_16x16x32_bf16 v[52:55], v[136:139], v[156:159], v[52:55]
    ds_read_b64_tr_b16 v[98:99], v12 offset:17408
    s_add_u32 s21, s21, s101
    v_mfma_f32_16x16x32_bf16 v[56:59], v[140:143], v[152:155], v[56:59]
    ds_read_b64_tr_b16 v[100:101], v13 offset:16384
    buffer_load_dwordx4 v229, s[32:35], s87 offen offset:1024 lds
    v_mfma_f32_16x16x32_bf16 v[60:63], v[140:143], v[156:159], v[60:63]
    ds_read_b64_tr_b16 v[102:103], v13 offset:17408
    s_lshl_b32 s100, s68, 2
    v_mfma_f32_16x16x32_bf16 v[64:67], v[144:147], v[152:155], v[64:67]
    ds_read_b64_tr_b16 v[104:105], v14 offset:16384
    s_add_u32 s100, s100, s66
    v_mfma_f32_16x16x32_bf16 v[68:71], v[144:147], v[156:159], v[68:71]
    s_waitcnt lgkmcnt(7)
    ds_read_b64_tr_b16 v[106:107], v14 offset:17408
    buffer_load_dwordx4 v230, s[32:35], s87 offen offset:2048 lds
    v_mfma_f32_16x16x32_bf16 v[72:75], v[148:151], v[152:155], v[72:75]
    ds_read_b64_tr_b16 v[108:109], v15 offset:16384
    s_lshl_b32 s100, s100, 17
    v_mfma_f32_16x16x32_bf16 v[76:79], v[148:151], v[156:159], v[76:79]
    ds_read_b64_tr_b16 v[110:111], v15 offset:17408
    buffer_load_dwordx4 v231, s[32:35], s87 offen offset:3072 lds
    v_mfma_f32_16x16x32_bf16 v[16:19], v[80:83], v[112:115], v[16:19]
    ds_read_b128 v[152:155], v233 offset:4096
    ds_read_b128 v[156:159], v233 offset:6144
    s_lshl_b32 s101, s65, 11
    v_mfma_f32_16x16x32_bf16 v[20:23], v[80:83], v[116:119], v[20:23]
    ds_read_b64_tr_b16 v[120:121], v8 offset:24576
    s_add_u32 s100, s100, s101
    v_mfma_f32_16x16x32_bf16 v[24:27], v[84:87], v[112:115], v[24:27]
    ds_read_b64_tr_b16 v[122:123], v8 offset:25600
    ds_read_b64_tr_b16 v[124:125], v9 offset:24576
    s_add_u32 m0, s81, 0
    s_add_u32 s87, s88, 3670016
    buffer_load_dwordx4 v224, s[44:47], s87 offen offset:0 lds
    v_mfma_f32_16x16x32_bf16 v[28:31], v[84:87], v[116:119], v[28:31]
    s_waitcnt lgkmcnt(7)
    ds_read_b64_tr_b16 v[126:127], v9 offset:25600
    s_lshl_b32 s101, s83, 8
    v_mfma_f32_16x16x32_bf16 v[32:35], v[88:91], v[112:115], v[32:35]
    ds_read_b64_tr_b16 v[128:129], v10 offset:24576
    ds_read_b64_tr_b16 v[130:131], v10 offset:25600
    s_add_u32 s100, s100, s101
    v_mfma_f32_16x16x32_bf16 v[36:39], v[88:91], v[116:119], v[36:39]
    ds_read_b64_tr_b16 v[132:133], v11 offset:24576
    buffer_load_dwordx4 v225, s[44:47], s87 offen offset:1024 lds
    v_mfma_f32_16x16x32_bf16 v[40:43], v[92:95], v[112:115], v[40:43]
    ds_read_b64_tr_b16 v[134:135], v11 offset:25600
    ds_read_b64_tr_b16 v[136:137], v12 offset:24576
    s_lshl_b32 s101, s64, 6
    v_mfma_f32_16x16x32_bf16 v[44:47], v[92:95], v[116:119], v[44:47]
    ds_read_b64_tr_b16 v[138:139], v12 offset:25600
    buffer_load_dwordx4 v226, s[44:47], s87 offen offset:2048 lds
    v_mfma_f32_16x16x32_bf16 v[48:51], v[96:99], v[112:115], v[48:51]
    ds_read_b64_tr_b16 v[140:141], v13 offset:24576
    s_waitcnt lgkmcnt(7)
    ds_read_b64_tr_b16 v[142:143], v13 offset:25600
    s_add_u32 s20, s100, s101
    v_mfma_f32_16x16x32_bf16 v[52:55], v[96:99], v[116:119], v[52:55]
    ds_read_b64_tr_b16 v[144:145], v14 offset:24576
    v_mfma_f32_16x16x32_bf16 v[56:59], v[100:103], v[112:115], v[56:59]
    ds_read_b64_tr_b16 v[146:147], v14 offset:25600
    ds_read_b64_tr_b16 v[148:149], v15 offset:24576
    buffer_load_dwordx4 v227, s[44:47], s87 offen offset:3072 lds
    v_mfma_f32_16x16x32_bf16 v[60:63], v[100:103], v[116:119], v[60:63]
    ds_read_b64_tr_b16 v[150:151], v15 offset:25600
    v_mfma_f32_16x16x32_bf16 v[64:67], v[104:107], v[112:115], v[64:67]
    v_mfma_f32_16x16x32_bf16 v[68:71], v[104:107], v[116:119], v[68:71]
    v_mfma_f32_16x16x32_bf16 v[72:75], v[108:111], v[112:115], v[72:75]
    v_mfma_f32_16x16x32_bf16 v[76:79], v[108:111], v[116:119], v[76:79]
    s_waitcnt lgkmcnt(0)
    s_waitcnt vmcnt(24)
    s_barrier
    v_mfma_f32_16x16x32_bf16 v[16:19], v[120:123], v[152:155], v[16:19]
    ds_read_b128 v[112:115], v232 offset:8192
    ds_read_b128 v[116:119], v232 offset:10240
    s_add_u32 m0, s78, 4096
    s_add_u32 s87, s93, 128
    buffer_load_dwordx4 v228, s[32:35], s87 offen offset:0 lds
    v_mfma_f32_16x16x32_bf16 v[20:23], v[120:123], v[156:159], v[20:23]
    ds_read_b64_tr_b16 v[80:81], v8 offset:32768
    buffer_load_dwordx4 v229, s[32:35], s87 offen offset:1024 lds
    v_mfma_f32_16x16x32_bf16 v[24:27], v[124:127], v[152:155], v[24:27]
    ds_read_b64_tr_b16 v[82:83], v8 offset:33792
    buffer_load_dwordx4 v230, s[32:35], s87 offen offset:2048 lds
    v_mfma_f32_16x16x32_bf16 v[28:31], v[124:127], v[156:159], v[28:31]
    ds_read_b64_tr_b16 v[84:85], v9 offset:32768
    v_mfma_f32_16x16x32_bf16 v[32:35], v[128:131], v[152:155], v[32:35]
    ds_read_b64_tr_b16 v[86:87], v9 offset:33792
    v_mfma_f32_16x16x32_bf16 v[36:39], v[128:131], v[156:159], v[36:39]
    ds_read_b64_tr_b16 v[88:89], v10 offset:32768
    buffer_load_dwordx4 v231, s[32:35], s87 offen offset:3072 lds
    v_mfma_f32_16x16x32_bf16 v[40:43], v[132:135], v[152:155], v[40:43]
    ds_read_b64_tr_b16 v[90:91], v10 offset:33792
    v_mfma_f32_16x16x32_bf16 v[44:47], v[132:135], v[156:159], v[44:47]
    ds_read_b64_tr_b16 v[92:93], v11 offset:32768
    s_add_u32 m0, s81, 16384
    s_add_u32 s87, s89, 524288
    buffer_load_dwordx4 v224, s[44:47], s87 offen offset:0 lds
    v_mfma_f32_16x16x32_bf16 v[48:51], v[136:139], v[152:155], v[48:51]
    ds_read_b64_tr_b16 v[94:95], v11 offset:33792
    ds_read_b64_tr_b16 v[96:97], v12 offset:32768
    v_mfma_f32_16x16x32_bf16 v[52:55], v[136:139], v[156:159], v[52:55]
    ds_read_b64_tr_b16 v[98:99], v12 offset:33792
    v_mfma_f32_16x16x32_bf16 v[56:59], v[140:143], v[152:155], v[56:59]
    ds_read_b64_tr_b16 v[100:101], v13 offset:32768
    buffer_load_dwordx4 v225, s[44:47], s87 offen offset:1024 lds
    v_mfma_f32_16x16x32_bf16 v[60:63], v[140:143], v[156:159], v[60:63]
    ds_read_b64_tr_b16 v[102:103], v13 offset:33792
    v_mfma_f32_16x16x32_bf16 v[64:67], v[144:147], v[152:155], v[64:67]
    ds_read_b64_tr_b16 v[104:105], v14 offset:32768
    v_mfma_f32_16x16x32_bf16 v[68:71], v[144:147], v[156:159], v[68:71]
    s_waitcnt lgkmcnt(7)
    ds_read_b64_tr_b16 v[106:107], v14 offset:33792
    buffer_load_dwordx4 v226, s[44:47], s87 offen offset:2048 lds
    v_mfma_f32_16x16x32_bf16 v[72:75], v[148:151], v[152:155], v[72:75]
    ds_read_b64_tr_b16 v[108:109], v15 offset:32768
    v_mfma_f32_16x16x32_bf16 v[76:79], v[148:151], v[156:159], v[76:79]
    ds_read_b64_tr_b16 v[110:111], v15 offset:33792
    buffer_load_dwordx4 v227, s[44:47], s87 offen offset:3072 lds
    v_mfma_f32_16x16x32_bf16 v[16:19], v[80:83], v[112:115], v[16:19]
    ds_read_b128 v[152:155], v233 offset:8192
    ds_read_b128 v[156:159], v233 offset:10240
    v_mfma_f32_16x16x32_bf16 v[20:23], v[80:83], v[116:119], v[20:23]
    ds_read_b64_tr_b16 v[120:121], v8 offset:40960
    v_mfma_f32_16x16x32_bf16 v[24:27], v[84:87], v[112:115], v[24:27]
    ds_read_b64_tr_b16 v[122:123], v8 offset:41984
    ds_read_b64_tr_b16 v[124:125], v9 offset:40960
    v_mfma_f32_16x16x32_bf16 v[28:31], v[84:87], v[116:119], v[28:31]
    s_waitcnt lgkmcnt(7)
    ds_read_b64_tr_b16 v[126:127], v9 offset:41984
    v_mfma_f32_16x16x32_bf16 v[32:35], v[88:91], v[112:115], v[32:35]
    ds_read_b64_tr_b16 v[128:129], v10 offset:40960
    ds_read_b64_tr_b16 v[130:131], v10 offset:41984
    v_mfma_f32_16x16x32_bf16 v[36:39], v[88:91], v[116:119], v[36:39]
    ds_read_b64_tr_b16 v[132:133], v11 offset:40960
    v_mfma_f32_16x16x32_bf16 v[40:43], v[92:95], v[112:115], v[40:43]
    ds_read_b64_tr_b16 v[134:135], v11 offset:41984
    ds_read_b64_tr_b16 v[136:137], v12 offset:40960
    v_mfma_f32_16x16x32_bf16 v[44:47], v[92:95], v[116:119], v[44:47]
    ds_read_b64_tr_b16 v[138:139], v12 offset:41984
    v_mfma_f32_16x16x32_bf16 v[48:51], v[96:99], v[112:115], v[48:51]
    ds_read_b64_tr_b16 v[140:141], v13 offset:40960
    s_waitcnt lgkmcnt(7)
    ds_read_b64_tr_b16 v[142:143], v13 offset:41984
    v_mfma_f32_16x16x32_bf16 v[52:55], v[96:99], v[116:119], v[52:55]
    ds_read_b64_tr_b16 v[144:145], v14 offset:40960
    v_mfma_f32_16x16x32_bf16 v[56:59], v[100:103], v[112:115], v[56:59]
    ds_read_b64_tr_b16 v[146:147], v14 offset:41984
    ds_read_b64_tr_b16 v[148:149], v15 offset:40960
    v_mfma_f32_16x16x32_bf16 v[60:63], v[100:103], v[116:119], v[60:63]
    ds_read_b64_tr_b16 v[150:151], v15 offset:41984
    v_mfma_f32_16x16x32_bf16 v[64:67], v[104:107], v[112:115], v[64:67]
    v_mfma_f32_16x16x32_bf16 v[68:71], v[104:107], v[116:119], v[68:71]
    v_mfma_f32_16x16x32_bf16 v[72:75], v[108:111], v[112:115], v[72:75]
    v_mfma_f32_16x16x32_bf16 v[76:79], v[108:111], v[116:119], v[76:79]
    s_waitcnt lgkmcnt(0)
    s_waitcnt vmcnt(16)
    s_barrier
    v_mfma_f32_16x16x32_bf16 v[16:19], v[120:123], v[152:155], v[16:19]
    ds_read_b128 v[112:115], v232 offset:12288
    ds_read_b128 v[116:119], v232 offset:14336
    s_add_u32 m0, s78, 8192
    s_add_u32 s87, s93, 512
    buffer_load_dwordx4 v228, s[32:35], s87 offen offset:0 lds
    v_mfma_f32_16x16x32_bf16 v[20:23], v[120:123], v[156:159], v[20:23]
    ds_read_b64_tr_b16 v[80:81], v8 offset:49152
    buffer_load_dwordx4 v229, s[32:35], s87 offen offset:1024 lds
    v_mfma_f32_16x16x32_bf16 v[24:27], v[124:127], v[152:155], v[24:27]
    ds_read_b64_tr_b16 v[82:83], v8 offset:50176
    buffer_load_dwordx4 v230, s[32:35], s87 offen offset:2048 lds
    v_mfma_f32_16x16x32_bf16 v[28:31], v[124:127], v[156:159], v[28:31]
    ds_read_b64_tr_b16 v[84:85], v9 offset:49152
    buffer_load_dwordx4 v231, s[32:35], s87 offen offset:3072 lds
    s_add_u32 s71, s82, 131072
    v_add_u32 v253, s71, v8
    ds_read_b64_tr_b16 v[192:193], v253 offset:0
    ds_read_b64_tr_b16 v[194:195], v253 offset:1024
    v_mfma_f32_16x16x32_bf16 v[32:35], v[128:131], v[152:155], v[32:35]
    ds_read_b64_tr_b16 v[86:87], v9 offset:50176
    s_add_u32 m0, s81, 32768
    s_add_u32 s87, s89, 2097152
    buffer_load_dwordx4 v224, s[44:47], s87 offen offset:0 lds
    v_mfma_f32_16x16x32_bf16 v[36:39], v[128:131], v[156:159], v[36:39]
    ds_read_b64_tr_b16 v[88:89], v10 offset:49152
    buffer_load_dwordx4 v225, s[44:47], s87 offen offset:1024 lds
    v_mfma_f32_16x16x32_bf16 v[40:43], v[132:135], v[152:155], v[40:43]
    ds_read_b64_tr_b16 v[90:91], v10 offset:50176
    buffer_load_dwordx4 v226, s[44:47], s87 offen offset:2048 lds
    v_add_u32 v253, s71, v9
    ds_read_b64_tr_b16 v[196:197], v253 offset:0
    ds_read_b64_tr_b16 v[198:199], v253 offset:1024
    v_mfma_f32_16x16x32_bf16 v[44:47], v[132:135], v[156:159], v[44:47]
    ds_read_b64_tr_b16 v[92:93], v11 offset:49152
    buffer_load_dwordx4 v227, s[44:47], s87 offen offset:3072 lds
    v_mfma_f32_16x16x32_bf16 v[48:51], v[136:139], v[152:155], v[48:51]
    ds_read_b64_tr_b16 v[94:95], v11 offset:50176
    ds_read_b64_tr_b16 v[96:97], v12 offset:49152
    v_mfma_f32_16x16x32_bf16 v[52:55], v[136:139], v[156:159], v[52:55]
    s_waitcnt lgkmcnt(7)
    ds_read_b64_tr_b16 v[98:99], v12 offset:50176
    v_add_u32 v253, s71, v10
    ds_read_b64_tr_b16 v[200:201], v253 offset:0
    ds_read_b64_tr_b16 v[202:203], v253 offset:1024
    v_mfma_f32_16x16x32_bf16 v[56:59], v[140:143], v[152:155], v[56:59]
    ds_read_b64_tr_b16 v[100:101], v13 offset:49152
    v_mfma_f32_16x16x32_bf16 v[60:63], v[140:143], v[156:159], v[60:63]
    ds_read_b64_tr_b16 v[102:103], v13 offset:50176
    v_mfma_f32_16x16x32_bf16 v[64:67], v[144:147], v[152:155], v[64:67]
    ds_read_b64_tr_b16 v[104:105], v14 offset:49152
    v_add_u32 v253, s71, v11
    ds_read_b64_tr_b16 v[204:205], v253 offset:0
    ds_read_b64_tr_b16 v[206:207], v253 offset:1024
    v_mfma_f32_16x16x32_bf16 v[68:71], v[144:147], v[156:159], v[68:71]
    s_waitcnt lgkmcnt(7)
    ds_read_b64_tr_b16 v[106:107], v14 offset:50176
    v_mfma_f32_16x16x32_bf16 v[72:75], v[148:151], v[152:155], v[72:75]
    ds_read_b64_tr_b16 v[108:109], v15 offset:49152
    v_mfma_f32_16x16x32_bf16 v[76:79], v[148:151], v[156:159], v[76:79]
    ds_read_b64_tr_b16 v[110:111], v15 offset:50176
    v_mfma_f32_16x16x32_bf16 v[16:19], v[80:83], v[112:115], v[16:19]
    ds_read_b128 v[152:155], v233 offset:12288
    ds_read_b128 v[156:159], v233 offset:14336
    v_add_u32 v253, s71, v12
    ds_read_b64_tr_b16 v[208:209], v253 offset:0
    ds_read_b64_tr_b16 v[210:211], v253 offset:1024
    v_mfma_f32_16x16x32_bf16 v[20:23], v[80:83], v[116:119], v[20:23]
    ds_read_b64_tr_b16 v[120:121], v8 offset:57344
    v_mfma_f32_16x16x32_bf16 v[24:27], v[84:87], v[112:115], v[24:27]
    s_waitcnt lgkmcnt(7)
    ds_read_b64_tr_b16 v[122:123], v8 offset:58368
    ds_read_b64_tr_b16 v[124:125], v9 offset:57344
    v_mfma_f32_16x16x32_bf16 v[28:31], v[84:87], v[116:119], v[28:31]
    ds_read_b64_tr_b16 v[126:127], v9 offset:58368
    v_add_u32 v253, s71, v13
    ds_read_b64_tr_b16 v[212:213], v253 offset:0
    ds_read_b64_tr_b16 v[214:215], v253 offset:1024
    v_mfma_f32_16x16x32_bf16 v[32:35], v[88:91], v[112:115], v[32:35]
    ds_read_b64_tr_b16 v[128:129], v10 offset:57344
    ds_read_b64_tr_b16 v[130:131], v10 offset:58368
    v_mfma_f32_16x16x32_bf16 v[36:39], v[88:91], v[116:119], v[36:39]
    ds_read_b64_tr_b16 v[132:133], v11 offset:57344
    v_mfma_f32_16x16x32_bf16 v[40:43], v[92:95], v[112:115], v[40:43]
    s_waitcnt lgkmcnt(7)
    ds_read_b64_tr_b16 v[134:135], v11 offset:58368
    ds_read_b64_tr_b16 v[136:137], v12 offset:57344
    v_add_u32 v253, s71, v14
    ds_read_b64_tr_b16 v[216:217], v253 offset:0
    ds_read_b64_tr_b16 v[218:219], v253 offset:1024
    v_mfma_f32_16x16x32_bf16 v[44:47], v[92:95], v[116:119], v[44:47]
    ds_read_b64_tr_b16 v[138:139], v12 offset:58368
    v_mfma_f32_16x16x32_bf16 v[48:51], v[96:99], v[112:115], v[48:51]
    ds_read_b64_tr_b16 v[140:141], v13 offset:57344
    ds_read_b64_tr_b16 v[142:143], v13 offset:58368
    v_mfma_f32_16x16x32_bf16 v[52:55], v[96:99], v[116:119], v[52:55]
    ds_read_b64_tr_b16 v[144:145], v14 offset:57344
    v_add_u32 v253, s71, v15
    s_waitcnt lgkmcnt(7)
    ds_read_b64_tr_b16 v[220:221], v253 offset:0
    ds_read_b64_tr_b16 v[222:223], v253 offset:1024
    v_mfma_f32_16x16x32_bf16 v[56:59], v[100:103], v[112:115], v[56:59]
    ds_read_b64_tr_b16 v[146:147], v14 offset:58368
    ds_read_b64_tr_b16 v[148:149], v15 offset:57344
    v_mfma_f32_16x16x32_bf16 v[60:63], v[100:103], v[116:119], v[60:63]
    ds_read_b64_tr_b16 v[150:151], v15 offset:58368
    v_mfma_f32_16x16x32_bf16 v[64:67], v[104:107], v[112:115], v[64:67]
    v_mfma_f32_16x16x32_bf16 v[68:71], v[104:107], v[116:119], v[68:71]
    v_mfma_f32_16x16x32_bf16 v[72:75], v[108:111], v[112:115], v[72:75]
    v_mfma_f32_16x16x32_bf16 v[76:79], v[108:111], v[116:119], v[76:79]
    s_waitcnt lgkmcnt(0)
    s_waitcnt vmcnt(16)
    s_barrier
    v_mfma_f32_16x16x32_bf16 v[16:19], v[120:123], v[152:155], v[16:19]
    ds_read_b128 v[112:115], v232 offset:0
    ds_read_b128 v[116:119], v232 offset:2048
    s_add_u32 m0, s82, 131072
    s_add_u32 s87, s4, 0
    buffer_load_dwordx4 v4, s[48:51], s87 offen offset:0 lds
    v_mfma_f32_16x16x32_bf16 v[20:23], v[120:123], v[156:159], v[20:23]
    ds_read_b64_tr_b16 v[80:81], v8 offset:0
    buffer_load_dwordx4 v5, s[48:51], s87 offen offset:1024 lds
    v_mfma_f32_16x16x32_bf16 v[24:27], v[124:127], v[152:155], v[24:27]
    ds_read_b64_tr_b16 v[82:83], v8 offset:1024
    buffer_load_dwordx4 v6, s[48:51], s87 offen offset:2048 lds
    v_mfma_f32_16x16x32_bf16 v[28:31], v[124:127], v[156:159], v[28:31]
    ds_read_b64_tr_b16 v[84:85], v9 offset:0
    buffer_load_dwordx4 v7, s[48:51], s87 offen offset:3072 lds
    v_mfma_f32_16x16x32_bf16 v[32:35], v[128:131], v[152:155], v[32:35]
    ds_read_b64_tr_b16 v[86:87], v9 offset:1024
    s_add_u32 m0, s82, 135168
    s_add_u32 s87, s4, 16384
    buffer_load_dwordx4 v4, s[48:51], s87 offen offset:0 lds
    v_mfma_f32_16x16x32_bf16 v[36:39], v[128:131], v[156:159], v[36:39]
    ds_read_b64_tr_b16 v[88:89], v10 offset:0
    buffer_load_dwordx4 v5, s[48:51], s87 offen offset:1024 lds
    v_mfma_f32_16x16x32_bf16 v[40:43], v[132:135], v[152:155], v[40:43]
    ds_read_b64_tr_b16 v[90:91], v10 offset:1024
    buffer_load_dwordx4 v6, s[48:51], s87 offen offset:2048 lds
    v_mfma_f32_16x16x32_bf16 v[44:47], v[132:135], v[156:159], v[44:47]
    ds_read_b64_tr_b16 v[92:93], v11 offset:0
    buffer_load_dwordx4 v7, s[48:51], s87 offen offset:3072 lds
    v_mfma_f32_16x16x32_bf16 v[48:51], v[136:139], v[152:155], v[48:51]
    ds_read_b64_tr_b16 v[94:95], v11 offset:1024
    ds_read_b64_tr_b16 v[96:97], v12 offset:0
    buffer_load_dword v252, v241, s[60:63], 0 offen sc1
    v_mfma_f32_16x16x32_bf16 v[52:55], v[136:139], v[156:159], v[52:55]
    ds_read_b64_tr_b16 v[98:99], v12 offset:1024
    buffer_load_dword v242, v241, s[52:55], s18 offen
    v_mfma_f32_16x16x32_bf16 v[56:59], v[140:143], v[152:155], v[56:59]
    ds_read_b64_tr_b16 v[100:101], v13 offset:0
    v_mfma_f32_16x16x32_bf16 v[60:63], v[140:143], v[156:159], v[60:63]
    ds_read_b64_tr_b16 v[102:103], v13 offset:1024
    v_mfma_f32_16x16x32_bf16 v[64:67], v[144:147], v[152:155], v[64:67]
    ds_read_b64_tr_b16 v[104:105], v14 offset:0
    v_mfma_f32_16x16x32_bf16 v[68:71], v[144:147], v[156:159], v[68:71]
    s_waitcnt lgkmcnt(7)
    ds_read_b64_tr_b16 v[106:107], v14 offset:1024
    v_mfma_f32_16x16x32_bf16 v[72:75], v[148:151], v[152:155], v[72:75]
    ds_read_b64_tr_b16 v[108:109], v15 offset:0
    v_mfma_f32_16x16x32_bf16 v[76:79], v[148:151], v[156:159], v[76:79]
    ds_read_b64_tr_b16 v[110:111], v15 offset:1024
    v_mfma_f32_16x16x32_bf16 v[16:19], v[80:83], v[112:115], v[16:19]
    ds_read_b128 v[152:155], v233 offset:0
    ds_read_b128 v[156:159], v233 offset:2048
    v_mfma_f32_16x16x32_bf16 v[20:23], v[80:83], v[116:119], v[20:23]
    ds_read_b64_tr_b16 v[120:121], v8 offset:8192
    v_mfma_f32_16x16x32_bf16 v[24:27], v[84:87], v[112:115], v[24:27]
    ds_read_b64_tr_b16 v[122:123], v8 offset:9216
    ds_read_b64_tr_b16 v[124:125], v9 offset:8192
    v_mfma_f32_16x16x32_bf16 v[28:31], v[84:87], v[116:119], v[28:31]
    s_waitcnt lgkmcnt(7)
    ds_read_b64_tr_b16 v[126:127], v9 offset:9216
    v_mfma_f32_16x16x32_bf16 v[32:35], v[88:91], v[112:115], v[32:35]
    ds_read_b64_tr_b16 v[128:129], v10 offset:8192
    ds_read_b64_tr_b16 v[130:131], v10 offset:9216
    s_add_u32 m0, s78, 12288
    s_add_u32 s87, s93, 256
    buffer_load_dwordx4 v228, s[32:35], s87 offen offset:0 lds
    v_mfma_f32_16x16x32_bf16 v[36:39], v[88:91], v[116:119], v[36:39]
    ds_read_b64_tr_b16 v[132:133], v11 offset:8192
    v_mfma_f32_16x16x32_bf16 v[40:43], v[92:95], v[112:115], v[40:43]
    ds_read_b64_tr_b16 v[134:135], v11 offset:9216
    ds_read_b64_tr_b16 v[136:137], v12 offset:8192
    v_mfma_f32_16x16x32_bf16 v[44:47], v[92:95], v[116:119], v[44:47]
    ds_read_b64_tr_b16 v[138:139], v12 offset:9216
    buffer_load_dwordx4 v229, s[32:35], s87 offen offset:1024 lds
    v_mfma_f32_16x16x32_bf16 v[48:51], v[96:99], v[112:115], v[48:51]
    ds_read_b64_tr_b16 v[140:141], v13 offset:8192
    s_waitcnt lgkmcnt(7)
    ds_read_b64_tr_b16 v[142:143], v13 offset:9216
    v_mfma_f32_16x16x32_bf16 v[52:55], v[96:99], v[116:119], v[52:55]
    ds_read_b64_tr_b16 v[144:145], v14 offset:8192
    v_mfma_f32_16x16x32_bf16 v[56:59], v[100:103], v[112:115], v[56:59]
    ds_read_b64_tr_b16 v[146:147], v14 offset:9216
    ds_read_b64_tr_b16 v[148:149], v15 offset:8192
    buffer_load_dwordx4 v230, s[32:35], s87 offen offset:2048 lds
    v_mfma_f32_16x16x32_bf16 v[60:63], v[100:103], v[116:119], v[60:63]
    ds_read_b64_tr_b16 v[150:151], v15 offset:9216
    v_mfma_f32_16x16x32_bf16 v[64:67], v[104:107], v[112:115], v[64:67]
    v_mfma_f32_16x16x32_bf16 v[68:71], v[104:107], v[116:119], v[68:71]
    buffer_load_dwordx4 v231, s[32:35], s87 offen offset:3072 lds
    v_mfma_f32_16x16x32_bf16 v[72:75], v[108:111], v[112:115], v[72:75]
    v_mfma_f32_16x16x32_bf16 v[76:79], v[108:111], v[116:119], v[76:79]
    s_add_u32 m0, s81, 49152
    s_add_u32 s87, s89, 1048576
    buffer_load_dwordx4 v224, s[44:47], s87 offen offset:0 lds
    s_waitcnt lgkmcnt(0)
    s_waitcnt vmcnt(23)
    s_barrier
    v_mfma_f32_16x16x32_bf16 v[16:19], v[120:123], v[152:155], v[16:19]
    ds_read_b128 v[112:115], v232 offset:4096
    ds_read_b128 v[116:119], v232 offset:6144
    v_mfma_f32_16x16x32_bf16 v[20:23], v[120:123], v[156:159], v[20:23]
    ds_read_b64_tr_b16 v[80:81], v8 offset:16384
    v_mfma_f32_16x16x32_bf16 v[24:27], v[124:127], v[152:155], v[24:27]
    ds_read_b64_tr_b16 v[82:83], v8 offset:17408
    buffer_load_dwordx4 v225, s[44:47], s87 offen offset:1024 lds
    v_mfma_f32_16x16x32_bf16 v[28:31], v[124:127], v[156:159], v[28:31]
    ds_read_b64_tr_b16 v[84:85], v9 offset:16384
    v_mfma_f32_16x16x32_bf16 v[32:35], v[128:131], v[152:155], v[32:35]
    ds_read_b64_tr_b16 v[86:87], v9 offset:17408
    v_mfma_f32_16x16x32_bf16 v[36:39], v[128:131], v[156:159], v[36:39]
    ds_read_b64_tr_b16 v[88:89], v10 offset:16384
    buffer_load_dwordx4 v226, s[44:47], s87 offen offset:2048 lds
    v_mfma_f32_16x16x32_bf16 v[40:43], v[132:135], v[152:155], v[40:43]
    ds_read_b64_tr_b16 v[90:91], v10 offset:17408
    v_mfma_f32_16x16x32_bf16 v[44:47], v[132:135], v[156:159], v[44:47]
    ds_read_b64_tr_b16 v[92:93], v11 offset:16384
    buffer_load_dwordx4 v227, s[44:47], s87 offen offset:3072 lds
    v_mfma_f32_16x16x32_bf16 v[48:51], v[136:139], v[152:155], v[48:51]
    ds_read_b64_tr_b16 v[94:95], v11 offset:17408
    ds_read_b64_tr_b16 v[96:97], v12 offset:16384
    s_add_u32 m0, s78, 0
    s_add_u32 s87, s93, 384
    buffer_load_dwordx4 v228, s[32:35], s87 offen offset:0 lds
    v_mfma_f32_16x16x32_bf16 v[52:55], v[136:139], v[156:159], v[52:55]
    ds_read_b64_tr_b16 v[98:99], v12 offset:17408
    buffer_load_dwordx4 v229, s[32:35], s87 offen offset:1024 lds
    v_mfma_f32_16x16x32_bf16 v[56:59], v[140:143], v[152:155], v[56:59]
    ds_read_b64_tr_b16 v[100:101], v13 offset:16384
    v_mfma_f32_16x16x32_bf16 v[60:63], v[140:143], v[156:159], v[60:63]
    ds_read_b64_tr_b16 v[102:103], v13 offset:17408
    buffer_load_dwordx4 v230, s[32:35], s87 offen offset:2048 lds
    v_mfma_f32_16x16x32_bf16 v[64:67], v[144:147], v[152:155], v[64:67]
    ds_read_b64_tr_b16 v[104:105], v14 offset:16384
    v_mfma_f32_16x16x32_bf16 v[68:71], v[144:147], v[156:159], v[68:71]
    s_waitcnt lgkmcnt(7)
    ds_read_b64_tr_b16 v[106:107], v14 offset:17408
    v_mfma_f32_16x16x32_bf16 v[72:75], v[148:151], v[152:155], v[72:75]
    ds_read_b64_tr_b16 v[108:109], v15 offset:16384
    buffer_load_dwordx4 v231, s[32:35], s87 offen offset:3072 lds
    v_mfma_f32_16x16x32_bf16 v[76:79], v[148:151], v[156:159], v[76:79]
    ds_read_b64_tr_b16 v[110:111], v15 offset:17408
    v_mfma_f32_16x16x32_bf16 v[16:19], v[80:83], v[112:115], v[16:19]
    ds_read_b128 v[152:155], v233 offset:4096
    ds_read_b128 v[156:159], v233 offset:6144
    s_add_u32 m0, s81, 0
    s_add_u32 s87, s89, 1572864
    buffer_load_dwordx4 v224, s[44:47], s87 offen offset:0 lds
    v_mfma_f32_16x16x32_bf16 v[20:23], v[80:83], v[116:119], v[20:23]
    ds_read_b64_tr_b16 v[120:121], v8 offset:24576
    v_mfma_f32_16x16x32_bf16 v[24:27], v[84:87], v[112:115], v[24:27]
    ds_read_b64_tr_b16 v[122:123], v8 offset:25600
    ds_read_b64_tr_b16 v[124:125], v9 offset:24576
    v_mfma_f32_16x16x32_bf16 v[28:31], v[84:87], v[116:119], v[28:31]
    s_waitcnt lgkmcnt(7)
    ds_read_b64_tr_b16 v[126:127], v9 offset:25600
    buffer_load_dwordx4 v225, s[44:47], s87 offen offset:1024 lds
    v_mfma_f32_16x16x32_bf16 v[32:35], v[88:91], v[112:115], v[32:35]
    ds_read_b64_tr_b16 v[128:129], v10 offset:24576
    ds_read_b64_tr_b16 v[130:131], v10 offset:25600
    v_mfma_f32_16x16x32_bf16 v[36:39], v[88:91], v[116:119], v[36:39]
    ds_read_b64_tr_b16 v[132:133], v11 offset:24576
    v_mfma_f32_16x16x32_bf16 v[40:43], v[92:95], v[112:115], v[40:43]
    ds_read_b64_tr_b16 v[134:135], v11 offset:25600
    ds_read_b64_tr_b16 v[136:137], v12 offset:24576
    buffer_load_dwordx4 v226, s[44:47], s87 offen offset:2048 lds
    v_mfma_f32_16x16x32_bf16 v[44:47], v[92:95], v[116:119], v[44:47]
    ds_read_b64_tr_b16 v[138:139], v12 offset:25600
    v_mfma_f32_16x16x32_bf16 v[48:51], v[96:99], v[112:115], v[48:51]
    ds_read_b64_tr_b16 v[140:141], v13 offset:24576
    s_waitcnt lgkmcnt(7)
    ds_read_b64_tr_b16 v[142:143], v13 offset:25600
    buffer_load_dwordx4 v227, s[44:47], s87 offen offset:3072 lds
    v_mfma_f32_16x16x32_bf16 v[52:55], v[96:99], v[116:119], v[52:55]
    ds_read_b64_tr_b16 v[144:145], v14 offset:24576
    v_mfma_f32_16x16x32_bf16 v[56:59], v[100:103], v[112:115], v[56:59]
    ds_read_b64_tr_b16 v[146:147], v14 offset:25600
    ds_read_b64_tr_b16 v[148:149], v15 offset:24576
    v_mfma_f32_16x16x32_bf16 v[60:63], v[100:103], v[116:119], v[60:63]
    ds_read_b64_tr_b16 v[150:151], v15 offset:25600
    v_mfma_f32_16x16x32_bf16 v[64:67], v[104:107], v[112:115], v[64:67]
    v_mfma_f32_16x16x32_bf16 v[68:71], v[104:107], v[116:119], v[68:71]
    v_mfma_f32_16x16x32_bf16 v[72:75], v[108:111], v[112:115], v[72:75]
    v_mfma_f32_16x16x32_bf16 v[76:79], v[108:111], v[116:119], v[76:79]
    s_waitcnt lgkmcnt(0)
    s_waitcnt vmcnt(26)
    s_barrier
    v_mfma_f32_16x16x32_bf16 v[16:19], v[120:123], v[152:155], v[16:19]
    ds_read_b128 v[112:115], v232 offset:8192
    ds_read_b128 v[116:119], v232 offset:10240
    s_add_u32 m0, s78, 4096
    s_add_u32 s87, s93, 640
    buffer_load_dwordx4 v228, s[32:35], s87 offen offset:0 lds
    v_mfma_f32_16x16x32_bf16 v[20:23], v[120:123], v[156:159], v[20:23]
    ds_read_b64_tr_b16 v[80:81], v8 offset:32768
    buffer_load_dwordx4 v229, s[32:35], s87 offen offset:1024 lds
    v_mfma_f32_16x16x32_bf16 v[24:27], v[124:127], v[152:155], v[24:27]
    ds_read_b64_tr_b16 v[82:83], v8 offset:33792
    buffer_load_dwordx4 v230, s[32:35], s87 offen offset:2048 lds
    v_mfma_f32_16x16x32_bf16 v[28:31], v[124:127], v[156:159], v[28:31]
    ds_read_b64_tr_b16 v[84:85], v9 offset:32768
    buffer_load_dwordx4 v231, s[32:35], s87 offen offset:3072 lds
    v_mfma_f32_16x16x32_bf16 v[32:35], v[128:131], v[152:155], v[32:35]
    ds_read_b64_tr_b16 v[86:87], v9 offset:33792
    v_mfma_f32_16x16x32_bf16 v[36:39], v[128:131], v[156:159], v[36:39]
    ds_read_b64_tr_b16 v[88:89], v10 offset:32768
    v_mfma_f32_16x16x32_bf16 v[40:43], v[132:135], v[152:155], v[40:43]
    ds_read_b64_tr_b16 v[90:91], v10 offset:33792
    s_add_u32 m0, s81, 16384
    s_add_u32 s87, s89, 2621440
    buffer_load_dwordx4 v224, s[44:47], s87 offen offset:0 lds
    v_mfma_f32_16x16x32_bf16 v[44:47], v[132:135], v[156:159], v[44:47]
    ds_read_b64_tr_b16 v[92:93], v11 offset:32768
    v_mfma_f32_16x16x32_bf16 v[48:51], v[136:139], v[152:155], v[48:51]
    ds_read_b64_tr_b16 v[94:95], v11 offset:33792
    ds_read_b64_tr_b16 v[96:97], v12 offset:32768
    buffer_load_dwordx4 v225, s[44:47], s87 offen offset:1024 lds
    v_mfma_f32_16x16x32_bf16 v[52:55], v[136:139], v[156:159], v[52:55]
    ds_read_b64_tr_b16 v[98:99], v12 offset:33792
    v_mfma_f32_16x16x32_bf16 v[56:59], v[140:143], v[152:155], v[56:59]
    ds_read_b64_tr_b16 v[100:101], v13 offset:32768
    v_mfma_f32_16x16x32_bf16 v[60:63], v[140:143], v[156:159], v[60:63]
    ds_read_b64_tr_b16 v[102:103], v13 offset:33792
    buffer_load_dwordx4 v226, s[44:47], s87 offen offset:2048 lds
    v_mfma_f32_16x16x32_bf16 v[64:67], v[144:147], v[152:155], v[64:67]
    ds_read_b64_tr_b16 v[104:105], v14 offset:32768
    v_mfma_f32_16x16x32_bf16 v[68:71], v[144:147], v[156:159], v[68:71]
    s_waitcnt lgkmcnt(7)
    ds_read_b64_tr_b16 v[106:107], v14 offset:33792
    v_mfma_f32_16x16x32_bf16 v[72:75], v[148:151], v[152:155], v[72:75]
    ds_read_b64_tr_b16 v[108:109], v15 offset:32768
    buffer_load_dwordx4 v227, s[44:47], s87 offen offset:3072 lds
    v_mfma_f32_16x16x32_bf16 v[76:79], v[148:151], v[156:159], v[76:79]
    ds_read_b64_tr_b16 v[110:111], v15 offset:33792
    v_mfma_f32_16x16x32_bf16 v[16:19], v[80:83], v[112:115], v[16:19]
    ds_read_b128 v[152:155], v233 offset:8192
    ds_read_b128 v[156:159], v233 offset:10240
    v_mfma_f32_16x16x32_bf16 v[20:23], v[80:83], v[116:119], v[20:23]
    ds_read_b64_tr_b16 v[120:121], v8 offset:40960
    v_mfma_f32_16x16x32_bf16 v[24:27], v[84:87], v[112:115], v[24:27]
    ds_read_b64_tr_b16 v[122:123], v8 offset:41984
    ds_read_b64_tr_b16 v[124:125], v9 offset:40960
    v_mfma_f32_16x16x32_bf16 v[28:31], v[84:87], v[116:119], v[28:31]
    s_waitcnt lgkmcnt(7)
    ds_read_b64_tr_b16 v[126:127], v9 offset:41984
    v_mfma_f32_16x16x32_bf16 v[32:35], v[88:91], v[112:115], v[32:35]
    ds_read_b64_tr_b16 v[128:129], v10 offset:40960
    ds_read_b64_tr_b16 v[130:131], v10 offset:41984
    v_mfma_f32_16x16x32_bf16 v[36:39], v[88:91], v[116:119], v[36:39]
    ds_read_b64_tr_b16 v[132:133], v11 offset:40960
    v_mfma_f32_16x16x32_bf16 v[40:43], v[92:95], v[112:115], v[40:43]
    ds_read_b64_tr_b16 v[134:135], v11 offset:41984
    ds_read_b64_tr_b16 v[136:137], v12 offset:40960
    v_mfma_f32_16x16x32_bf16 v[44:47], v[92:95], v[116:119], v[44:47]
    ds_read_b64_tr_b16 v[138:139], v12 offset:41984
    v_mfma_f32_16x16x32_bf16 v[48:51], v[96:99], v[112:115], v[48:51]
    ds_read_b64_tr_b16 v[140:141], v13 offset:40960
    s_waitcnt lgkmcnt(7)
    ds_read_b64_tr_b16 v[142:143], v13 offset:41984
    v_mfma_f32_16x16x32_bf16 v[52:55], v[96:99], v[116:119], v[52:55]
    ds_read_b64_tr_b16 v[144:145], v14 offset:40960
    v_mfma_f32_16x16x32_bf16 v[56:59], v[100:103], v[112:115], v[56:59]
    ds_read_b64_tr_b16 v[146:147], v14 offset:41984
    ds_read_b64_tr_b16 v[148:149], v15 offset:40960
    v_mfma_f32_16x16x32_bf16 v[60:63], v[100:103], v[116:119], v[60:63]
    ds_read_b64_tr_b16 v[150:151], v15 offset:41984
    v_mfma_f32_16x16x32_bf16 v[64:67], v[104:107], v[112:115], v[64:67]
    v_mfma_f32_16x16x32_bf16 v[68:71], v[104:107], v[116:119], v[68:71]
    v_mfma_f32_16x16x32_bf16 v[72:75], v[108:111], v[112:115], v[72:75]
    v_mfma_f32_16x16x32_bf16 v[76:79], v[108:111], v[116:119], v[76:79]
    s_waitcnt lgkmcnt(0)
    s_waitcnt vmcnt(16)
    s_barrier
    v_mfma_f32_16x16x32_bf16 v[16:19], v[120:123], v[152:155], v[16:19]
    ds_read_b128 v[112:115], v232 offset:12288
    ds_read_b128 v[116:119], v232 offset:14336
    s_add_u32 m0, s78, 8192
    s_add_u32 s87, s93, 768
    buffer_load_dwordx4 v228, s[32:35], s87 offen offset:0 lds
    v_mfma_f32_16x16x32_bf16 v[20:23], v[120:123], v[156:159], v[20:23]
    ds_read_b64_tr_b16 v[80:81], v8 offset:49152
    buffer_load_dwordx4 v229, s[32:35], s87 offen offset:1024 lds
    v_mfma_f32_16x16x32_bf16 v[24:27], v[124:127], v[152:155], v[24:27]
    ds_read_b64_tr_b16 v[82:83], v8 offset:50176
    buffer_load_dwordx4 v230, s[32:35], s87 offen offset:2048 lds
    v_mfma_f32_16x16x32_bf16 v[28:31], v[124:127], v[156:159], v[28:31]
    ds_read_b64_tr_b16 v[84:85], v9 offset:49152
    buffer_load_dwordx4 v231, s[32:35], s87 offen offset:3072 lds
    s_add_u32 s71, s82, 131072
    v_add_u32 v253, s71, v244
    ds_read_b64_tr_b16 a[0:1], v253 offset:0
    ds_read_b64_tr_b16 a[2:3], v253 offset:1024
    v_mfma_f32_16x16x32_bf16 v[32:35], v[128:131], v[152:155], v[32:35]
    ds_read_b64_tr_b16 v[86:87], v9 offset:50176
    s_add_u32 m0, s81, 32768
    s_add_u32 s87, s89, 3145728
    buffer_load_dwordx4 v224, s[44:47], s87 offen offset:0 lds
    v_mfma_f32_16x16x32_bf16 v[36:39], v[128:131], v[156:159], v[36:39]
    ds_read_b64_tr_b16 v[88:89], v10 offset:49152
    buffer_load_dwordx4 v225, s[44:47], s87 offen offset:1024 lds
    v_mfma_f32_16x16x32_bf16 v[40:43], v[132:135], v[152:155], v[40:43]
    ds_read_b64_tr_b16 v[90:91], v10 offset:50176
    buffer_load_dwordx4 v226, s[44:47], s87 offen offset:2048 lds
    v_add_u32 v253, s71, v245
    ds_read_b64_tr_b16 a[4:5], v253 offset:0
    ds_read_b64_tr_b16 a[6:7], v253 offset:1024
    v_mfma_f32_16x16x32_bf16 v[44:47], v[132:135], v[156:159], v[44:47]
    ds_read_b64_tr_b16 v[92:93], v11 offset:49152
    buffer_load_dwordx4 v227, s[44:47], s87 offen offset:3072 lds
    v_mfma_f32_16x16x32_bf16 v[48:51], v[136:139], v[152:155], v[48:51]
    ds_read_b64_tr_b16 v[94:95], v11 offset:50176
    ds_read_b64_tr_b16 v[96:97], v12 offset:49152
    v_mfma_f32_16x16x32_bf16 v[52:55], v[136:139], v[156:159], v[52:55]
    s_waitcnt lgkmcnt(7)
    ds_read_b64_tr_b16 v[98:99], v12 offset:50176
    v_add_u32 v253, s71, v246
    ds_read_b64_tr_b16 a[8:9], v253 offset:0
    ds_read_b64_tr_b16 a[10:11], v253 offset:1024
    v_mfma_f32_16x16x32_bf16 v[56:59], v[140:143], v[152:155], v[56:59]
    ds_read_b64_tr_b16 v[100:101], v13 offset:49152
    v_mfma_f32_16x16x32_bf16 v[60:63], v[140:143], v[156:159], v[60:63]
    ds_read_b64_tr_b16 v[102:103], v13 offset:50176
    v_mfma_f32_16x16x32_bf16 v[64:67], v[144:147], v[152:155], v[64:67]
    ds_read_b64_tr_b16 v[104:105], v14 offset:49152
    v_add_u32 v253, s71, v247
    ds_read_b64_tr_b16 a[12:13], v253 offset:0
    ds_read_b64_tr_b16 a[14:15], v253 offset:1024
    v_mfma_f32_16x16x32_bf16 v[68:71], v[144:147], v[156:159], v[68:71]
    s_waitcnt lgkmcnt(7)
    ds_read_b64_tr_b16 v[106:107], v14 offset:50176
    v_mfma_f32_16x16x32_bf16 v[72:75], v[148:151], v[152:155], v[72:75]
    ds_read_b64_tr_b16 v[108:109], v15 offset:49152
    v_mfma_f32_16x16x32_bf16 v[76:79], v[148:151], v[156:159], v[76:79]
    ds_read_b64_tr_b16 v[110:111], v15 offset:50176
    v_mfma_f32_16x16x32_bf16 v[16:19], v[80:83], v[112:115], v[16:19]
    ds_read_b128 v[152:155], v233 offset:12288
    ds_read_b128 v[156:159], v233 offset:14336
    s_add_u32 s71, s82, 135168
    v_add_u32 v253, s71, v244
    ds_read_b64_tr_b16 a[16:17], v253 offset:0
    ds_read_b64_tr_b16 a[18:19], v253 offset:1024
    v_mfma_f32_16x16x32_bf16 v[20:23], v[80:83], v[116:119], v[20:23]
    ds_read_b64_tr_b16 v[120:121], v8 offset:57344
    v_mfma_f32_16x16x32_bf16 v[24:27], v[84:87], v[112:115], v[24:27]
    s_waitcnt lgkmcnt(7)
    ds_read_b64_tr_b16 v[122:123], v8 offset:58368
    ds_read_b64_tr_b16 v[124:125], v9 offset:57344
    v_mfma_f32_16x16x32_bf16 v[28:31], v[84:87], v[116:119], v[28:31]
    ds_read_b64_tr_b16 v[126:127], v9 offset:58368
    v_add_u32 v253, s71, v245
    ds_read_b64_tr_b16 a[20:21], v253 offset:0
    ds_read_b64_tr_b16 a[22:23], v253 offset:1024
    v_mfma_f32_16x16x32_bf16 v[32:35], v[88:91], v[112:115], v[32:35]
    ds_read_b64_tr_b16 v[128:129], v10 offset:57344
    ds_read_b64_tr_b16 v[130:131], v10 offset:58368
    v_mfma_f32_16x16x32_bf16 v[36:39], v[88:91], v[116:119], v[36:39]
    ds_read_b64_tr_b16 v[132:133], v11 offset:57344
    v_mfma_f32_16x16x32_bf16 v[40:43], v[92:95], v[112:115], v[40:43]
    s_waitcnt lgkmcnt(7)
    ds_read_b64_tr_b16 v[134:135], v11 offset:58368
    ds_read_b64_tr_b16 v[136:137], v12 offset:57344
    v_add_u32 v253, s71, v246
    ds_read_b64_tr_b16 a[24:25], v253 offset:0
    ds_read_b64_tr_b16 a[26:27], v253 offset:1024
    v_mfma_f32_16x16x32_bf16 v[44:47], v[92:95], v[116:119], v[44:47]
    ds_read_b64_tr_b16 v[138:139], v12 offset:58368
    v_mfma_f32_16x16x32_bf16 v[48:51], v[96:99], v[112:115], v[48:51]
    ds_read_b64_tr_b16 v[140:141], v13 offset:57344
    ds_read_b64_tr_b16 v[142:143], v13 offset:58368
    v_mfma_f32_16x16x32_bf16 v[52:55], v[96:99], v[116:119], v[52:55]
    ds_read_b64_tr_b16 v[144:145], v14 offset:57344
    v_add_u32 v253, s71, v247
    s_waitcnt lgkmcnt(7)
    ds_read_b64_tr_b16 a[28:29], v253 offset:0
    ds_read_b64_tr_b16 a[30:31], v253 offset:1024
    v_mfma_f32_16x16x32_bf16 v[56:59], v[100:103], v[112:115], v[56:59]
    ds_read_b64_tr_b16 v[146:147], v14 offset:58368
    ds_read_b64_tr_b16 v[148:149], v15 offset:57344
    v_mfma_f32_16x16x32_bf16 v[60:63], v[100:103], v[116:119], v[60:63]
    ds_read_b64_tr_b16 v[150:151], v15 offset:58368
    v_mfma_f32_16x16x32_bf16 v[64:67], v[104:107], v[112:115], v[64:67]
    v_mfma_f32_16x16x32_bf16 v[68:71], v[104:107], v[116:119], v[68:71]
    v_mfma_f32_16x16x32_bf16 v[72:75], v[108:111], v[112:115], v[72:75]
    v_mfma_f32_16x16x32_bf16 v[76:79], v[108:111], v[116:119], v[76:79]
    s_waitcnt lgkmcnt(0)
    s_waitcnt vmcnt(16)
    s_barrier
    v_mfma_f32_16x16x32_bf16 v[16:19], v[120:123], v[152:155], v[16:19]
    ds_read_b128 v[112:115], v232 offset:0
    ds_read_b128 v[116:119], v232 offset:2048
    s_add_u32 m0, s78, 12288
    s_add_u32 s87, s93, 896
    buffer_load_dwordx4 v228, s[32:35], s87 offen offset:0 lds
    v_mfma_f32_16x16x32_bf16 v[20:23], v[120:123], v[156:159], v[20:23]
    ds_read_b64_tr_b16 v[80:81], v8 offset:0
    buffer_load_dwordx4 v229, s[32:35], s87 offen offset:1024 lds
    v_mfma_f32_16x16x32_bf16 v[24:27], v[124:127], v[152:155], v[24:27]
    ds_read_b64_tr_b16 v[82:83], v8 offset:1024
    buffer_load_dwordx4 v230, s[32:35], s87 offen offset:2048 lds
    v_mfma_f32_16x16x32_bf16 v[28:31], v[124:127], v[156:159], v[28:31]
    ds_read_b64_tr_b16 v[84:85], v9 offset:0
    buffer_load_dwordx4 v231, s[32:35], s87 offen offset:3072 lds
    v_mfma_f32_16x16x32_bf16 v[32:35], v[128:131], v[152:155], v[32:35]
    ds_read_b64_tr_b16 v[86:87], v9 offset:1024
    s_add_u32 m0, s81, 49152
    s_add_u32 s87, s89, 3670016
    buffer_load_dwordx4 v224, s[44:47], s87 offen offset:0 lds
    v_mfma_f32_16x16x32_bf16 v[36:39], v[128:131], v[156:159], v[36:39]
    ds_read_b64_tr_b16 v[88:89], v10 offset:0
    buffer_load_dwordx4 v225, s[44:47], s87 offen offset:1024 lds
    v_mfma_f32_16x16x32_bf16 v[40:43], v[132:135], v[152:155], v[40:43]
    ds_read_b64_tr_b16 v[90:91], v10 offset:1024
    buffer_load_dwordx4 v226, s[44:47], s87 offen offset:2048 lds
    v_mfma_f32_16x16x32_bf16 v[44:47], v[132:135], v[156:159], v[44:47]
    ds_read_b64_tr_b16 v[92:93], v11 offset:0
    buffer_load_dwordx4 v227, s[44:47], s87 offen offset:3072 lds
    v_mfma_f32_16x16x32_bf16 v[48:51], v[136:139], v[152:155], v[48:51]
    ds_read_b64_tr_b16 v[94:95], v11 offset:1024
    ds_read_b64_tr_b16 v[96:97], v12 offset:0
    v_mfma_f32_16x16x32_bf16 v[52:55], v[136:139], v[156:159], v[52:55]
    ds_read_b64_tr_b16 v[98:99], v12 offset:1024
    v_mfma_f32_16x16x32_bf16 v[56:59], v[140:143], v[152:155], v[56:59]
    ds_read_b64_tr_b16 v[100:101], v13 offset:0
    v_mfma_f32_16x16x32_bf16 v[60:63], v[140:143], v[156:159], v[60:63]
    ds_read_b64_tr_b16 v[102:103], v13 offset:1024
    v_mfma_f32_16x16x32_bf16 v[64:67], v[144:147], v[152:155], v[64:67]
    ds_read_b64_tr_b16 v[104:105], v14 offset:0
    v_mfma_f32_16x16x32_bf16 v[68:71], v[144:147], v[156:159], v[68:71]
    s_waitcnt lgkmcnt(7)
    ds_read_b64_tr_b16 v[106:107], v14 offset:1024
    v_mfma_f32_16x16x32_bf16 v[72:75], v[148:151], v[152:155], v[72:75]
    ds_read_b64_tr_b16 v[108:109], v15 offset:0
    v_mfma_f32_16x16x32_bf16 v[76:79], v[148:151], v[156:159], v[76:79]
    ds_read_b64_tr_b16 v[110:111], v15 offset:1024
    v_mfma_f32_16x16x32_bf16 v[16:19], v[80:83], v[112:115], v[16:19]
    ds_read_b128 v[152:155], v233 offset:0
    ds_read_b128 v[156:159], v233 offset:2048
    v_mfma_f32_16x16x32_bf16 v[20:23], v[80:83], v[116:119], v[20:23]
    ds_read_b64_tr_b16 v[120:121], v8 offset:8192
    v_mfma_f32_16x16x32_bf16 v[24:27], v[84:87], v[112:115], v[24:27]
    ds_read_b64_tr_b16 v[122:123], v8 offset:9216
    ds_read_b64_tr_b16 v[124:125], v9 offset:8192
    v_mfma_f32_16x16x32_bf16 v[28:31], v[84:87], v[116:119], v[28:31]
    s_waitcnt lgkmcnt(7)
    ds_read_b64_tr_b16 v[126:127], v9 offset:9216
    v_mfma_f32_16x16x32_bf16 v[32:35], v[88:91], v[112:115], v[32:35]
    ds_read_b64_tr_b16 v[128:129], v10 offset:8192
    ds_read_b64_tr_b16 v[130:131], v10 offset:9216
    v_mfma_f32_16x16x32_bf16 v[36:39], v[88:91], v[116:119], v[36:39]
    ds_read_b64_tr_b16 v[132:133], v11 offset:8192
    v_mfma_f32_16x16x32_bf16 v[40:43], v[92:95], v[112:115], v[40:43]
    ds_read_b64_tr_b16 v[134:135], v11 offset:9216
    ds_read_b64_tr_b16 v[136:137], v12 offset:8192
    v_mfma_f32_16x16x32_bf16 v[44:47], v[92:95], v[116:119], v[44:47]
    ds_read_b64_tr_b16 v[138:139], v12 offset:9216
    v_mfma_f32_16x16x32_bf16 v[48:51], v[96:99], v[112:115], v[48:51]
    ds_read_b64_tr_b16 v[140:141], v13 offset:8192
    s_waitcnt lgkmcnt(7)
    ds_read_b64_tr_b16 v[142:143], v13 offset:9216
    v_mfma_f32_16x16x32_bf16 v[52:55], v[96:99], v[116:119], v[52:55]
    ds_read_b64_tr_b16 v[144:145], v14 offset:8192
    v_mfma_f32_16x16x32_bf16 v[56:59], v[100:103], v[112:115], v[56:59]
    ds_read_b64_tr_b16 v[146:147], v14 offset:9216
    ds_read_b64_tr_b16 v[148:149], v15 offset:8192
    v_mfma_f32_16x16x32_bf16 v[60:63], v[100:103], v[116:119], v[60:63]
    ds_read_b64_tr_b16 v[150:151], v15 offset:9216
    v_mfma_f32_16x16x32_bf16 v[64:67], v[104:107], v[112:115], v[64:67]
    v_mfma_f32_16x16x32_bf16 v[68:71], v[104:107], v[116:119], v[68:71]
    v_mfma_f32_16x16x32_bf16 v[72:75], v[108:111], v[112:115], v[72:75]
    v_mfma_f32_16x16x32_bf16 v[76:79], v[108:111], v[116:119], v[76:79]
    s_waitcnt lgkmcnt(0)
    s_waitcnt vmcnt(16)
    s_barrier
    v_mfma_f32_16x16x32_bf16 v[16:19], v[120:123], v[152:155], v[16:19]
    ds_read_b128 v[112:115], v232 offset:4096
    ds_read_b128 v[116:119], v232 offset:6144
    s_add_u32 m0, s81, 0
    s_add_u32 s87, s4, 65536
    buffer_load_dwordx4 v4, s[48:51], s87 offen offset:0 lds
    v_mfma_f32_16x16x32_bf16 v[20:23], v[120:123], v[156:159], v[20:23]
    ds_read_b64_tr_b16 v[80:81], v8 offset:16384
    buffer_load_dwordx4 v5, s[48:51], s87 offen offset:1024 lds
    v_mfma_f32_16x16x32_bf16 v[24:27], v[124:127], v[152:155], v[24:27]
    ds_read_b64_tr_b16 v[82:83], v8 offset:17408
    buffer_load_dwordx4 v6, s[48:51], s87 offen offset:2048 lds
    v_mfma_f32_16x16x32_bf16 v[28:31], v[124:127], v[156:159], v[28:31]
    ds_read_b64_tr_b16 v[84:85], v9 offset:16384
    buffer_load_dwordx4 v7, s[48:51], s87 offen offset:3072 lds
    v_mfma_f32_16x16x32_bf16 v[32:35], v[128:131], v[152:155], v[32:35]
    ds_read_b64_tr_b16 v[86:87], v9 offset:17408
    s_add_u32 m0, s78, 0
    s_add_u32 s87, s4, 81920
    buffer_load_dwordx4 v4, s[48:51], s87 offen offset:0 lds
    v_mfma_f32_16x16x32_bf16 v[36:39], v[128:131], v[156:159], v[36:39]
    ds_read_b64_tr_b16 v[88:89], v10 offset:16384
    buffer_load_dwordx4 v5, s[48:51], s87 offen offset:1024 lds
    v_mfma_f32_16x16x32_bf16 v[40:43], v[132:135], v[152:155], v[40:43]
    ds_read_b64_tr_b16 v[90:91], v10 offset:17408
    buffer_load_dwordx4 v6, s[48:51], s87 offen offset:2048 lds
    v_mfma_f32_16x16x32_bf16 v[44:47], v[132:135], v[156:159], v[44:47]
    ds_read_b64_tr_b16 v[92:93], v11 offset:16384
    buffer_load_dwordx4 v7, s[48:51], s87 offen offset:3072 lds
    v_mfma_f32_16x16x32_bf16 v[48:51], v[136:139], v[152:155], v[48:51]
    ds_read_b64_tr_b16 v[94:95], v11 offset:17408
    ds_read_b64_tr_b16 v[96:97], v12 offset:16384
    v_mfma_f32_16x16x32_bf16 v[52:55], v[136:139], v[156:159], v[52:55]
    ds_read_b64_tr_b16 v[98:99], v12 offset:17408
    v_mfma_f32_16x16x32_bf16 v[56:59], v[140:143], v[152:155], v[56:59]
    ds_read_b64_tr_b16 v[100:101], v13 offset:16384
    v_mfma_f32_16x16x32_bf16 v[60:63], v[140:143], v[156:159], v[60:63]
    ds_read_b64_tr_b16 v[102:103], v13 offset:17408
    v_mfma_f32_16x16x32_bf16 v[64:67], v[144:147], v[152:155], v[64:67]
    ds_read_b64_tr_b16 v[104:105], v14 offset:16384
    v_mfma_f32_16x16x32_bf16 v[68:71], v[144:147], v[156:159], v[68:71]
    s_waitcnt lgkmcnt(7)
    ds_read_b64_tr_b16 v[106:107], v14 offset:17408
    v_mfma_f32_16x16x32_bf16 v[72:75], v[148:151], v[152:155], v[72:75]
    ds_read_b64_tr_b16 v[108:109], v15 offset:16384
    v_mfma_f32_16x16x32_bf16 v[76:79], v[148:151], v[156:159], v[76:79]
    ds_read_b64_tr_b16 v[110:111], v15 offset:17408
    v_mfma_f32_16x16x32_bf16 v[16:19], v[80:83], v[112:115], v[16:19]
    ds_read_b128 v[152:155], v233 offset:4096
    ds_read_b128 v[156:159], v233 offset:6144
    v_mfma_f32_16x16x32_bf16 v[20:23], v[80:83], v[116:119], v[20:23]
    ds_read_b64_tr_b16 v[120:121], v8 offset:24576
    v_mfma_f32_16x16x32_bf16 v[24:27], v[84:87], v[112:115], v[24:27]
    ds_read_b64_tr_b16 v[122:123], v8 offset:25600
    ds_read_b64_tr_b16 v[124:125], v9 offset:24576
    v_mfma_f32_16x16x32_bf16 v[28:31], v[84:87], v[116:119], v[28:31]
    s_waitcnt lgkmcnt(7)
    ds_read_b64_tr_b16 v[126:127], v9 offset:25600
    v_mfma_f32_16x16x32_bf16 v[32:35], v[88:91], v[112:115], v[32:35]
    ds_read_b64_tr_b16 v[128:129], v10 offset:24576
    ds_read_b64_tr_b16 v[130:131], v10 offset:25600
    v_mfma_f32_16x16x32_bf16 v[36:39], v[88:91], v[116:119], v[36:39]
    ds_read_b64_tr_b16 v[132:133], v11 offset:24576
    v_mfma_f32_16x16x32_bf16 v[40:43], v[92:95], v[112:115], v[40:43]
    ds_read_b64_tr_b16 v[134:135], v11 offset:25600
    ds_read_b64_tr_b16 v[136:137], v12 offset:24576
    v_mfma_f32_16x16x32_bf16 v[44:47], v[92:95], v[116:119], v[44:47]
    ds_read_b64_tr_b16 v[138:139], v12 offset:25600
    v_mfma_f32_16x16x32_bf16 v[48:51], v[96:99], v[112:115], v[48:51]
    ds_read_b64_tr_b16 v[140:141], v13 offset:24576
    s_waitcnt lgkmcnt(7)
    ds_read_b64_tr_b16 v[142:143], v13 offset:25600
    v_mfma_f32_16x16x32_bf16 v[52:55], v[96:99], v[116:119], v[52:55]
    ds_read_b64_tr_b16 v[144:145], v14 offset:24576
    v_mfma_f32_16x16x32_bf16 v[56:59], v[100:103], v[112:115], v[56:59]
    ds_read_b64_tr_b16 v[146:147], v14 offset:25600
    ds_read_b64_tr_b16 v[148:149], v15 offset:24576
    v_mfma_f32_16x16x32_bf16 v[60:63], v[100:103], v[116:119], v[60:63]
    ds_read_b64_tr_b16 v[150:151], v15 offset:25600
    v_mfma_f32_16x16x32_bf16 v[64:67], v[104:107], v[112:115], v[64:67]
    v_mfma_f32_16x16x32_bf16 v[68:71], v[104:107], v[116:119], v[68:71]
    v_mfma_f32_16x16x32_bf16 v[72:75], v[108:111], v[112:115], v[72:75]
    v_mfma_f32_16x16x32_bf16 v[76:79], v[108:111], v[116:119], v[76:79]
    s_waitcnt lgkmcnt(0)
    s_waitcnt vmcnt(16)
    s_barrier
    v_mfma_f32_16x16x32_bf16 v[16:19], v[120:123], v[152:155], v[16:19]
    ds_read_b128 v[112:115], v232 offset:8192
    ds_read_b128 v[116:119], v232 offset:10240
    v_mfma_f32_16x16x32_bf16 v[20:23], v[120:123], v[156:159], v[20:23]
    ds_read_b64_tr_b16 v[80:81], v8 offset:32768
    v_mfma_f32_16x16x32_bf16 v[24:27], v[124:127], v[152:155], v[24:27]
    ds_read_b64_tr_b16 v[82:83], v8 offset:33792
    v_mfma_f32_16x16x32_bf16 v[28:31], v[124:127], v[156:159], v[28:31]
    ds_read_b64_tr_b16 v[84:85], v9 offset:32768
    v_mfma_f32_16x16x32_bf16 v[32:35], v[128:131], v[152:155], v[32:35]
    ds_read_b64_tr_b16 v[86:87], v9 offset:33792
    v_mfma_f32_16x16x32_bf16 v[36:39], v[128:131], v[156:159], v[36:39]
    ds_read_b64_tr_b16 v[88:89], v10 offset:32768
    v_mfma_f32_16x16x32_bf16 v[40:43], v[132:135], v[152:155], v[40:43]
    ds_read_b64_tr_b16 v[90:91], v10 offset:33792
    v_mfma_f32_16x16x32_bf16 v[44:47], v[132:135], v[156:159], v[44:47]
    ds_read_b64_tr_b16 v[92:93], v11 offset:32768
    v_mfma_f32_16x16x32_bf16 v[48:51], v[136:139], v[152:155], v[48:51]
    ds_read_b64_tr_b16 v[94:95], v11 offset:33792
    ds_read_b64_tr_b16 v[96:97], v12 offset:32768
    v_mfma_f32_16x16x32_bf16 v[52:55], v[136:139], v[156:159], v[52:55]
    ds_read_b64_tr_b16 v[98:99], v12 offset:33792
    v_mfma_f32_16x16x32_bf16 v[56:59], v[140:143], v[152:155], v[56:59]
    ds_read_b64_tr_b16 v[100:101], v13 offset:32768
    v_mfma_f32_16x16x32_bf16 v[60:63], v[140:143], v[156:159], v[60:63]
    ds_read_b64_tr_b16 v[102:103], v13 offset:33792
    v_mfma_f32_16x16x32_bf16 v[64:67], v[144:147], v[152:155], v[64:67]
    ds_read_b64_tr_b16 v[104:105], v14 offset:32768
    v_mfma_f32_16x16x32_bf16 v[68:71], v[144:147], v[156:159], v[68:71]
    s_waitcnt lgkmcnt(7)
    ds_read_b64_tr_b16 v[106:107], v14 offset:33792
    v_mfma_f32_16x16x32_bf16 v[72:75], v[148:151], v[152:155], v[72:75]
    ds_read_b64_tr_b16 v[108:109], v15 offset:32768
    v_mfma_f32_16x16x32_bf16 v[76:79], v[148:151], v[156:159], v[76:79]
    ds_read_b64_tr_b16 v[110:111], v15 offset:33792
    v_mfma_f32_16x16x32_bf16 v[16:19], v[80:83], v[112:115], v[16:19]
    ds_read_b128 v[152:155], v233 offset:8192
    ds_read_b128 v[156:159], v233 offset:10240
    v_mfma_f32_16x16x32_bf16 v[20:23], v[80:83], v[116:119], v[20:23]
    ds_read_b64_tr_b16 v[120:121], v8 offset:40960
    v_mfma_f32_16x16x32_bf16 v[24:27], v[84:87], v[112:115], v[24:27]
    ds_read_b64_tr_b16 v[122:123], v8 offset:41984
    ds_read_b64_tr_b16 v[124:125], v9 offset:40960
    v_mfma_f32_16x16x32_bf16 v[28:31], v[84:87], v[116:119], v[28:31]
    s_waitcnt lgkmcnt(7)
    ds_read_b64_tr_b16 v[126:127], v9 offset:41984
    v_mfma_f32_16x16x32_bf16 v[32:35], v[88:91], v[112:115], v[32:35]
    ds_read_b64_tr_b16 v[128:129], v10 offset:40960
    ds_read_b64_tr_b16 v[130:131], v10 offset:41984
    v_mfma_f32_16x16x32_bf16 v[36:39], v[88:91], v[116:119], v[36:39]
    ds_read_b64_tr_b16 v[132:133], v11 offset:40960
    v_mfma_f32_16x16x32_bf16 v[40:43], v[92:95], v[112:115], v[40:43]
    ds_read_b64_tr_b16 v[134:135], v11 offset:41984
    ds_read_b64_tr_b16 v[136:137], v12 offset:40960
    v_mfma_f32_16x16x32_bf16 v[44:47], v[92:95], v[116:119], v[44:47]
    ds_read_b64_tr_b16 v[138:139], v12 offset:41984
    v_mfma_f32_16x16x32_bf16 v[48:51], v[96:99], v[112:115], v[48:51]
    ds_read_b64_tr_b16 v[140:141], v13 offset:40960
    s_waitcnt lgkmcnt(7)
    ds_read_b64_tr_b16 v[142:143], v13 offset:41984
    v_mfma_f32_16x16x32_bf16 v[52:55], v[96:99], v[116:119], v[52:55]
    ds_read_b64_tr_b16 v[144:145], v14 offset:40960
    v_mfma_f32_16x16x32_bf16 v[56:59], v[100:103], v[112:115], v[56:59]
    ds_read_b64_tr_b16 v[146:147], v14 offset:41984
    ds_read_b64_tr_b16 v[148:149], v15 offset:40960
    v_mfma_f32_16x16x32_bf16 v[60:63], v[100:103], v[116:119], v[60:63]
    ds_read_b64_tr_b16 v[150:151], v15 offset:41984
    v_mfma_f32_16x16x32_bf16 v[64:67], v[104:107], v[112:115], v[64:67]
    v_mfma_f32_16x16x32_bf16 v[68:71], v[104:107], v[116:119], v[68:71]
    v_mfma_f32_16x16x32_bf16 v[72:75], v[108:111], v[112:115], v[72:75]
    v_mfma_f32_16x16x32_bf16 v[76:79], v[108:111], v[116:119], v[76:79]
    s_waitcnt lgkmcnt(0)
    s_waitcnt vmcnt(8)
    s_barrier
    v_mfma_f32_16x16x32_bf16 v[16:19], v[120:123], v[152:155], v[16:19]
    ds_read_b128 v[112:115], v232 offset:12288
    ds_read_b128 v[116:119], v232 offset:14336
    v_mfma_f32_16x16x32_bf16 v[20:23], v[120:123], v[156:159], v[20:23]
    ds_read_b64_tr_b16 v[80:81], v8 offset:49152
    v_mfma_f32_16x16x32_bf16 v[24:27], v[124:127], v[152:155], v[24:27]
    ds_read_b64_tr_b16 v[82:83], v8 offset:50176
    v_mfma_f32_16x16x32_bf16 v[28:31], v[124:127], v[156:159], v[28:31]
    ds_read_b64_tr_b16 v[84:85], v9 offset:49152
    v_mfma_f32_16x16x32_bf16 v[32:35], v[128:131], v[152:155], v[32:35]
    ds_read_b64_tr_b16 v[86:87], v9 offset:50176
    v_mfma_f32_16x16x32_bf16 v[36:39], v[128:131], v[156:159], v[36:39]
    ds_read_b64_tr_b16 v[88:89], v10 offset:49152
    v_mfma_f32_16x16x32_bf16 v[40:43], v[132:135], v[152:155], v[40:43]
    ds_read_b64_tr_b16 v[90:91], v10 offset:50176
    v_mfma_f32_16x16x32_bf16 v[44:47], v[132:135], v[156:159], v[44:47]
    ds_read_b64_tr_b16 v[92:93], v11 offset:49152
    v_mfma_f32_16x16x32_bf16 v[48:51], v[136:139], v[152:155], v[48:51]
    ds_read_b64_tr_b16 v[94:95], v11 offset:50176
    ds_read_b64_tr_b16 v[96:97], v12 offset:49152
    v_mfma_f32_16x16x32_bf16 v[52:55], v[136:139], v[156:159], v[52:55]
    ds_read_b64_tr_b16 v[98:99], v12 offset:50176
    v_mfma_f32_16x16x32_bf16 v[56:59], v[140:143], v[152:155], v[56:59]
    ds_read_b64_tr_b16 v[100:101], v13 offset:49152
    v_mfma_f32_16x16x32_bf16 v[60:63], v[140:143], v[156:159], v[60:63]
    ds_read_b64_tr_b16 v[102:103], v13 offset:50176
    v_mfma_f32_16x16x32_bf16 v[64:67], v[144:147], v[152:155], v[64:67]
    ds_read_b64_tr_b16 v[104:105], v14 offset:49152
    v_mfma_f32_16x16x32_bf16 v[68:71], v[144:147], v[156:159], v[68:71]
    s_waitcnt lgkmcnt(7)
    ds_read_b64_tr_b16 v[106:107], v14 offset:50176
    v_mfma_f32_16x16x32_bf16 v[72:75], v[148:151], v[152:155], v[72:75]
    ds_read_b64_tr_b16 v[108:109], v15 offset:49152
    v_mfma_f32_16x16x32_bf16 v[76:79], v[148:151], v[156:159], v[76:79]
    ds_read_b64_tr_b16 v[110:111], v15 offset:50176
    v_mfma_f32_16x16x32_bf16 v[16:19], v[80:83], v[112:115], v[16:19]
    ds_read_b128 v[152:155], v233 offset:12288
    ds_read_b128 v[156:159], v233 offset:14336
    v_mfma_f32_16x16x32_bf16 v[20:23], v[80:83], v[116:119], v[20:23]
    ds_read_b64_tr_b16 v[120:121], v8 offset:57344
    v_mfma_f32_16x16x32_bf16 v[24:27], v[84:87], v[112:115], v[24:27]
    ds_read_b64_tr_b16 v[122:123], v8 offset:58368
    ds_read_b64_tr_b16 v[124:125], v9 offset:57344
    v_mfma_f32_16x16x32_bf16 v[28:31], v[84:87], v[116:119], v[28:31]
    s_waitcnt lgkmcnt(7)
    ds_read_b64_tr_b16 v[126:127], v9 offset:58368
    v_mfma_f32_16x16x32_bf16 v[32:35], v[88:91], v[112:115], v[32:35]
    ds_read_b64_tr_b16 v[128:129], v10 offset:57344
    ds_read_b64_tr_b16 v[130:131], v10 offset:58368
    v_mfma_f32_16x16x32_bf16 v[36:39], v[88:91], v[116:119], v[36:39]
    ds_read_b64_tr_b16 v[132:133], v11 offset:57344
    v_mfma_f32_16x16x32_bf16 v[40:43], v[92:95], v[112:115], v[40:43]
    ds_read_b64_tr_b16 v[134:135], v11 offset:58368
    ds_read_b64_tr_b16 v[136:137], v12 offset:57344
    v_mfma_f32_16x16x32_bf16 v[44:47], v[92:95], v[116:119], v[44:47]
    ds_read_b64_tr_b16 v[138:139], v12 offset:58368
    v_mfma_f32_16x16x32_bf16 v[48:51], v[96:99], v[112:115], v[48:51]
    ds_read_b64_tr_b16 v[140:141], v13 offset:57344
    s_waitcnt lgkmcnt(7)
    ds_read_b64_tr_b16 v[142:143], v13 offset:58368
    v_mfma_f32_16x16x32_bf16 v[52:55], v[96:99], v[116:119], v[52:55]
    ds_read_b64_tr_b16 v[144:145], v14 offset:57344
    v_mfma_f32_16x16x32_bf16 v[56:59], v[100:103], v[112:115], v[56:59]
    ds_read_b64_tr_b16 v[146:147], v14 offset:58368
    ds_read_b64_tr_b16 v[148:149], v15 offset:57344
    v_mfma_f32_16x16x32_bf16 v[60:63], v[100:103], v[116:119], v[60:63]
    ds_read_b64_tr_b16 v[150:151], v15 offset:58368
    v_mfma_f32_16x16x32_bf16 v[64:67], v[104:107], v[112:115], v[64:67]
    v_mfma_f32_16x16x32_bf16 v[68:71], v[104:107], v[116:119], v[68:71]
    v_mfma_f32_16x16x32_bf16 v[72:75], v[108:111], v[112:115], v[72:75]
    v_mfma_f32_16x16x32_bf16 v[76:79], v[108:111], v[116:119], v[76:79]
    s_branch L_common
L_p1_1:
    s_waitcnt vmcnt(9)
    s_barrier
    ds_read_b128 v[112:115], v232 offset:0
    ds_read_b128 v[116:119], v232 offset:2048
    s_add_u32 m0, s78, 8192
    s_add_u32 s87, s92, 256
    buffer_load_dwordx4 v228, s[32:35], s87 offen offset:0 lds
    ds_read_b64_tr_b16 v[80:81], v8 offset:0
    buffer_load_dwordx4 v229, s[32:35], s87 offen offset:1024 lds
    ds_read_b64_tr_b16 v[82:83], v8 offset:1024
    buffer_load_dwordx4 v230, s[32:35], s87 offen offset:2048 lds
    ds_read_b64_tr_b16 v[84:85], v9 offset:0
    v_lshrrev_b32 v254, 4, v0
    v_bfe_u32 v255, v0, 2, 2
    v_xor_b32 v255, v255, v254
    ds_read_b64_tr_b16 v[86:87], v9 offset:1024
    v_lshlrev_b32 v255, 6, v255
    v_lshl_add_u32 v4, v254, 11, v255
    v_and_b32 v255, 3, v0
    ds_read_b64_tr_b16 v[88:89], v10 offset:0
    buffer_load_dwordx4 v231, s[32:35], s87 offen offset:3072 lds
    ds_read_b64_tr_b16 v[90:91], v10 offset:1024
    v_lshl_add_u32 v4, v255, 4, v4
    v_add_u32 v5, 31744, v4
    v_add_u32 v6, 6144, v4
    ds_read_b64_tr_b16 v[92:93], v11 offset:0
    s_add_u32 m0, s81, 32768
    s_add_u32 s87, s88, 1048576
    buffer_load_dwordx4 v224, s[44:47], s87 offen offset:0 lds
    ds_read_b64_tr_b16 v[94:95], v11 offset:1024
    ds_read_b64_tr_b16 v[96:97], v12 offset:0
    v_add_u32 v7, 37888, v4
    v_bfe_u32 v251, v0, 2, 2
    v_lshrrev_b32 v254, 5, v0
    ds_read_b64_tr_b16 v[98:99], v12 offset:1024
    v_lshl_add_u32 v254, v254, 3, v251
    v_lshlrev_b32 v250, 8, v254
    v_bfe_u32 v254, v0, 4, 1
    ds_read_b64_tr_b16 v[100:101], v13 offset:0
    buffer_load_dwordx4 v225, s[44:47], s87 offen offset:1024 lds
    ds_read_b64_tr_b16 v[102:103], v13 offset:1024
    v_lshl_add_u32 v250, v254, 5, v250
    v_and_b32 v254, 1, v0
    v_lshl_add_u32 v250, v254, 4, v250
    ds_read_b64_tr_b16 v[104:105], v14 offset:0
    v_bfe_u32 v254, v0, 1, 1
    v_lshl_add_u32 v250, v254, 3, v250
    s_add_u32 s100, s64, 0
    s_waitcnt lgkmcnt(7)
    ds_read_b64_tr_b16 v[106:107], v14 offset:1024
    buffer_load_dwordx4 v226, s[44:47], s87 offen offset:2048 lds
    ds_read_b64_tr_b16 v[108:109], v15 offset:0
    s_and_b32 s100, s100, 3
    v_xor_b32 v254, s100, v251
    v_lshl_add_u32 v244, v254, 6, v250
    ds_read_b64_tr_b16 v[110:111], v15 offset:1024
    buffer_load_dwordx4 v227, s[44:47], s87 offen offset:3072 lds
    v_mfma_f32_16x16x32_bf16 v[16:19], v[80:83], v[112:115], 0
    ds_read_b128 v[152:155], v233 offset:0
    ds_read_b128 v[156:159], v233 offset:2048
    s_add_u32 s100, s64, 1
    v_mfma_f32_16x16x32_bf16 v[20:23], v[80:83], v[116:119], 0
    ds_read_b64_tr_b16 v[120:121], v8 offset:8192
    s_and_b32 s100, s100, 3
    v_mfma_f32_16x16x32_bf16 v[24:27], v[84:87], v[112:115], 0
    ds_read_b64_tr_b16 v[122:123], v8 offset:9216
    ds_read_b64_tr_b16 v[124:125], v9 offset:8192
    s_add_u32 m0, s78, 12288
    s_add_u32 s87, s92, 640
    buffer_load_dwordx4 v228, s[32:35], s87 offen offset:0 lds
    v_mfma_f32_16x16x32_bf16 v[28:31], v[84:87], v[116:119], 0
    s_waitcnt lgkmcnt(7)
    ds_read_b64_tr_b16 v[126:127], v9 offset:9216
    v_xor_b32 v254, s100, v251
    v_mfma_f32_16x16x32_bf16 v[32:35], v[88:91], v[112:115], 0
    ds_read_b64_tr_b16 v[128:129], v10 offset:8192
    ds_read_b64_tr_b16 v[130:131], v10 offset:9216
    v_lshl_add_u32 v245, v254, 6, v250
    v_mfma_f32_16x16x32_bf16 v[36:39], v[88:91], v[116:119], 0
    ds_read_b64_tr_b16 v[132:133], v11 offset:8192
    buffer_load_dwordx4 v229, s[32:35], s87 offen offset:1024 lds
    v_mfma_f32_16x16x32_bf16 v[40:43], v[92:95], v[112:115], 0
    ds_read_b64_tr_b16 v[134:135], v11 offset:9216
    ds_read_b64_tr_b16 v[136:137], v12 offset:8192
    s_add_u32 s100, s64, 2
    v_mfma_f32_16x16x32_bf16 v[44:47], v[92:95], v[116:119], 0
    ds_read_b64_tr_b16 v[138:139], v12 offset:9216
    buffer_load_dwordx4 v230, s[32:35], s87 offen offset:2048 lds
    v_mfma_f32_16x16x32_bf16 v[48:51], v[96:99], v[112:115], 0
    ds_read_b64_tr_b16 v[140:141], v13 offset:8192
    s_waitcnt lgkmcnt(7)
    ds_read_b64_tr_b16 v[142:143], v13 offset:9216
    s_and_b32 s100, s100, 3
    v_mfma_f32_16x16x32_bf16 v[52:55], v[96:99], v[116:119], 0
    ds_read_b64_tr_b16 v[144:145], v14 offset:8192
    v_xor_b32 v254, s100, v251
    v_mfma_f32_16x16x32_bf16 v[56:59], v[100:103], v[112:115], 0
    ds_read_b64_tr_b16 v[146:147], v14 offset:9216
    ds_read_b64_tr_b16 v[148:149], v15 offset:8192
    buffer_load_dwordx4 v231, s[32:35], s87 offen offset:3072 lds
    v_mfma_f32_16x16x32_bf16 v[60:63], v[100:103], v[116:119], 0
    ds_read_b64_tr_b16 v[150:151], v15 offset:9216
    v_lshl_add_u32 v246, v254, 6, v250
    v_mfma_f32_16x16x32_bf16 v[64:67], v[104:107], v[112:115], 0
    s_add_u32 s100, s64, 3
    v_mfma_f32_16x16x32_bf16 v[68:71], v[104:107], v[116:119], 0
    s_add_u32 m0, s81, 49152
    s_add_u32 s87, s88, 2621440
    buffer_load_dwordx4 v224, s[44:47], s87 offen offset:0 lds
    v_mfma_f32_16x16x32_bf16 v[72:75], v[108:111], v[112:115], 0
    s_and_b32 s100, s100, 3
    v_mfma_f32_16x16x32_bf16 v[76:79], v[108:111], v[116:119], 0
    buffer_load_dwordx4 v225, s[44:47], s87 offen offset:1024 lds
    s_waitcnt lgkmcnt(0)
    s_waitcnt vmcnt(15)
    s_barrier
    v_mfma_f32_16x16x32_bf16 v[16:19], v[120:123], v[152:155], v[16:19]
    ds_read_b128 v[112:115], v232 offset:4096
    ds_read_b128 v[116:119], v232 offset:6144
    v_xor_b32 v254, s100, v251
    v_mfma_f32_16x16x32_bf16 v[20:23], v[120:123], v[156:159], v[20:23]
    ds_read_b64_tr_b16 v[80:81], v8 offset:16384
    v_lshl_add_u32 v247, v254, 6, v250
    v_mfma_f32_16x16x32_bf16 v[24:27], v[124:127], v[152:155], v[24:27]
    ds_read_b64_tr_b16 v[82:83], v8 offset:17408
    buffer_load_dwordx4 v226, s[44:47], s87 offen offset:2048 lds
    v_mfma_f32_16x16x32_bf16 v[28:31], v[124:127], v[156:159], v[28:31]
    ds_read_b64_tr_b16 v[84:85], v9 offset:16384
    v_and_b32 v254, 3, v0
    v_mfma_f32_16x16x32_bf16 v[32:35], v[128:131], v[152:155], v[32:35]
    ds_read_b64_tr_b16 v[86:87], v9 offset:17408
    v_lshl_add_u32 v254, v251, 3, v254
    v_mfma_f32_16x16x32_bf16 v[36:39], v[128:131], v[156:159], v[36:39]
    ds_read_b64_tr_b16 v[88:89], v10 offset:16384
    buffer_load_dwordx4 v227, s[44:47], s87 offen offset:3072 lds
    v_mfma_f32_16x16x32_bf16 v[40:43], v[132:135], v[152:155], v[40:43]
    ds_read_b64_tr_b16 v[90:91], v10 offset:17408
    v_and_b32 v255, 15, v254
    v_mfma_f32_16x16x32_bf16 v[44:47], v[132:135], v[156:159], v[44:47]
    ds_read_b64_tr_b16 v[92:93], v11 offset:16384
    s_add_u32 m0, s82, 131072
    s_add_u32 s87, s80, 0
    v_xor_b32 v240, 0, v2
    buffer_load_dwordx4 v240, s[36:39], s87 offen offset:0 nt lds
    v_mfma_f32_16x16x32_bf16 v[48:51], v[136:139], v[152:155], v[48:51]
    ds_read_b64_tr_b16 v[94:95], v11 offset:17408
    ds_read_b64_tr_b16 v[96:97], v12 offset:16384
    v_lshrrev_b32 v248, 5, v0
    v_mfma_f32_16x16x32_bf16 v[52:55], v[136:139], v[156:159], v[52:55]
    ds_read_b64_tr_b16 v[98:99], v12 offset:17408
    v_xor_b32 v255, v255, v248
    v_mfma_f32_16x16x32_bf16 v[56:59], v[140:143], v[152:155], v[56:59]
    ds_read_b64_tr_b16 v[100:101], v13 offset:16384
    v_xor_b32 v240, 64, v2
    buffer_load_dwordx4 v240, s[36:39], s87 offen offset:1024 nt lds
    v_mfma_f32_16x16x32_bf16 v[60:63], v[140:143], v[156:159], v[60:63]
    ds_read_b64_tr_b16 v[102:103], v13 offset:17408
    v_lshlrev_b32 v255, 4, v255
    v_mfma_f32_16x16x32_bf16 v[64:67], v[144:147], v[152:155], v[64:67]
    ds_read_b64_tr_b16 v[104:105], v14 offset:16384
    v_lshl_add_u32 v254, v254, 8, v255
    v_mfma_f32_16x16x32_bf16 v[68:71], v[144:147], v[156:159], v[68:71]
    s_waitcnt lgkmcnt(7)
    ds_read_b64_tr_b16 v[106:107], v14 offset:17408
    v_xor_b32 v240, 128, v2
    buffer_load_dwordx4 v240, s[36:39], s87 offen offset:2048 nt lds
    v_mfma_f32_16x16x32_bf16 v[72:75], v[148:151], v[152:155], v[72:75]
    ds_read_b64_tr_b16 v[108:109], v15 offset:16384
    v_bfe_u32 v255, v0, 4, 1
    v_mfma_f32_16x16x32_bf16 v[76:79], v[148:151], v[156:159], v[76:79]
    ds_read_b64_tr_b16 v[110:111], v15 offset:17408
    v_xor_b32 v240, 192, v2
    buffer_load_dwordx4 v240, s[36:39], s87 offen offset:3072 nt lds
    v_mfma_f32_16x16x32_bf16 v[16:19], v[80:83], v[112:115], v[16:19]
    ds_read_b128 v[152:155], v233 offset:4096
    ds_read_b128 v[156:159], v233 offset:6144
    v_lshl_add_u32 v254, v255, 3, v254
    v_mfma_f32_16x16x32_bf16 v[20:23], v[80:83], v[116:119], v[20:23]
    ds_read_b64_tr_b16 v[120:121], v8 offset:24576
    s_add_u32 s100, s82, 131072
    v_mfma_f32_16x16x32_bf16 v[24:27], v[84:87], v[112:115], v[24:27]
    ds_read_b64_tr_b16 v[122:123], v8 offset:25600
    ds_read_b64_tr_b16 v[124:125], v9 offset:24576
    s_add_u32 m0, s82, 135168
    s_add_u32 s87, s80, 4096
    v_xor_b32 v240, 0, v2
    buffer_load_dwordx4 v240, s[36:39], s87 offen offset:0 nt lds
    v_mfma_f32_16x16x32_bf16 v[28:31], v[84:87], v[116:119], v[28:31]
    s_waitcnt lgkmcnt(7)
    ds_read_b64_tr_b16 v[126:127], v9 offset:25600
    v_add_u32 v248, s100, v254
    v_mfma_f32_16x16x32_bf16 v[32:35], v[88:91], v[112:115], v[32:35]
    ds_read_b64_tr_b16 v[128:129], v10 offset:24576
    ds_read_b64_tr_b16 v[130:131], v10 offset:25600
    v_lshlrev_b32 v249, 4, v0
    v_mfma_f32_16x16x32_bf16 v[36:39], v[88:91], v[116:119], v[36:39]
    ds_read_b64_tr_b16 v[132:133], v11 offset:24576
    v_xor_b32 v240, 64, v2
    buffer_load_dwordx4 v240, s[36:39], s87 offen offset:1024 nt lds
    v_mfma_f32_16x16x32_bf16 v[40:43], v[92:95], v[112:115], v[40:43]
    ds_read_b64_tr_b16 v[134:135], v11 offset:25600
    ds_read_b64_tr_b16 v[136:137], v12 offset:24576
    v_mov_b32 v241, 0
    v_mfma_f32_16x16x32_bf16 v[44:47], v[92:95], v[116:119], v[44:47]
    ds_read_b64_tr_b16 v[138:139], v12 offset:25600
    v_xor_b32 v240, 128, v2
    buffer_load_dwordx4 v240, s[36:39], s87 offen offset:2048 nt lds
    v_mfma_f32_16x16x32_bf16 v[48:51], v[96:99], v[112:115], v[48:51]
    ds_read_b64_tr_b16 v[140:141], v13 offset:24576
    s_waitcnt lgkmcnt(7)
    ds_read_b64_tr_b16 v[142:143], v13 offset:25600
    s_lshl_b32 s98, s66, 2
    v_mfma_f32_16x16x32_bf16 v[52:55], v[96:99], v[116:119], v[52:55]
    ds_read_b64_tr_b16 v[144:145], v14 offset:24576
    s_add_u32 s98, s98, s64
    v_mfma_f32_16x16x32_bf16 v[56:59], v[100:103], v[112:115], v[56:59]
    ds_read_b64_tr_b16 v[146:147], v14 offset:25600
    ds_read_b64_tr_b16 v[148:149], v15 offset:24576
    v_xor_b32 v240, 192, v2
    buffer_load_dwordx4 v240, s[36:39], s87 offen offset:3072 nt lds
    v_mfma_f32_16x16x32_bf16 v[60:63], v[100:103], v[116:119], v[60:63]
    ds_read_b64_tr_b16 v[150:151], v15 offset:25600
    s_lshl_b32 s99, s98, 19
    v_mfma_f32_16x16x32_bf16 v[64:67], v[104:107], v[112:115], v[64:67]
    s_add_u32 s83, s67, 1
    v_mfma_f32_16x16x32_bf16 v[68:71], v[104:107], v[116:119], v[68:71]
    s_add_u32 m0, s78, 0
    s_add_u32 s87, s92, 384
    buffer_load_dwordx4 v228, s[32:35], s87 offen offset:0 lds
    v_mfma_f32_16x16x32_bf16 v[72:75], v[108:111], v[112:115], v[72:75]
    s_and_b32 s83, s83, 7
    v_mfma_f32_16x16x32_bf16 v[76:79], v[108:111], v[116:119], v[76:79]
    buffer_load_dwordx4 v229, s[32:35], s87 offen offset:1024 lds
    s_waitcnt lgkmcnt(0)
    s_waitcnt vmcnt(18)
    s_barrier
    v_mfma_f32_16x16x32_bf16 v[16:19], v[120:123], v[152:155], v[16:19]
    ds_read_b128 v[112:115], v232 offset:8192
    ds_read_b128 v[116:119], v232 offset:10240
    s_lshl_b32 s100, s83, 8
    v_mfma_f32_16x16x32_bf16 v[20:23], v[120:123], v[156:159], v[20:23]
    ds_read_b64_tr_b16 v[80:81], v8 offset:32768
    s_add_u32 s99, s99, s100
    v_mfma_f32_16x16x32_bf16 v[24:27], v[124:127], v[152:155], v[24:27]
    ds_read_b64_tr_b16 v[82:83], v8 offset:33792
    buffer_load_dwordx4 v230, s[32:35], s87 offen offset:2048 lds
    v_mfma_f32_16x16x32_bf16 v[28:31], v[124:127], v[156:159], v[28:31]
    ds_read_b64_tr_b16 v[84:85], v9 offset:32768
    s_add_u32 s100, s79, 0
    v_mfma_f32_16x16x32_bf16 v[32:35], v[128:131], v[152:155], v[32:35]
    ds_read_b64_tr_b16 v[86:87], v9 offset:33792
    s_and_b32 s100, s100, 3
    v_mfma_f32_16x16x32_bf16 v[36:39], v[128:131], v[156:159], v[36:39]
    ds_read_b64_tr_b16 v[88:89], v10 offset:32768
    buffer_load_dwordx4 v231, s[32:35], s87 offen offset:3072 lds
    v_mfma_f32_16x16x32_bf16 v[40:43], v[132:135], v[152:155], v[40:43]
    ds_read_b64_tr_b16 v[90:91], v10 offset:33792
    s_lshl_b32 s101, s100, 17
    v_mfma_f32_16x16x32_bf16 v[44:47], v[132:135], v[156:159], v[44:47]
    ds_read_b64_tr_b16 v[92:93], v11 offset:32768
    s_add_u32 m0, s81, 0
    s_add_u32 s87, s88, 1572864
    buffer_load_dwordx4 v224, s[44:47], s87 offen offset:0 lds
    v_mfma_f32_16x16x32_bf16 v[48:51], v[136:139], v[152:155], v[48:51]
    ds_read_b64_tr_b16 v[94:95], v11 offset:33792
    ds_read_b64_tr_b16 v[96:97], v12 offset:32768
    s_add_u32 s4, s99, s101
    v_mfma_f32_16x16x32_bf16 v[52:55], v[136:139], v[156:159], v[52:55]
    ds_read_b64_tr_b16 v[98:99], v12 offset:33792
    s_lshl_b32 s8, s100, 12
    v_mfma_f32_16x16x32_bf16 v[56:59], v[140:143], v[152:155], v[56:59]
    ds_read_b64_tr_b16 v[100:101], v13 offset:32768
    buffer_load_dwordx4 v225, s[44:47], s87 offen offset:1024 lds
    v_mfma_f32_16x16x32_bf16 v[60:63], v[140:143], v[156:159], v[60:63]
    ds_read_b64_tr_b16 v[102:103], v13 offset:33792
    s_add_u32 s12, s66, 1
    v_mfma_f32_16x16x32_bf16 v[64:67], v[144:147], v[152:155], v[64:67]
    ds_read_b64_tr_b16 v[104:105], v14 offset:32768
    s_and_b32 s12, s12, 3
    v_mfma_f32_16x16x32_bf16 v[68:71], v[144:147], v[156:159], v[68:71]
    s_waitcnt lgkmcnt(7)
    ds_read_b64_tr_b16 v[106:107], v14 offset:33792
    buffer_load_dwordx4 v226, s[44:47], s87 offen offset:2048 lds
    v_mfma_f32_16x16x32_bf16 v[72:75], v[148:151], v[152:155], v[72:75]
    ds_read_b64_tr_b16 v[108:109], v15 offset:32768
    s_add_u32 s100, s79, 1
    v_mfma_f32_16x16x32_bf16 v[76:79], v[148:151], v[156:159], v[76:79]
    ds_read_b64_tr_b16 v[110:111], v15 offset:33792
    buffer_load_dwordx4 v227, s[44:47], s87 offen offset:3072 lds
    v_mfma_f32_16x16x32_bf16 v[16:19], v[80:83], v[112:115], v[16:19]
    ds_read_b128 v[152:155], v233 offset:8192
    ds_read_b128 v[156:159], v233 offset:10240
    s_and_b32 s100, s100, 3
    v_mfma_f32_16x16x32_bf16 v[20:23], v[80:83], v[116:119], v[20:23]
    ds_read_b64_tr_b16 v[120:121], v8 offset:40960
    s_lshl_b32 s101, s100, 17
    v_mfma_f32_16x16x32_bf16 v[24:27], v[84:87], v[112:115], v[24:27]
    ds_read_b64_tr_b16 v[122:123], v8 offset:41984
    ds_read_b64_tr_b16 v[124:125], v9 offset:40960
    s_add_u32 m0, s78, 4096
    s_add_u32 s87, s92, 512
    buffer_load_dwordx4 v228, s[32:35], s87 offen offset:0 lds
    v_mfma_f32_16x16x32_bf16 v[28:31], v[84:87], v[116:119], v[28:31]
    s_waitcnt lgkmcnt(7)
    ds_read_b64_tr_b16 v[126:127], v9 offset:41984
    s_add_u32 s5, s99, s101
    v_mfma_f32_16x16x32_bf16 v[32:35], v[88:91], v[112:115], v[32:35]
    ds_read_b64_tr_b16 v[128:129], v10 offset:40960
    ds_read_b64_tr_b16 v[130:131], v10 offset:41984
    s_lshl_b32 s9, s100, 12
    v_mfma_f32_16x16x32_bf16 v[36:39], v[88:91], v[116:119], v[36:39]
    ds_read_b64_tr_b16 v[132:133], v11 offset:40960
    buffer_load_dwordx4 v229, s[32:35], s87 offen offset:1024 lds
    v_mfma_f32_16x16x32_bf16 v[40:43], v[92:95], v[112:115], v[40:43]
    ds_read_b64_tr_b16 v[134:135], v11 offset:41984
    ds_read_b64_tr_b16 v[136:137], v12 offset:40960
    s_add_u32 s13, s66, 2
    v_mfma_f32_16x16x32_bf16 v[44:47], v[92:95], v[116:119], v[44:47]
    ds_read_b64_tr_b16 v[138:139], v12 offset:41984
    s_and_b32 s13, s13, 3
    v_mfma_f32_16x16x32_bf16 v[48:51], v[96:99], v[112:115], v[48:51]
    ds_read_b64_tr_b16 v[140:141], v13 offset:40960
    s_waitcnt lgkmcnt(7)
    ds_read_b64_tr_b16 v[142:143], v13 offset:41984
    buffer_load_dwordx4 v230, s[32:35], s87 offen offset:2048 lds
    v_mfma_f32_16x16x32_bf16 v[52:55], v[96:99], v[116:119], v[52:55]
    ds_read_b64_tr_b16 v[144:145], v14 offset:40960
    s_add_u32 s100, s79, 2
    v_mfma_f32_16x16x32_bf16 v[56:59], v[100:103], v[112:115], v[56:59]
    ds_read_b64_tr_b16 v[146:147], v14 offset:41984
    ds_read_b64_tr_b16 v[148:149], v15 offset:40960
    buffer_load_dwordx4 v231, s[32:35], s87 offen offset:3072 lds
    v_mfma_f32_16x16x32_bf16 v[60:63], v[100:103], v[116:119], v[60:63]
    ds_read_b64_tr_b16 v[150:151], v15 offset:41984
    s_and_b32 s100, s100, 3
    v_mfma_f32_16x16x32_bf16 v[64:67], v[104:107], v[112:115], v[64:67]
    s_lshl_b32 s101, s100, 17
    v_mfma_f32_16x16x32_bf16 v[68:71], v[104:107], v[116:119], v[68:71]
    s_add_u32 m0, s81, 16384
    s_add_u32 s87, s88, 2097152
    buffer_load_dwordx4 v224, s[44:47], s87 offen offset:0 lds
    v_mfma_f32_16x16x32_bf16 v[72:75], v[108:111], v[112:115], v[72:75]
    s_add_u32 s6, s99, s101
    v_mfma_f32_16x16x32_bf16 v[76:79], v[108:111], v[116:119], v[76:79]
    s_lshl_b32 s10, s100, 12
    s_waitcnt lgkmcnt(0)
    s_waitcnt vmcnt(21)
    s_barrier
    v_mfma_f32_16x16x32_bf16 v[16:19], v[120:123], v[152:155], v[16:19]
    ds_read_b128 v[112:115], v232 offset:12288
    ds_read_b128 v[116:119], v232 offset:14336
    buffer_load_dwordx4 v225, s[44:47], s87 offen offset:1024 lds
    v_mfma_f32_16x16x32_bf16 v[20:23], v[120:123], v[156:159], v[20:23]
    ds_read_b64_tr_b16 v[80:81], v8 offset:49152
    s_add_u32 s14, s66, 3
    v_mfma_f32_16x16x32_bf16 v[24:27], v[124:127], v[152:155], v[24:27]
    ds_read_b64_tr_b16 v[82:83], v8 offset:50176
    buffer_load_dwordx4 v226, s[44:47], s87 offen offset:2048 lds
    v_mfma_f32_16x16x32_bf16 v[28:31], v[124:127], v[156:159], v[28:31]
    ds_read_b64_tr_b16 v[84:85], v9 offset:49152
    s_and_b32 s14, s14, 3
    v_mfma_f32_16x16x32_bf16 v[32:35], v[128:131], v[152:155], v[32:35]
    ds_read_b64_tr_b16 v[86:87], v9 offset:50176
    s_add_u32 s100, s79, 3
    v_mfma_f32_16x16x32_bf16 v[36:39], v[128:131], v[156:159], v[36:39]
    ds_read_b64_tr_b16 v[88:89], v10 offset:49152
    buffer_load_dwordx4 v227, s[44:47], s87 offen offset:3072 lds
    v_mfma_f32_16x16x32_bf16 v[40:43], v[132:135], v[152:155], v[40:43]
    ds_read_b64_tr_b16 v[90:91], v10 offset:50176
    s_and_b32 s100, s100, 3
    v_mfma_f32_16x16x32_bf16 v[44:47], v[132:135], v[156:159], v[44:47]
    ds_read_b64_tr_b16 v[92:93], v11 offset:49152
    s_lshl_b32 s101, s100, 17
    v_mfma_f32_16x16x32_bf16 v[48:51], v[136:139], v[152:155], v[48:51]
    ds_read_b64_tr_b16 v[94:95], v11 offset:50176
    ds_read_b64_tr_b16 v[96:97], v12 offset:49152
    s_add_u32 m0, s78, 8192
    s_add_u32 s87, s92, 768
    buffer_load_dwordx4 v228, s[32:35], s87 offen offset:0 lds
    v_mfma_f32_16x16x32_bf16 v[52:55], v[136:139], v[156:159], v[52:55]
    ds_read_b64_tr_b16 v[98:99], v12 offset:50176
    s_add_u32 s7, s99, s101
    v_mfma_f32_16x16x32_bf16 v[56:59], v[140:143], v[152:155], v[56:59]
    ds_read_b64_tr_b16 v[100:101], v13 offset:49152
    buffer_load_dwordx4 v229, s[32:35], s87 offen offset:1024 lds
    v_mfma_f32_16x16x32_bf16 v[60:63], v[140:143], v[156:159], v[60:63]
    ds_read_b64_tr_b16 v[102:103], v13 offset:50176
    s_lshl_b32 s11, s100, 12
    v_mfma_f32_16x16x32_bf16 v[64:67], v[144:147], v[152:155], v[64:67]
    ds_read_b64_tr_b16 v[104:105], v14 offset:49152
    s_add_u32 s15, s66, 4
    v_mfma_f32_16x16x32_bf16 v[68:71], v[144:147], v[156:159], v[68:71]
    s_waitcnt lgkmcnt(7)
    ds_read_b64_tr_b16 v[106:107], v14 offset:50176
    buffer_load_dwordx4 v230, s[32:35], s87 offen offset:2048 lds
    v_mfma_f32_16x16x32_bf16 v[72:75], v[148:151], v[152:155], v[72:75]
    ds_read_b64_tr_b16 v[108:109], v15 offset:49152
    s_and_b32 s15, s15, 3
    v_mfma_f32_16x16x32_bf16 v[76:79], v[148:151], v[156:159], v[76:79]
    ds_read_b64_tr_b16 v[110:111], v15 offset:50176
    s_lshl_b32 s99, s65, 2
    v_mfma_f32_16x16x32_bf16 v[16:19], v[80:83], v[112:115], v[16:19]
    ds_read_b128 v[152:155], v233 offset:12288
    ds_read_b128 v[156:159], v233 offset:14336
    buffer_load_dwordx4 v231, s[32:35], s87 offen offset:3072 lds
    v_mfma_f32_16x16x32_bf16 v[20:23], v[80:83], v[116:119], v[20:23]
    ds_read_b64_tr_b16 v[120:121], v8 offset:57344
    s_add_u32 s99, s99, s68
    v_mfma_f32_16x16x32_bf16 v[24:27], v[84:87], v[112:115], v[24:27]
    ds_read_b64_tr_b16 v[122:123], v8 offset:58368
    ds_read_b64_tr_b16 v[124:125], v9 offset:57344
    s_add_u32 m0, s81, 32768
    s_add_u32 s87, s88, 3145728
    buffer_load_dwordx4 v224, s[44:47], s87 offen offset:0 lds
    v_mfma_f32_16x16x32_bf16 v[28:31], v[84:87], v[116:119], v[28:31]
    s_waitcnt lgkmcnt(7)
    ds_read_b64_tr_b16 v[126:127], v9 offset:58368
    s_lshl_b32 s99, s99, 21
    v_mfma_f32_16x16x32_bf16 v[32:35], v[88:91], v[112:115], v[32:35]
    ds_read_b64_tr_b16 v[128:129], v10 offset:57344
    ds_read_b64_tr_b16 v[130:131], v10 offset:58368
    s_lshl_b32 s100, s98, 14
    v_mfma_f32_16x16x32_bf16 v[36:39], v[88:91], v[116:119], v[36:39]
    ds_read_b64_tr_b16 v[132:133], v11 offset:57344
    buffer_load_dwordx4 v225, s[44:47], s87 offen offset:1024 lds
    v_mfma_f32_16x16x32_bf16 v[40:43], v[92:95], v[112:115], v[40:43]
    ds_read_b64_tr_b16 v[134:135], v11 offset:58368
    ds_read_b64_tr_b16 v[136:137], v12 offset:57344
    s_add_u32 s16, s99, s100
    v_mfma_f32_16x16x32_bf16 v[44:47], v[92:95], v[116:119], v[44:47]
    ds_read_b64_tr_b16 v[138:139], v12 offset:58368
    s_and_b32 s100, s80, 0xfffff
    v_mfma_f32_16x16x32_bf16 v[48:51], v[96:99], v[112:115], v[48:51]
    ds_read_b64_tr_b16 v[140:141], v13 offset:57344
    s_waitcnt lgkmcnt(7)
    ds_read_b64_tr_b16 v[142:143], v13 offset:58368
    buffer_load_dwordx4 v226, s[44:47], s87 offen offset:2048 lds
    v_mfma_f32_16x16x32_bf16 v[52:55], v[96:99], v[116:119], v[52:55]
    ds_read_b64_tr_b16 v[144:145], v14 offset:57344
    s_add_u32 s22, s99, s100
    v_mfma_f32_16x16x32_bf16 v[56:59], v[100:103], v[112:115], v[56:59]
    ds_read_b64_tr_b16 v[146:147], v14 offset:58368
    ds_read_b64_tr_b16 v[148:149], v15 offset:57344
    buffer_load_dwordx4 v227, s[44:47], s87 offen offset:3072 lds
    v_mfma_f32_16x16x32_bf16 v[60:63], v[100:103], v[116:119], v[60:63]
    ds_read_b64_tr_b16 v[150:151], v15 offset:58368
    s_add_u32 s23, s22, 4096
    v_mfma_f32_16x16x32_bf16 v[64:67], v[104:107], v[112:115], v[64:67]
    s_add_u32 s99, s99, 1048576
    v_mfma_f32_16x16x32_bf16 v[68:71], v[104:107], v[116:119], v[68:71]
    s_mul_i32 s100, s66, 40960
    v_mfma_f32_16x16x32_bf16 v[72:75], v[108:111], v[112:115], v[72:75]
    s_add_u32 s100, s100, s99
    v_mfma_f32_16x16x32_bf16 v[76:79], v[108:111], v[116:119], v[76:79]
    s_lshl_b32 s101, s64, 10
    s_waitcnt lgkmcnt(0)
    s_waitcnt vmcnt(16)
    s_barrier
    v_mfma_f32_16x16x32_bf16 v[16:19], v[120:123], v[152:155], v[16:19]
    ds_read_b128 v[112:115], v232 offset:0
    ds_read_b128 v[116:119], v232 offset:2048
    s_add_u32 m0, s78, 12288
    s_add_u32 s87, s93, 128
    buffer_load_dwordx4 v228, s[32:35], s87 offen offset:0 lds
    v_mfma_f32_16x16x32_bf16 v[20:23], v[120:123], v[156:159], v[20:23]
    ds_read_b64_tr_b16 v[80:81], v8 offset:0
    buffer_load_dwordx4 v229, s[32:35], s87 offen offset:1024 lds
    v_xor_b32 v253, 0, v248
    ds_read_b64 v[160:161], v253 offset:0
    v_mfma_f32_16x16x32_bf16 v[24:27], v[124:127], v[152:155], v[24:27]
    ds_read_b64_tr_b16 v[82:83], v8 offset:1024
    buffer_load_dwordx4 v230, s[32:35], s87 offen offset:2048 lds
    v_mfma_f32_16x16x32_bf16 v[28:31], v[124:127], v[156:159], v[28:31]
    ds_read_b64_tr_b16 v[84:85], v9 offset:0
    v_xor_b32 v253, 32, v248
    ds_read_b64 v[162:163], v253 offset:0
    v_mfma_f32_16x16x32_bf16 v[32:35], v[128:131], v[152:155], v[32:35]
    ds_read_b64_tr_b16 v[86:87], v9 offset:1024
    v_xor_b32 v253, 64, v248
    ds_read_b64 v[164:165], v253 offset:0
    v_mfma_f32_16x16x32_bf16 v[36:39], v[128:131], v[156:159], v[36:39]
    ds_read_b64_tr_b16 v[88:89], v10 offset:0
    buffer_load_dwordx4 v231, s[32:35], s87 offen offset:3072 lds
    v_mfma_f32_16x16x32_bf16 v[40:43], v[132:135], v[152:155], v[40:43]
    ds_read_b64_tr_b16 v[90:91], v10 offset:1024
    v_xor_b32 v253, 96, v248
    ds_read_b64 v[166:167], v253 offset:0
    v_mfma_f32_16x16x32_bf16 v[44:47], v[132:135], v[156:159], v[44:47]
    ds_read_b64_tr_b16 v[92:93], v11 offset:0
    s_add_u32 s19, s100, s101
    v_mfma_f32_16x16x32_bf16 v[48:51], v[136:139], v[152:155], v[48:51]
    ds_read_b64_tr_b16 v[94:95], v11 offset:1024
    ds_read_b64_tr_b16 v[96:97], v12 offset:0
    s_add_u32 m0, s81, 49152
    s_add_u32 s87, s89, 524288
    buffer_load_dwordx4 v224, s[44:47], s87 offen offset:0 lds
    v_xor_b32 v253, 128, v248
    s_waitcnt lgkmcnt(7)
    ds_read_b64 v[168:169], v253 offset:0
    v_mfma_f32_16x16x32_bf16 v[52:55], v[136:139], v[156:159], v[52:55]
    ds_read_b64_tr_b16 v[98:99], v12 offset:1024
    v_xor_b32 v253, 160, v248
    ds_read_b64 v[170:171], v253 offset:0
    v_mfma_f32_16x16x32_bf16 v[56:59], v[140:143], v[152:155], v[56:59]
    ds_read_b64_tr_b16 v[100:101], v13 offset:0
    buffer_load_dwordx4 v225, s[44:47], s87 offen offset:1024 lds
    v_mfma_f32_16x16x32_bf16 v[60:63], v[140:143], v[156:159], v[60:63]
    ds_read_b64_tr_b16 v[102:103], v13 offset:1024
    v_xor_b32 v253, 192, v248
    ds_read_b64 v[172:173], v253 offset:0
    v_mfma_f32_16x16x32_bf16 v[64:67], v[144:147], v[152:155], v[64:67]
    ds_read_b64_tr_b16 v[104:105], v14 offset:0
    v_xor_b32 v253, 224, v248
    ds_read_b64 v[174:175], v253 offset:0
    v_mfma_f32_16x16x32_bf16 v[68:71], v[144:147], v[156:159], v[68:71]
    s_waitcnt lgkmcnt(7)
    ds_read_b64_tr_b16 v[106:107], v14 offset:1024
    buffer_load_dwordx4 v226, s[44:47], s87 offen offset:2048 lds
    v_mfma_f32_16x16x32_bf16 v[72:75], v[148:151], v[152:155], v[72:75]
    ds_read_b64_tr_b16 v[108:109], v15 offset:0
    v_xor_b32 v253, 64, v248
    ds_read_b64 v[176:177], v253 offset:1024
    v_mfma_f32_16x16x32_bf16 v[76:79], v[148:151], v[156:159], v[76:79]
    ds_read_b64_tr_b16 v[110:111], v15 offset:1024
    s_lshl_b32 s101, s67, 2
    v_mfma_f32_16x16x32_bf16 v[16:19], v[80:83], v[112:115], v[16:19]
    ds_read_b128 v[152:155], v233 offset:0
    ds_read_b128 v[156:159], v233 offset:2048
    buffer_load_dwordx4 v227, s[44:47], s87 offen offset:3072 lds
    v_xor_b32 v253, 96, v248
    ds_read_b64 v[178:179], v253 offset:1024
    v_mfma_f32_16x16x32_bf16 v[20:23], v[80:83], v[116:119], v[20:23]
    ds_read_b64_tr_b16 v[120:121], v8 offset:8192
    v_xor_b32 v253, 0, v248
    s_waitcnt lgkmcnt(7)
    ds_read_b64 v[180:181], v253 offset:1024
    v_mfma_f32_16x16x32_bf16 v[24:27], v[84:87], v[112:115], v[24:27]
    ds_read_b64_tr_b16 v[122:123], v8 offset:9216
    ds_read_b64_tr_b16 v[124:125], v9 offset:8192
    s_add_u32 s101, s101, s64
    v_mfma_f32_16x16x32_bf16 v[28:31], v[84:87], v[116:119], v[28:31]
    ds_read_b64_tr_b16 v[126:127], v9 offset:9216
    v_xor_b32 v253, 32, v248
    ds_read_b64 v[182:183], v253 offset:1024
    v_mfma_f32_16x16x32_bf16 v[32:35], v[88:91], v[112:115], v[32:35]
    ds_read_b64_tr_b16 v[128:129], v10 offset:8192
    ds_read_b64_tr_b16 v[130:131], v10 offset:9216
    s_lshl_b32 s101, s101, 7
    v_mfma_f32_16x16x32_bf16 v[36:39], v[88:91], v[116:119], v[36:39]
    ds_read_b64_tr_b16 v[132:133], v11 offset:8192
    v_xor_b32 v253, 192, v248
    s_waitcnt lgkmcnt(7)
    ds_read_b64 v[184:185], v253 offset:1024
    v_mfma_f32_16x16x32_bf16 v[40:43], v[92:95], v[112:115], v[40:43]
    ds_read_b64_tr_b16 v[134:135], v11 offset:9216
    ds_read_b64_tr_b16 v[136:137], v12 offset:8192
    v_xor_b32 v253, 224, v248
    ds_read_b64 v[186:187], v253 offset:1024
    v_mfma_f32_16x16x32_bf16 v[44:47], v[92:95], v[116:119], v[44:47]
    ds_read_b64_tr_b16 v[138:139], v12 offset:9216
    s_add_u32 s18, s100, s101
    v_mfma_f32_16x16x32_bf16 v[48:51], v[96:99], v[112:115], v[48:51]
    ds_read_b64_tr_b16 v[140:141], v13 offset:8192
    ds_read_b64_tr_b16 v[142:143], v13 offset:9216
    v_xor_b32 v253, 128, v248
    ds_read_b64 v[188:189], v253 offset:1024
    v_mfma_f32_16x16x32_bf16 v[52:55], v[96:99], v[116:119], v[52:55]
    s_waitcnt lgkmcnt(7)
    ds_read_b64_tr_b16 v[144:145], v14 offset:8192
    v_xor_b32 v253, 160, v248
    ds_read_b64 v[190:191], v253 offset:1024
    v_mfma_f32_16x16x32_bf16 v[56:59], v[100:103], v[112:115], v[56:59]
    ds_read_b64_tr_b16 v[146:147], v14 offset:9216
    ds_read_b64_tr_b16 v[148:149], v15 offset:8192
    s_lshl_b32 s100, s83, 17
    v_mfma_f32_16x16x32_bf16 v[60:63], v[100:103], v[116:119], v[60:63]
    ds_read_b64_tr_b16 v[150:151], v15 offset:9216
    s_add_u32 s100, s100, s99
    v_mfma_f32_16x16x32_bf16 v[64:67], v[104:107], v[112:115], v[64:67]
    s_lshl_b32 s101, s98, 11
    v_mfma_f32_16x16x32_bf16 v[68:71], v[104:107], v[116:119], v[68:71]
    s_add_u32 s17, s100, s101
    v_mfma_f32_16x16x32_bf16 v[72:75], v[108:111], v[112:115], v[72:75]
    s_lshl_b32 s101, s66, 15
    v_mfma_f32_16x16x32_bf16 v[76:79], v[108:111], v[116:119], v[76:79]
    s_add_u32 s21, s100, s101
    s_waitcnt lgkmcnt(0)
    s_waitcnt vmcnt(16)
    s_barrier
    v_mfma_f32_16x16x32_bf16 v[16:19], v[120:123], v[152:155], v[16:19]
    ds_read_b128 v[112:115], v232 offset:4096
    ds_read_b128 v[116:119], v232 offset:6144
    s_add_u32 m0, s82, 131072
    s_add_u32 s87, s80, 0
    buffer_load_dwordx4 v3, s[40:43], s87 offen offset:0 nt lds
    v_mfma_f32_16x16x32_bf16 v[20:23], v[120:123], v[156:159], v[20:23]
    ds_read_b64_tr_b16 v[80:81], v8 offset:16384
    buffer_load_dwordx4 v3, s[40:43], s87 offen offset:1024 nt lds
    v_mfma_f32_16x16x32_bf16 v[24:27], v[124:127], v[152:155], v[24:27]
    ds_read_b64_tr_b16 v[82:83], v8 offset:17408
    v_xor_b32 v240, 32, v3
    buffer_load_dwordx4 v240, s[40:43], s87 offen offset:2048 nt lds
    v_mfma_f32_16x16x32_bf16 v[28:31], v[124:127], v[156:159], v[28:31]
    ds_read_b64_tr_b16 v[84:85], v9 offset:16384
    buffer_load_dwordx4 v240, s[40:43], s87 offen offset:3072 nt lds
    v_mfma_f32_16x16x32_bf16 v[32:35], v[128:131], v[152:155], v[32:35]
    ds_read_b64_tr_b16 v[86:87], v9 offset:17408
    s_add_u32 m0, s82, 135168
    s_add_u32 s87, s80, 4096
    buffer_load_dwordx4 v3, s[40:43], s87 offen offset:0 nt lds
    v_mfma_f32_16x16x32_bf16 v[36:39], v[128:131], v[156:159], v[36:39]
    ds_read_b64_tr_b16 v[88:89], v10 offset:16384
    buffer_load_dwordx4 v3, s[40:43], s87 offen offset:1024 nt lds
    v_mfma_f32_16x16x32_bf16 v[40:43], v[132:135], v[152:155], v[40:43]
    ds_read_b64_tr_b16 v[90:91], v10 offset:17408
    v_xor_b32 v240, 32, v3
    buffer_load_dwordx4 v240, s[40:43], s87 offen offset:2048 nt lds
    v_mfma_f32_16x16x32_bf16 v[44:47], v[132:135], v[156:159], v[44:47]
    ds_read_b64_tr_b16 v[92:93], v11 offset:16384
    buffer_load_dwordx4 v240, s[40:43], s87 offen offset:3072 nt lds
    v_mfma_f32_16x16x32_bf16 v[48:51], v[136:139], v[152:155], v[48:51]
    ds_read_b64_tr_b16 v[94:95], v11 offset:17408
    ds_read_b64_tr_b16 v[96:97], v12 offset:16384
    s_add_u32 m0, s78, 0
    s_add_u32 s87, s92, 896
    buffer_load_dwordx4 v228, s[32:35], s87 offen offset:0 lds
    v_mfma_f32_16x16x32_bf16 v[52:55], v[136:139], v[156:159], v[52:55]
    ds_read_b64_tr_b16 v[98:99], v12 offset:17408
    s_lshl_b32 s101, s64, 11
    v_mfma_f32_16x16x32_bf16 v[56:59], v[140:143], v[152:155], v[56:59]
    ds_read_b64_tr_b16 v[100:101], v13 offset:16384
    buffer_load_dwordx4 v229, s[32:35], s87 offen offset:1024 lds
    v_mfma_f32_16x16x32_bf16 v[60:63], v[140:143], v[156:159], v[60:63]
    ds_read_b64_tr_b16 v[102:103], v13 offset:17408
    s_add_u32 s21, s21, s101
    v_mfma_f32_16x16x32_bf16 v[64:67], v[144:147], v[152:155], v[64:67]
    ds_read_b64_tr_b16 v[104:105], v14 offset:16384
    s_lshl_b32 s100, s68, 2
    v_mfma_f32_16x16x32_bf16 v[68:71], v[144:147], v[156:159], v[68:71]
    s_waitcnt lgkmcnt(7)
    ds_read_b64_tr_b16 v[106:107], v14 offset:17408
    s_add_u32 s100, s100, s66
    v_mfma_f32_16x16x32_bf16 v[72:75], v[148:151], v[152:155], v[72:75]
    ds_read_b64_tr_b16 v[108:109], v15 offset:16384
    s_lshl_b32 s100, s100, 17
    v_mfma_f32_16x16x32_bf16 v[76:79], v[148:151], v[156:159], v[76:79]
    ds_read_b64_tr_b16 v[110:111], v15 offset:17408
    s_lshl_b32 s101, s65, 11
    v_mfma_f32_16x16x32_bf16 v[16:19], v[80:83], v[112:115], v[16:19]
    ds_read_b128 v[152:155], v233 offset:4096
    ds_read_b128 v[156:159], v233 offset:6144
    s_add_u32 s100, s100, s101
    v_mfma_f32_16x16x32_bf16 v[20:23], v[80:83], v[116:119], v[20:23]
    ds_read_b64_tr_b16 v[120:121], v8 offset:24576
    s_lshl_b32 s101, s83, 8
    v_mfma_f32_16x16x32_bf16 v[24:27], v[84:87], v[112:115], v[24:27]
    ds_read_b64_tr_b16 v[122:123], v8 offset:25600
    ds_read_b64_tr_b16 v[124:125], v9 offset:24576
    s_add_u32 s100, s100, s101
    v_mfma_f32_16x16x32_bf16 v[28:31], v[84:87], v[116:119], v[28:31]
    s_waitcnt lgkmcnt(7)
    ds_read_b64_tr_b16 v[126:127], v9 offset:25600
    s_lshl_b32 s101, s64, 6
    v_mfma_f32_16x16x32_bf16 v[32:35], v[88:91], v[112:115], v[32:35]
    ds_read_b64_tr_b16 v[128:129], v10 offset:24576
    ds_read_b64_tr_b16 v[130:131], v10 offset:25600
    buffer_load_dwordx4 v230, s[32:35], s87 offen offset:2048 lds
    v_mfma_f32_16x16x32_bf16 v[36:39], v[88:91], v[116:119], v[36:39]
    ds_read_b64_tr_b16 v[132:133], v11 offset:24576
    s_add_u32 s20, s100, s101
    v_mfma_f32_16x16x32_bf16 v[40:43], v[92:95], v[112:115], v[40:43]
    ds_read_b64_tr_b16 v[134:135], v11 offset:25600
    ds_read_b64_tr_b16 v[136:137], v12 offset:24576
    v_mfma_f32_16x16x32_bf16 v[44:47], v[92:95], v[116:119], v[44:47]
    ds_read_b64_tr_b16 v[138:139], v12 offset:25600
    buffer_load_dwordx4 v231, s[32:35], s87 offen offset:3072 lds
    v_mfma_f32_16x16x32_bf16 v[48:51], v[96:99], v[112:115], v[48:51]
    ds_read_b64_tr_b16 v[140:141], v13 offset:24576
    s_waitcnt lgkmcnt(7)
    ds_read_b64_tr_b16 v[142:143], v13 offset:25600
    v_mfma_f32_16x16x32_bf16 v[52:55], v[96:99], v[116:119], v[52:55]
    ds_read_b64_tr_b16 v[144:145], v14 offset:24576
    v_mfma_f32_16x16x32_bf16 v[56:59], v[100:103], v[112:115], v[56:59]
    ds_read_b64_tr_b16 v[146:147], v14 offset:25600
    ds_read_b64_tr_b16 v[148:149], v15 offset:24576
    s_add_u32 m0, s81, 0
    s_add_u32 s87, s88, 3670016
    buffer_load_dwordx4 v224, s[44:47], s87 offen offset:0 lds
    v_mfma_f32_16x16x32_bf16 v[60:63], v[100:103], v[116:119], v[60:63]
    ds_read_b64_tr_b16 v[150:151], v15 offset:25600
    v_mfma_f32_16x16x32_bf16 v[64:67], v[104:107], v[112:115], v[64:67]
    buffer_load_dwordx4 v225, s[44:47], s87 offen offset:1024 lds
    v_mfma_f32_16x16x32_bf16 v[68:71], v[104:107], v[116:119], v[68:71]
    v_mfma_f32_16x16x32_bf16 v[72:75], v[108:111], v[112:115], v[72:75]
    v_mfma_f32_16x16x32_bf16 v[76:79], v[108:111], v[116:119], v[76:79]
    buffer_load_dwordx4 v226, s[44:47], s87 offen offset:2048 lds
    s_waitcnt lgkmcnt(0)
    s_waitcnt vmcnt(23)
    s_barrier
    v_mfma_f32_16x16x32_bf16 v[16:19], v[120:123], v[152:155], v[16:19]
    ds_read_b128 v[112:115], v232 offset:8192
    ds_read_b128 v[116:119], v232 offset:10240
    v_mfma_f32_16x16x32_bf16 v[20:23], v[120:123], v[156:159], v[20:23]
    ds_read_b64_tr_b16 v[80:81], v8 offset:32768
    v_mfma_f32_16x16x32_bf16 v[24:27], v[124:127], v[152:155], v[24:27]
    ds_read_b64_tr_b16 v[82:83], v8 offset:33792
    buffer_load_dwordx4 v227, s[44:47], s87 offen offset:3072 lds
    v_mfma_f32_16x16x32_bf16 v[28:31], v[124:127], v[156:159], v[28:31]
    ds_read_b64_tr_b16 v[84:85], v9 offset:32768
    v_mfma_f32_16x16x32_bf16 v[32:35], v[128:131], v[152:155], v[32:35]
    ds_read_b64_tr_b16 v[86:87], v9 offset:33792
    s_add_u32 m0, s78, 4096
    s_add_u32 s87, s93, 0
    buffer_load_dwordx4 v228, s[32:35], s87 offen offset:0 lds
    v_mfma_f32_16x16x32_bf16 v[36:39], v[128:131], v[156:159], v[36:39]
    ds_read_b64_tr_b16 v[88:89], v10 offset:32768
    v_mfma_f32_16x16x32_bf16 v[40:43], v[132:135], v[152:155], v[40:43]
    ds_read_b64_tr_b16 v[90:91], v10 offset:33792
    v_mfma_f32_16x16x32_bf16 v[44:47], v[132:135], v[156:159], v[44:47]
    ds_read_b64_tr_b16 v[92:93], v11 offset:32768
    buffer_load_dwordx4 v229, s[32:35], s87 offen offset:1024 lds
    v_mfma_f32_16x16x32_bf16 v[48:51], v[136:139], v[152:155], v[48:51]
    ds_read_b64_tr_b16 v[94:95], v11 offset:33792
    ds_read_b64_tr_b16 v[96:97], v12 offset:32768
    v_mfma_f32_16x16x32_bf16 v[52:55], v[136:139], v[156:159], v[52:55]
    ds_read_b64_tr_b16 v[98:99], v12 offset:33792
    v_mfma_f32_16x16x32_bf16 v[56:59], v[140:143], v[152:155], v[56:59]
    ds_read_b64_tr_b16 v[100:101], v13 offset:32768
    buffer_load_dwordx4 v230, s[32:35], s87 offen offset:2048 lds
    v_mfma_f32_16x16x32_bf16 v[60:63], v[140:143], v[156:159], v[60:63]
    ds_read_b64_tr_b16 v[102:103], v13 offset:33792
    v_mfma_f32_16x16x32_bf16 v[64:67], v[144:147], v[152:155], v[64:67]
    ds_read_b64_tr_b16 v[104:105], v14 offset:32768
    buffer_load_dwordx4 v231, s[32:35], s87 offen offset:3072 lds
    v_mfma_f32_16x16x32_bf16 v[68:71], v[144:147], v[156:159], v[68:71]
    s_waitcnt lgkmcnt(7)
    ds_read_b64_tr_b16 v[106:107], v14 offset:33792
    v_mfma_f32_16x16x32_bf16 v[72:75], v[148:151], v[152:155], v[72:75]
    ds_read_b64_tr_b16 v[108:109], v15 offset:32768
    v_mfma_f32_16x16x32_bf16 v[76:79], v[148:151], v[156:159], v[76:79]
    ds_read_b64_tr_b16 v[110:111], v15 offset:33792
    s_add_u32 m0, s81, 16384
    s_add_u32 s87, s89, 0
    buffer_load_dwordx4 v224, s[44:47], s87 offen offset:0 lds
    v_mfma_f32_16x16x32_bf16 v[16:19], v[80:83], v[112:115], v[16:19]
    ds_read_b128 v[152:155], v233 offset:8192
    ds_read_b128 v[156:159], v233 offset:10240
    v_mfma_f32_16x16x32_bf16 v[20:23], v[80:83], v[116:119], v[20:23]
    ds_read_b64_tr_b16 v[120:121], v8 offset:40960
    v_mfma_f32_16x16x32_bf16 v[24:27], v[84:87], v[112:115], v[24:27]
    ds_read_b64_tr_b16 v[122:123], v8 offset:41984
    ds_read_b64_tr_b16 v[124:125], v9 offset:40960
    buffer_load_dwordx4 v225, s[44:47], s87 offen offset:1024 lds
    v_mfma_f32_16x16x32_bf16 v[28:31], v[84:87], v[116:119], v[28:31]
    s_waitcnt lgkmcnt(7)
    ds_read_b64_tr_b16 v[126:127], v9 offset:41984
    v_mfma_f32_16x16x32_bf16 v[32:35], v[88:91], v[112:115], v[32:35]
    ds_read_b64_tr_b16 v[128:129], v10 offset:40960
    ds_read_b64_tr_b16 v[130:131], v10 offset:41984
    buffer_load_dwordx4 v226, s[44:47], s87 offen offset:2048 lds
    v_mfma_f32_16x16x32_bf16 v[36:39], v[88:91], v[116:119], v[36:39]
    ds_read_b64_tr_b16 v[132:133], v11 offset:40960
    v_mfma_f32_16x16x32_bf16 v[40:43], v[92:95], v[112:115], v[40:43]
    ds_read_b64_tr_b16 v[134:135], v11 offset:41984
    ds_read_b64_tr_b16 v[136:137], v12 offset:40960
    v_mfma_f32_16x16x32_bf16 v[44:47], v[92:95], v[116:119], v[44:47]
    ds_read_b64_tr_b16 v[138:139], v12 offset:41984
    buffer_load_dwordx4 v227, s[44:47], s87 offen offset:3072 lds
    v_mfma_f32_16x16x32_bf16 v[48:51], v[96:99], v[112:115], v[48:51]
    ds_read_b64_tr_b16 v[140:141], v13 offset:40960
    s_waitcnt lgkmcnt(7)
    ds_read_b64_tr_b16 v[142:143], v13 offset:41984
    v_mfma_f32_16x16x32_bf16 v[52:55], v[96:99], v[116:119], v[52:55]
    ds_read_b64_tr_b16 v[144:145], v14 offset:40960
    v_mfma_f32_16x16x32_bf16 v[56:59], v[100:103], v[112:115], v[56:59]
    ds_read_b64_tr_b16 v[146:147], v14 offset:41984
    ds_read_b64_tr_b16 v[148:149], v15 offset:40960
    v_mfma_f32_16x16x32_bf16 v[60:63], v[100:103], v[116:119], v[60:63]
    ds_read_b64_tr_b16 v[150:151], v15 offset:41984
    v_mfma_f32_16x16x32_bf16 v[64:67], v[104:107], v[112:115], v[64:67]
    v_mfma_f32_16x16x32_bf16 v[68:71], v[104:107], v[116:119], v[68:71]
    v_mfma_f32_16x16x32_bf16 v[72:75], v[108:111], v[112:115], v[72:75]
    v_mfma_f32_16x16x32_bf16 v[76:79], v[108:111], v[116:119], v[76:79]
    s_waitcnt lgkmcnt(0)
    s_waitcnt vmcnt(24)
    s_barrier
    v_mfma_f32_16x16x32_bf16 v[16:19], v[120:123], v[152:155], v[16:19]
    ds_read_b128 v[112:115], v232 offset:12288
    ds_read_b128 v[116:119], v232 offset:14336
    s_add_u32 m0, s78, 8192
    s_add_u32 s87, s93, 256
    buffer_load_dwordx4 v228, s[32:35], s87 offen offset:0 lds
    v_mfma_f32_16x16x32_bf16 v[20:23], v[120:123], v[156:159], v[20:23]
    ds_read_b64_tr_b16 v[80:81], v8 offset:49152
    buffer_load_dwordx4 v229, s[32:35], s87 offen offset:1024 lds
    v_mfma_f32_16x16x32_bf16 v[24:27], v[124:127], v[152:155], v[24:27]
    ds_read_b64_tr_b16 v[82:83], v8 offset:50176
    buffer_load_dwordx4 v230, s[32:35], s87 offen offset:2048 lds
    v_mfma_f32_16x16x32_bf16 v[28:31], v[124:127], v[156:159], v[28:31]
    ds_read_b64_tr_b16 v[84:85], v9 offset:49152
    buffer_load_dwordx4 v231, s[32:35], s87 offen offset:3072 lds
    v_mfma_f32_16x16x32_bf16 v[32:35], v[128:131], v[152:155], v[32:35]
    ds_read_b64_tr_b16 v[86:87], v9 offset:50176
    s_add_u32 m0, s81, 32768
    s_add_u32 s87, s89, 1048576
    buffer_load_dwordx4 v224, s[44:47], s87 offen offset:0 lds
    v_mfma_f32_16x16x32_bf16 v[36:39], v[128:131], v[156:159], v[36:39]
    ds_read_b64_tr_b16 v[88:89], v10 offset:49152
    v_mfma_f32_16x16x32_bf16 v[40:43], v[132:135], v[152:155], v[40:43]
    ds_read_b64_tr_b16 v[90:91], v10 offset:50176
    v_mfma_f32_16x16x32_bf16 v[44:47], v[132:135], v[156:159], v[44:47]
    ds_read_b64_tr_b16 v[92:93], v11 offset:49152
    buffer_load_dwordx4 v225, s[44:47], s87 offen offset:1024 lds
    v_mfma_f32_16x16x32_bf16 v[48:51], v[136:139], v[152:155], v[48:51]
    ds_read_b64_tr_b16 v[94:95], v11 offset:50176
    ds_read_b64_tr_b16 v[96:97], v12 offset:49152
    v_mfma_f32_16x16x32_bf16 v[52:55], v[136:139], v[156:159], v[52:55]
    ds_read_b64_tr_b16 v[98:99], v12 offset:50176
    v_mfma_f32_16x16x32_bf16 v[56:59], v[140:143], v[152:155], v[56:59]
    ds_read_b64_tr_b16 v[100:101], v13 offset:49152
    buffer_load_dwordx4 v226, s[44:47], s87 offen offset:2048 lds
    v_mfma_f32_16x16x32_bf16 v[60:63], v[140:143], v[156:159], v[60:63]
    ds_read_b64_tr_b16 v[102:103], v13 offset:50176
    v_mfma_f32_16x16x32_bf16 v[64:67], v[144:147], v[152:155], v[64:67]
    ds_read_b64_tr_b16 v[104:105], v14 offset:49152
    buffer_load_dwordx4 v227, s[44:47], s87 offen offset:3072 lds
    v_mfma_f32_16x16x32_bf16 v[68:71], v[144:147], v[156:159], v[68:71]
    s_waitcnt lgkmcnt(7)
    ds_read_b64_tr_b16 v[106:107], v14 offset:50176
    v_mfma_f32_16x16x32_bf16 v[72:75], v[148:151], v[152:155], v[72:75]
    ds_read_b64_tr_b16 v[108:109], v15 offset:49152
    v_mfma_f32_16x16x32_bf16 v[76:79], v[148:151], v[156:159], v[76:79]
    ds_read_b64_tr_b16 v[110:111], v15 offset:50176
    v_mfma_f32_16x16x32_bf16 v[16:19], v[80:83], v[112:115], v[16:19]
    ds_read_b128 v[152:155], v233 offset:12288
    ds_read_b128 v[156:159], v233 offset:14336
    v_mfma_f32_16x16x32_bf16 v[20:23], v[80:83], v[116:119], v[20:23]
    ds_read_b64_tr_b16 v[120:121], v8 offset:57344
    v_mfma_f32_16x16x32_bf16 v[24:27], v[84:87], v[112:115], v[24:27]
    ds_read_b64_tr_b16 v[122:123], v8 offset:58368
    ds_read_b64_tr_b16 v[124:125], v9 offset:57344
    v_mfma_f32_16x16x32_bf16 v[28:31], v[84:87], v[116:119], v[28:31]
    s_waitcnt lgkmcnt(7)
    ds_read_b64_tr_b16 v[126:127], v9 offset:58368
    v_mfma_f32_16x16x32_bf16 v[32:35], v[88:91], v[112:115], v[32:35]
    ds_read_b64_tr_b16 v[128:129], v10 offset:57344
    ds_read_b64_tr_b16 v[130:131], v10 offset:58368
    v_mfma_f32_16x16x32_bf16 v[36:39], v[88:91], v[116:119], v[36:39]
    ds_read_b64_tr_b16 v[132:133], v11 offset:57344
    v_mfma_f32_16x16x32_bf16 v[40:43], v[92:95], v[112:115], v[40:43]
    ds_read_b64_tr_b16 v[134:135], v11 offset:58368
    ds_read_b64_tr_b16 v[136:137], v12 offset:57344
    v_mfma_f32_16x16x32_bf16 v[44:47], v[92:95], v[116:119], v[44:47]
    ds_read_b64_tr_b16 v[138:139], v12 offset:58368
    v_mfma_f32_16x16x32_bf16 v[48:51], v[96:99], v[112:115], v[48:51]
    ds_read_b64_tr_b16 v[140:141], v13 offset:57344
    s_waitcnt lgkmcnt(7)
    ds_read_b64_tr_b16 v[142:143], v13 offset:58368
    v_mfma_f32_16x16x32_bf16 v[52:55], v[96:99], v[116:119], v[52:55]
    ds_read_b64_tr_b16 v[144:145], v14 offset:57344
    v_mfma_f32_16x16x32_bf16 v[56:59], v[100:103], v[112:115], v[56:59]
    ds_read_b64_tr_b16 v[146:147], v14 offset:58368
    ds_read_b64_tr_b16 v[148:149], v15 offset:57344
    v_mfma_f32_16x16x32_bf16 v[60:63], v[100:103], v[116:119], v[60:63]
    ds_read_b64_tr_b16 v[150:151], v15 offset:58368
    v_mfma_f32_16x16x32_bf16 v[64:67], v[104:107], v[112:115], v[64:67]
    v_mfma_f32_16x16x32_bf16 v[68:71], v[104:107], v[116:119], v[68:71]
    v_mfma_f32_16x16x32_bf16 v[72:75], v[108:111], v[112:115], v[72:75]
    v_mfma_f32_16x16x32_bf16 v[76:79], v[108:111], v[116:119], v[76:79]
    s_waitcnt lgkmcnt(0)
    s_waitcnt vmcnt(16)
    s_barrier
    v_mfma_f32_16x16x32_bf16 v[16:19], v[120:123], v[152:155], v[16:19]
    ds_read_b128 v[112:115], v232 offset:0
    ds_read_b128 v[116:119], v232 offset:2048
    s_add_u32 m0, s78, 12288
    s_add_u32 s87, s93, 640
    buffer_load_dwordx4 v228, s[32:35], s87 offen offset:0 lds
    v_mfma_f32_16x16x32_bf16 v[20:23], v[120:123], v[156:159], v[20:23]
    ds_read_b64_tr_b16 v[80:81], v8 offset:0
    buffer_load_dwordx4 v229, s[32:35], s87 offen offset:1024 lds
    v_mfma_f32_16x16x32_bf16 v[24:27], v[124:127], v[152:155], v[24:27]
    ds_read_b64_tr_b16 v[82:83], v8 offset:1024
    buffer_load_dwordx4 v230, s[32:35], s87 offen offset:2048 lds
    v_mfma_f32_16x16x32_bf16 v[28:31], v[124:127], v[156:159], v[28:31]
    ds_read_b64_tr_b16 v[84:85], v9 offset:0
    buffer_load_dwordx4 v231, s[32:35], s87 offen offset:3072 lds
    s_add_u32 s71, s82, 131072
    v_add_u32 v253, s71, v8
    ds_read_b64_tr_b16 v[192:193], v253 offset:0
    ds_read_b64_tr_b16 v[194:195], v253 offset:1024
    v_mfma_f32_16x16x32_bf16 v[32:35], v[128:131], v[152:155], v[32:35]
    ds_read_b64_tr_b16 v[86:87], v9 offset:1024
    s_add_u32 m0, s81, 49152
    s_add_u32 s87, s89, 2621440
    buffer_load_dwordx4 v224, s[44:47], s87 offen offset:0 lds
    v_mfma_f32_16x16x32_bf16 v[36:39], v[128:131], v[156:159], v[36:39]
    ds_read_b64_tr_b16 v[88:89], v10 offset:0
    buffer_load_dwordx4 v225, s[44:47], s87 offen offset:1024 lds
    v_mfma_f32_16x16x32_bf16 v[40:43], v[132:135], v[152:155], v[40:43]
    ds_read_b64_tr_b16 v[90:91], v10 offset:1024
    buffer_load_dwordx4 v226, s[44:47], s87 offen offset:2048 lds
    v_add_u32 v253, s71, v9
    ds_read_b64_tr_b16 v[196:197], v253 offset:0
    ds_read_b64_tr_b16 v[198:199], v253 offset:1024
    v_mfma_f32_16x16x32_bf16 v[44:47], v[132:135], v[156:159], v[44:47]
    ds_read_b64_tr_b16 v[92:93], v11 offset:0
    buffer_load_dwordx4 v227, s[44:47], s87 offen offset:3072 lds
    v_mfma_f32_16x16x32_bf16 v[48:51], v[136:139], v[152:155], v[48:51]
    ds_read_b64_tr_b16 v[94:95], v11 offset:1024
    ds_read_b64_tr_b16 v[96:97], v12 offset:0
    v_mfma_f32_16x16x32_bf16 v[52:55], v[136:139], v[156:159], v[52:55]
    s_waitcnt lgkmcnt(7)
    ds_read_b64_tr_b16 v[98:99], v12 offset:1024
    v_add_u32 v253, s71, v10
    ds_read_b64_tr_b16 v[200:201], v253 offset:0
    ds_read_b64_tr_b16 v[202:203], v253 offset:1024
    v_mfma_f32_16x16x32_bf16 v[56:59], v[140:143], v[152:155], v[56:59]
    ds_read_b64_tr_b16 v[100:101], v13 offset:0
    v_mfma_f32_16x16x32_bf16 v[60:63], v[140:143], v[156:159], v[60:63]
    ds_read_b64_tr_b16 v[102:103], v13 offset:1024
    v_mfma_f32_16x16x32_bf16 v[64:67], v[144:147], v[152:155], v[64:67]
    ds_read_b64_tr_b16 v[104:105], v14 offset:0
    v_add_u32 v253, s71, v11
    ds_read_b64_tr_b16 v[204:205], v253 offset:0
    ds_read_b64_tr_b16 v[206:207], v253 offset:1024
    v_mfma_f32_16x16x32_bf16 v[68:71], v[144:147], v[156:159], v[68:71]
    s_waitcnt lgkmcnt(7)
    ds_read_b64_tr_b16 v[106:107], v14 offset:1024
    v_mfma_f32_16x16x32_bf16 v[72:75], v[148:151], v[152:155], v[72:75]
    ds_read_b64_tr_b16 v[108:109], v15 offset:0
    v_mfma_f32_16x16x32_bf16 v[76:79], v[148:151], v[156:159], v[76:79]
    ds_read_b64_tr_b16 v[110:111], v15 offset:1024
    v_mfma_f32_16x16x32_bf16 v[16:19], v[80:83], v[112:115], v[16:19]
    ds_read_b128 v[152:155], v233 offset:0
    ds_read_b128 v[156:159], v233 offset:2048
    v_add_u32 v253, s71, v12
    ds_read_b64_tr_b16 v[208:209], v253 offset:0
    ds_read_b64_tr_b16 v[210:211], v253 offset:1024
    v_mfma_f32_16x16x32_bf16 v[20:23], v[80:83], v[116:119], v[20:23]
    ds_read_b64_tr_b16 v[120:121], v8 offset:8192
    v_mfma_f32_16x16x32_bf16 v[24:27], v[84:87], v[112:115], v[24:27]
    s_waitcnt lgkmcnt(7)
    ds_read_b64_tr_b16 v[122:123], v8 offset:9216
    ds_read_b64_tr_b16 v[124:125], v9 offset:8192
    v_mfma_f32_16x16x32_bf16 v[28:31], v[84:87], v[116:119], v[28:31]
    ds_read_b64_tr_b16 v[126:127], v9 offset:9216
    v_add_u32 v253, s71, v13
    ds_read_b64_tr_b16 v[212:213], v253 offset:0
    ds_read_b64_tr_b16 v[214:215], v253 offset:1024
    v_mfma_f32_16x16x32_bf16 v[32:35], v[88:91], v[112:115], v[32:35]
    ds_read_b64_tr_b16 v[128:129], v10 offset:8192
    ds_read_b64_tr_b16 v[130:131], v10 offset:9216
    v_mfma_f32_16x16x32_bf16 v[36:39], v[88:91], v[116:119], v[36:39]
    ds_read_b64_tr_b16 v[132:133], v11 offset:8192
    v_mfma_f32_16x16x32_bf16 v[40:43], v[92:95], v[112:115], v[40:43]
    s_waitcnt lgkmcnt(7)
    ds_read_b64_tr_b16 v[134:135], v11 offset:9216
    ds_read_b64_tr_b16 v[136:137], v12 offset:8192
    v_add_u32 v253, s71, v14
    ds_read_b64_tr_b16 v[216:217], v253 offset:0
    ds_read_b64_tr_b16 v[218:219], v253 offset:1024
    v_mfma_f32_16x16x32_bf16 v[44:47], v[92:95], v[116:119], v[44:47]
    ds_read_b64_tr_b16 v[138:139], v12 offset:9216
    v_mfma_f32_16x16x32_bf16 v[48:51], v[96:99], v[112:115], v[48:51]
    ds_read_b64_tr_b16 v[140:141], v13 offset:8192
    ds_read_b64_tr_b16 v[142:143], v13 offset:9216
    v_mfma_f32_16x16x32_bf16 v[52:55], v[96:99], v[116:119], v[52:55]
    ds_read_b64_tr_b16 v[144:145], v14 offset:8192
    v_add_u32 v253, s71, v15
    s_waitcnt lgkmcnt(7)
    ds_read_b64_tr_b16 v[220:221], v253 offset:0
    ds_read_b64_tr_b16 v[222:223], v253 offset:1024
    v_mfma_f32_16x16x32_bf16 v[56:59], v[100:103], v[112:115], v[56:59]
    ds_read_b64_tr_b16 v[146:147], v14 offset:9216
    ds_read_b64_tr_b16 v[148:149], v15 offset:8192
    v_mfma_f32_16x16x32_bf16 v[60:63], v[100:103], v[116:119], v[60:63]
    ds_read_b64_tr_b16 v[150:151], v15 offset:9216
    v_mfma_f32_16x16x32_bf16 v[64:67], v[104:107], v[112:115], v[64:67]
    v_mfma_f32_16x16x32_bf16 v[68:71], v[104:107], v[116:119], v[68:71]
    v_mfma_f32_16x16x32_bf16 v[72:75], v[108:111], v[112:115], v[72:75]
    v_mfma_f32_16x16x32_bf16 v[76:79], v[108:111], v[116:119], v[76:79]
    s_waitcnt lgkmcnt(0)
    s_waitcnt vmcnt(16)
    s_barrier
    v_mfma_f32_16x16x32_bf16 v[16:19], v[120:123], v[152:155], v[16:19]
    ds_read_b128 v[112:115], v232 offset:4096
    ds_read_b128 v[116:119], v232 offset:6144
    s_add_u32 m0, s82, 131072
    s_add_u32 s87, s4, 0
    buffer_load_dwordx4 v4, s[48:51], s87 offen offset:0 lds
    v_mfma_f32_16x16x32_bf16 v[20:23], v[120:123], v[156:159], v[20:23]
    ds_read_b64_tr_b16 v[80:81], v8 offset:16384
    buffer_load_dwordx4 v5, s[48:51], s87 offen offset:1024 lds
    v_mfma_f32_16x16x32_bf16 v[24:27], v[124:127], v[152:155], v[24:27]
    ds_read_b64_tr_b16 v[82:83], v8 offset:17408
    buffer_load_dwordx4 v6, s[48:51], s87 offen offset:2048 lds
    v_mfma_f32_16x16x32_bf16 v[28:31], v[124:127], v[156:159], v[28:31]
    ds_read_b64_tr_b16 v[84:85], v9 offset:16384
    buffer_load_dwordx4 v7, s[48:51], s87 offen offset:3072 lds
    v_mfma_f32_16x16x32_bf16 v[32:35], v[128:131], v[152:155], v[32:35]
    ds_read_b64_tr_b16 v[86:87], v9 offset:17408
    s_add_u32 m0, s82, 135168
    s_add_u32 s87, s4, 16384
    buffer_load_dwordx4 v4, s[48:51], s87 offen offset:0 lds
    v_mfma_f32_16x16x32_bf16 v[36:39], v[128:131], v[156:159], v[36:39]
    ds_read_b64_tr_b16 v[88:89], v10 offset:16384
    buffer_load_dwordx4 v5, s[48:51], s87 offen offset:1024 lds
    v_mfma_f32_16x16x32_bf16 v[40:43], v[132:135], v[152:155], v[40:43]
    ds_read_b64_tr_b16 v[90:91], v10 offset:17408
    buffer_load_dwordx4 v6, s[48:51], s87 offen offset:2048 lds
    v_mfma_f32_16x16x32_bf16 v[44:47], v[132:135], v[156:159], v[44:47]
    ds_read_b64_tr_b16 v[92:93], v11 offset:16384
    buffer_load_dwordx4 v7, s[48:51], s87 offen offset:3072 lds
    v_mfma_f32_16x16x32_bf16 v[48:51], v[136:139], v[152:155], v[48:51]
    ds_read_b64_tr_b16 v[94:95], v11 offset:17408
    ds_read_b64_tr_b16 v[96:97], v12 offset:16384
    buffer_load_dword v252, v241, s[60:63], 0 offen sc1
    v_mfma_f32_16x16x32_bf16 v[52:55], v[136:139], v[156:159], v[52:55]
    ds_read_b64_tr_b16 v[98:99], v12 offset:17408
    buffer_load_dword v242, v241, s[52:55], s18 offen
    v_mfma_f32_16x16x32_bf16 v[56:59], v[140:143], v[152:155], v[56:59]
    ds_read_b64_tr_b16 v[100:101], v13 offset:16384
    v_mfma_f32_16x16x32_bf16 v[60:63], v[140:143], v[156:159], v[60:63]
    ds_read_b64_tr_b16 v[102:103], v13 offset:17408
    v_mfma_f32_16x16x32_bf16 v[64:67], v[144:147], v[152:155], v[64:67]
    ds_read_b64_tr_b16 v[104:105], v14 offset:16384
    v_mfma_f32_16x16x32_bf16 v[68:71], v[144:147], v[156:159], v[68:71]
    s_waitcnt lgkmcnt(7)
    ds_read_b64_tr_b16 v[106:107], v14 offset:17408
    v_mfma_f32_16x16x32_bf16 v[72:75], v[148:151], v[152:155], v[72:75]
    ds_read_b64_tr_b16 v[108:109], v15 offset:16384
    v_mfma_f32_16x16x32_bf16 v[76:79], v[148:151], v[156:159], v[76:79]
    ds_read_b64_tr_b16 v[110:111], v15 offset:17408
    v_mfma_f32_16x16x32_bf16 v[16:19], v[80:83], v[112:115], v[16:19]
    ds_read_b128 v[152:155], v233 offset:4096
    ds_read_b128 v[156:159], v233 offset:6144
    v_mfma_f32_16x16x32_bf16 v[20:23], v[80:83], v[116:119], v[20:23]
    ds_read_b64_tr_b16 v[120:121], v8 offset:24576
    v_mfma_f32_16x16x32_bf16 v[24:27], v[84:87], v[112:115], v[24:27]
    ds_read_b64_tr_b16 v[122:123], v8 offset:25600
    ds_read_b64_tr_b16 v[124:125], v9 offset:24576
    v_mfma_f32_16x16x32_bf16 v[28:31], v[84:87], v[116:119], v[28:31]
    s_waitcnt lgkmcnt(7)
    ds_read_b64_tr_b16 v[126:127], v9 offset:25600
    v_mfma_f32_16x16x32_bf16 v[32:35], v[88:91], v[112:115], v[32:35]
    ds_read_b64_tr_b16 v[128:129], v10 offset:24576
    ds_read_b64_tr_b16 v[130:131], v10 offset:25600
    s_add_u32 m0, s78, 0
    s_add_u32 s87, s93, 384
    buffer_load_dwordx4 v228, s[32:35], s87 offen offset:0 lds
    v_mfma_f32_16x16x32_bf16 v[36:39], v[88:91], v[116:119], v[36:39]
    ds_read_b64_tr_b16 v[132:133], v11 offset:24576
    v_mfma_f32_16x16x32_bf16 v[40:43], v[92:95], v[112:115], v[40:43]
    ds_read_b64_tr_b16 v[134:135], v11 offset:25600
    ds_read_b64_tr_b16 v[136:137], v12 offset:24576
    v_mfma_f32_16x16x32_bf16 v[44:47], v[92:95], v[116:119], v[44:47]
    ds_read_b64_tr_b16 v[138:139], v12 offset:25600
    buffer_load_dwordx4 v229, s[32:35], s87 offen offset:1024 lds
    v_mfma_f32_16x16x32_bf16 v[48:51], v[96:99], v[112:115], v[48:51]
    ds_read_b64_tr_b16 v[140:141], v13 offset:24576
    s_waitcnt lgkmcnt(7)
    ds_read_b64_tr_b16 v[142:143], v13 offset:25600
    v_mfma_f32_16x16x32_bf16 v[52:55], v[96:99], v[116:119], v[52:55]
    ds_read_b64_tr_b16 v[144:145], v14 offset:24576
    v_mfma_f32_16x16x32_bf16 v[56:59], v[100:103], v[112:115], v[56:59]
    ds_read_b64_tr_b16 v[146:147], v14 offset:25600
    ds_read_b64_tr_b16 v[148:149], v15 offset:24576
    buffer_load_dwordx4 v230, s[32:35], s87 offen offset:2048 lds
    v_mfma_f32_16x16x32_bf16 v[60:63], v[100:103], v[116:119], v[60:63]
    ds_read_b64_tr_b16 v[150:151], v15 offset:25600
    v_mfma_f32_16x16x32_bf16 v[64:67], v[104:107], v[112:115], v[64:67]
    v_mfma_f32_16x16x32_bf16 v[68:71], v[104:107], v[116:119], v[68:71]
    buffer_load_dwordx4 v231, s[32:35], s87 offen offset:3072 lds
    v_mfma_f32_16x16x32_bf16 v[72:75], v[108:111], v[112:115], v[72:75]
    v_mfma_f32_16x16x32_bf16 v[76:79], v[108:111], v[116:119], v[76:79]
    s_add_u32 m0, s81, 0
    s_add_u32 s87, s89, 1572864
    buffer_load_dwordx4 v224, s[44:47], s87 offen offset:0 lds
    s_waitcnt lgkmcnt(0)
    s_waitcnt vmcnt(23)
    s_barrier
    v_mfma_f32_16x16x32_bf16 v[16:19], v[120:123], v[152:155], v[16:19]
    ds_read_b128 v[112:115], v232 offset:8192
    ds_read_b128 v[116:119], v232 offset:10240
    v_mfma_f32_16x16x32_bf16 v[20:23], v[120:123], v[156:159], v[20:23]
    ds_read_b64_tr_b16 v[80:81], v8 offset:32768
    v_mfma_f32_16x16x32_bf16 v[24:27], v[124:127], v[152:155], v[24:27]
    ds_read_b64_tr_b16 v[82:83], v8 offset:33792
    buffer_load_dwordx4 v225, s[44:47], s87 offen offset:1024 lds
    v_mfma_f32_16x16x32_bf16 v[28:31], v[124:127], v[156:159], v[28:31]
    ds_read_b64_tr_b16 v[84:85], v9 offset:32768
    v_mfma_f32_16x16x32_bf16 v[32:35], v[128:131], v[152:155], v[32:35]
    ds_read_b64_tr_b16 v[86:87], v9 offset:33792
    v_mfma_f32_16x16x32_bf16 v[36:39], v[128:131], v[156:159], v[36:39]
    ds_read_b64_tr_b16 v[88:89], v10 offset:32768
    buffer_load_dwordx4 v226, s[44:47], s87 offen offset:2048 lds
    v_mfma_f32_16x16x32_bf16 v[40:43], v[132:135], v[152:155], v[40:43]
    ds_read_b64_tr_b16 v[90:91], v10 offset:33792
    v_mfma_f32_16x16x32_bf16 v[44:47], v[132:135], v[156:159], v[44:47]
    ds_read_b64_tr_b16 v[92:93], v11 offset:32768
    buffer_load_dwordx4 v227, s[44:47], s87 offen offset:3072 lds
    v_mfma_f32_16x16x32_bf16 v[48:51], v[136:139], v[152:155], v[48:51]
    ds_read_b64_tr_b16 v[94:95], v11 offset:33792
    ds_read_b64_tr_b16 v[96:97], v12 offset:32768
    s_add_u32 m0, s78, 4096
    s_add_u32 s87, s93, 512
    buffer_load_dwordx4 v228, s[32:35], s87 offen offset:0 lds
    v_mfma_f32_16x16x32_bf16 v[52:55], v[136:139], v[156:159], v[52:55]
    ds_read_b64_tr_b16 v[98:99], v12 offset:33792
    buffer_load_dwordx4 v229, s[32:35], s87 offen offset:1024 lds
    v_mfma_f32_16x16x32_bf16 v[56:59], v[140:143], v[152:155], v[56:59]
    ds_read_b64_tr_b16 v[100:101], v13 offset:32768
    v_mfma_f32_16x16x32_bf16 v[60:63], v[140:143], v[156:159], v[60:63]
    ds_read_b64_tr_b16 v[102:103], v13 offset:33792
    buffer_load_dwordx4 v230, s[32:35], s87 offen offset:2048 lds
    v_mfma_f32_16x16x32_bf16 v[64:67], v[144:147], v[152:155], v[64:67]
    ds_read_b64_tr_b16 v[104:105], v14 offset:32768
    v_mfma_f32_16x16x32_bf16 v[68:71], v[144:147], v[156:159], v[68:71]
    s_waitcnt lgkmcnt(7)
    ds_read_b64_tr_b16 v[106:107], v14 offset:33792
    v_mfma_f32_16x16x32_bf16 v[72:75], v[148:151], v[152:155], v[72:75]
    ds_read_b64_tr_b16 v[108:109], v15 offset:32768
    buffer_load_dwordx4 v231, s[32:35], s87 offen offset:3072 lds
    v_mfma_f32_16x16x32_bf16 v[76:79], v[148:151], v[156:159], v[76:79]
    ds_read_b64_tr_b16 v[110:111], v15 offset:33792
    v_mfma_f32_16x16x32_bf16 v[16:19], v[80:83], v[112:115], v[16:19]
    ds_read_b128 v[152:155], v233 offset:8192
    ds_read_b128 v[156:159], v233 offset:10240
    s_add_u32 m0, s81, 16384
    s_add_u32 s87, s89, 2097152
    buffer_load_dwordx4 v224, s[44:47], s87 offen offset:0 lds
    v_mfma_f32_16x16x32_bf16 v[20:23], v[80:83], v[116:119], v[20:23]
    ds_read_b64_tr_b16 v[120:121], v8 offset:40960
    v_mfma_f32_16x16x32_bf16 v[24:27], v[84:87], v[112:115], v[24:27]
    ds_read_b64_tr_b16 v[122:123], v8 offset:41984
    ds_read_b64_tr_b16 v[124:125], v9 offset:40960
    v_mfma_f32_16x16x32_bf16 v[28:31], v[84:87], v[116:119], v[28:31]
    s_waitcnt lgkmcnt(7)
    ds_read_b64_tr_b16 v[126:127], v9 offset:41984
    buffer_load_dwordx4 v225, s[44:47], s87 offen offset:1024 lds
    v_mfma_f32_16x16x32_bf16 v[32:35], v[88:91], v[112:115], v[32:35]
    ds_read_b64_tr_b16 v[128:129], v10 offset:40960
    ds_read_b64_tr_b16 v[130:131], v10 offset:41984
    v_mfma_f32_16x16x32_bf16 v[36:39], v[88:91], v[116:119], v[36:39]
    ds_read_b64_tr_b16 v[132:133], v11 offset:40960
    v_mfma_f32_16x16x32_bf16 v[40:43], v[92:95], v[112:115], v[40:43]
    ds_read_b64_tr_b16 v[134:135], v11 offset:41984
    ds_read_b64_tr_b16 v[136:137], v12 offset:40960
    buffer_load_dwordx4 v226, s[44:47], s87 offen offset:2048 lds
    v_mfma_f32_16x16x32_bf16 v[44:47], v[92:95], v[116:119], v[44:47]
    ds_read_b64_tr_b16 v[138:139], v12 offset:41984
    v_mfma_f32_16x16x32_bf16 v[48:51], v[96:99], v[112:115], v[48:51]
    ds_read_b64_tr_b16 v[140:141], v13 offset:40960
    s_waitcnt lgkmcnt(7)
    ds_read_b64_tr_b16 v[142:143], v13 offset:41984
    buffer_load_dwordx4 v227, s[44:47], s87 offen offset:3072 lds
    v_mfma_f32_16x16x32_bf16 v[52:55], v[96:99], v[116:119], v[52:55]
    ds_read_b64_tr_b16 v[144:145], v14 offset:40960
    v_mfma_f32_16x16x32_bf16 v[56:59], v[100:103], v[112:115], v[56:59]
    ds_read_b64_tr_b16 v[146:147], v14 offset:41984
    ds_read_b64_tr_b16 v[148:149], v15 offset:40960
    v_mfma_f32_16x16x32_bf16 v[60:63], v[100:103], v[116:119], v[60:63]
    ds_read_b64_tr_b16 v[150:151], v15 offset:41984
    v_mfma_f32_16x16x32_bf16 v[64:67], v[104:107], v[112:115], v[64:67]
    v_mfma_f32_16x16x32_bf16 v[68:71], v[104:107], v[116:119], v[68:71]
    v_mfma_f32_16x16x32_bf16 v[72:75], v[108:111], v[112:115], v[72:75]
    v_mfma_f32_16x16x32_bf16 v[76:79], v[108:111], v[116:119], v[76:79]
    s_waitcnt lgkmcnt(0)
    s_waitcnt vmcnt(26)
    s_barrier
    v_mfma_f32_16x16x32_bf16 v[16:19], v[120:123], v[152:155], v[16:19]
    ds_read_b128 v[112:115], v232 offset:12288
    ds_read_b128 v[116:119], v232 offset:14336
    s_add_u32 m0, s78, 8192
    s_add_u32 s87, s93, 768
    buffer_load_dwordx4 v228, s[32:35], s87 offen offset:0 lds
    v_mfma_f32_16x16x32_bf16 v[20:23], v[120:123], v[156:159], v[20:23]
    ds_read_b64_tr_b16 v[80:81], v8 offset:49152
    buffer_load_dwordx4 v229, s[32:35], s87 offen offset:1024 lds
    v_mfma_f32_16x16x32_bf16 v[24:27], v[124:127], v[152:155], v[24:27]
    ds_read_b64_tr_b16 v[82:83], v8 offset:50176
    buffer_load_dwordx4 v230, s[32:35], s87 offen offset:2048 lds
    v_mfma_f32_16x16x32_bf16 v[28:31], v[124:127], v[156:159], v[28:31]
    ds_read_b64_tr_b16 v[84:85], v9 offset:49152
    buffer_load_dwordx4 v231, s[32:35], s87 offen offset:3072 lds
    v_mfma_f32_16x16x32_bf16 v[32:35], v[128:131], v[152:155], v[32:35]
    ds_read_b64_tr_b16 v[86:87], v9 offset:50176
    v_mfma_f32_16x16x32_bf16 v[36:39], v[128:131], v[156:159], v[36:39]
    ds_read_b64_tr_b16 v[88:89], v10 offset:49152
    v_mfma_f32_16x16x32_bf16 v[40:43], v[132:135], v[152:155], v[40:43]
    ds_read_b64_tr_b16 v[90:91], v10 offset:50176
    s_add_u32 m0, s81, 32768
    s_add_u32 s87, s89, 3145728
    buffer_load_dwordx4 v224, s[44:47], s87 offen offset:0 lds
    v_mfma_f32_16x16x32_bf16 v[44:47], v[132:135], v[156:159], v[44:47]
    ds_read_b64_tr_b16 v[92:93], v11 offset:49152
    v_mfma_f32_16x16x32_bf16 v[48:51], v[136:139], v[152:155], v[48:51]
    ds_read_b64_tr_b16 v[94:95], v11 offset:50176
    ds_read_b64_tr_b16 v[96:97], v12 offset:49152
    buffer_load_dwordx4 v225, s[44:47], s87 offen offset:1024 lds
    v_mfma_f32_16x16x32_bf16 v[52:55], v[136:139], v[156:159], v[52:55]
    ds_read_b64_tr_b16 v[98:99], v12 offset:50176
    v_mfma_f32_16x16x32_bf16 v[56:59], v[140:143], v[152:155], v[56:59]
    ds_read_b64_tr_b16 v[100:101], v13 offset:49152
    v_mfma_f32_16x16x32_bf16 v[60:63], v[140:143], v[156:159], v[60:63]
    ds_read_b64_tr_b16 v[102:103], v13 offset:50176
    buffer_load_dwordx4 v226, s[44:47], s87 offen offset:2048 lds
    v_mfma_f32_16x16x32_bf16 v[64:67], v[144:147], v[152:155], v[64:67]
    ds_read_b64_tr_b16 v[104:105], v14 offset:49152
    v_mfma_f32_16x16x32_bf16 v[68:71], v[144:147], v[156:159], v[68:71]
    s_waitcnt lgkmcnt(7)
    ds_read_b64_tr_b16 v[106:107], v14 offset:50176
    v_mfma_f32_16x16x32_bf16 v[72:75], v[148:151], v[152:155], v[72:75]
    ds_read_b64_tr_b16 v[108:109], v15 offset:49152
    buffer_load_dwordx4 v227, s[44:47], s87 offen offset:3072 lds
    v_mfma_f32_16x16x32_bf16 v[76:79], v[148:151], v[156:159], v[76:79]
    ds_read_b64_tr_b16 v[110:111], v15 offset:50176
    v_mfma_f32_16x16x32_bf16 v[16:19], v[80:83], v[112:115], v[16:19]
    ds_read_b128 v[152:155], v233 offset:12288
    ds_read_b128 v[156:159], v233 offset:14336
    v_mfma_f32_16x16x32_bf16 v[20:23], v[80:83], v[116:119], v[20:23]
    ds_read_b64_tr_b16 v[120:121], v8 offset:57344
    v_mfma_f32_16x16x32_bf16 v[24:27], v[84:87], v[112:115], v[24:27]
    ds_read_b64_tr_b16 v[122:123], v8 offset:58368
    ds_read_b64_tr_b16 v[124:125], v9 offset:57344
    v_mfma_f32_16x16x32_bf16 v[28:31], v[84:87], v[116:119], v[28:31]
    s_waitcnt lgkmcnt(7)
    ds_read_b64_tr_b16 v[126:127], v9 offset:58368
    v_mfma_f32_16x16x32_bf16 v[32:35], v[88:91], v[112:115], v[32:35]
    ds_read_b64_tr_b16 v[128:129], v10 offset:57344
    ds_read_b64_tr_b16 v[130:131], v10 offset:58368
    v_mfma_f32_16x16x32_bf16 v[36:39], v[88:91], v[116:119], v[36:39]
    ds_read_b64_tr_b16 v[132:133], v11 offset:57344
    v_mfma_f32_16x16x32_bf16 v[40:43], v[92:95], v[112:115], v[40:43]
    ds_read_b64_tr_b16 v[134:135], v11 offset:58368
    ds_read_b64_tr_b16 v[136:137], v12 offset:57344
    v_mfma_f32_16x16x32_bf16 v[44:47], v[92:95], v[116:119], v[44:47]
    ds_read_b64_tr_b16 v[138:139], v12 offset:58368
    v_mfma_f32_16x16x32_bf16 v[48:51], v[96:99], v[112:115], v[48:51]
    ds_read_b64_tr_b16 v[140:141], v13 offset:57344
    s_waitcnt lgkmcnt(7)
    ds_read_b64_tr_b16 v[142:143], v13 offset:58368
    v_mfma_f32_16x16x32_bf16 v[52:55], v[96:99], v[116:119], v[52:55]
    ds_read_b64_tr_b16 v[144:145], v14 offset:57344
    v_mfma_f32_16x16x32_bf16 v[56:59], v[100:103], v[112:115], v[56:59]
    ds_read_b64_tr_b16 v[146:147], v14 offset:58368
    ds_read_b64_tr_b16 v[148:149], v15 offset:57344
    v_mfma_f32_16x16x32_bf16 v[60:63], v[100:103], v[116:119], v[60:63]
    ds_read_b64_tr_b16 v[150:151], v15 offset:58368
    v_mfma_f32_16x16x32_bf16 v[64:67], v[104:107], v[112:115], v[64:67]
    v_mfma_f32_16x16x32_bf16 v[68:71], v[104:107], v[116:119], v[68:71]
    v_mfma_f32_16x16x32_bf16 v[72:75], v[108:111], v[112:115], v[72:75]
    v_mfma_f32_16x16x32_bf16 v[76:79], v[108:111], v[116:119], v[76:79]
    s_waitcnt lgkmcnt(0)
    s_waitcnt vmcnt(16)
    s_barrier
    v_mfma_f32_16x16x32_bf16 v[16:19], v[120:123], v[152:155], v[16:19]
    ds_read_b128 v[112:115], v232 offset:0
    ds_read_b128 v[116:119], v232 offset:2048
    s_add_u32 m0, s78, 12288
    s_add_u32 s87, s93, 896
    buffer_load_dwordx4 v228, s[32:35], s87 offen offset:0 lds
    v_mfma_f32_16x16x32_bf16 v[20:23], v[120:123], v[156:159], v[20:23]
    ds_read_b64_tr_b16 v[80:81], v8 offset:0
    buffer_load_dwordx4 v229, s[32:35], s87 offen offset:1024 lds
    v_mfma_f32_16x16x32_bf16 v[24:27], v[124:127], v[152:155], v[24:27]
    ds_read_b64_tr_b16 v[82:83], v8 offset:1024
    buffer_load_dwordx4 v230, s[32:35], s87 offen offset:2048 lds
    v_mfma_f32_16x16x32_bf16 v[28:31], v[124:127], v[156:159], v[28:31]
    ds_read_b64_tr_b16 v[84:85], v9 offset:0
    buffer_load_dwordx4 v231, s[32:35], s87 offen offset:3072 lds
    s_add_u32 s71, s82, 131072
    v_add_u32 v253, s71, v244
    ds_read_b64_tr_b16 a[0:1], v253 offset:0
    ds_read_b64_tr_b16 a[2:3], v253 offset:1024
    v_mfma_f32_16x16x32_bf16 v[32:35], v[128:131], v[152:155], v[32:35]
    ds_read_b64_tr_b16 v[86:87], v9 offset:1024
    s_add_u32 m0, s81, 49152
    s_add_u32 s87, s89, 3670016
    buffer_load_dwordx4 v224, s[44:47], s87 offen offset:0 lds
    v_mfma_f32_16x16x32_bf16 v[36:39], v[128:131], v[156:159], v[36:39]
    ds_read_b64_tr_b16 v[88:89], v10 offset:0
    buffer_load_dwordx4 v225, s[44:47], s87 offen offset:1024 lds
    v_mfma_f32_16x16x32_bf16 v[40:43], v[132:135], v[152:155], v[40:43]
    ds_read_b64_tr_b16 v[90:91], v10 offset:1024
    buffer_load_dwordx4 v226, s[44:47], s87 offen offset:2048 lds
    v_add_u32 v253, s71, v245
    ds_read_b64_tr_b16 a[4:5], v253 offset:0
    ds_read_b64_tr_b16 a[6:7], v253 offset:1024
    v_mfma_f32_16x16x32_bf16 v[44:47], v[132:135], v[156:159], v[44:47]
    ds_read_b64_tr_b16 v[92:93], v11 offset:0
    buffer_load_dwordx4 v227, s[44:47], s87 offen offset:3072 lds
    v_mfma_f32_16x16x32_bf16 v[48:51], v[136:139], v[152:155], v[48:51]
    ds_read_b64_tr_b16 v[94:95], v11 offset:1024
    ds_read_b64_tr_b16 v[96:97], v12 offset:0
    v_mfma_f32_16x16x32_bf16 v[52:55], v[136:139], v[156:159], v[52:55]
    s_waitcnt lgkmcnt(7)
    ds_read_b64_tr_b16 v[98:99], v12 offset:1024
    v_add_u32 v253, s71, v246
    ds_read_b64_tr_b16 a[8:9], v253 offset:0
    ds_read_b64_tr_b16 a[10:11], v253 offset:1024
    v_mfma_f32_16x16x32_bf16 v[56:59], v[140:143], v[152:155], v[56:59]
    ds_read_b64_tr_b16 v[100:101], v13 offset:0
    v_mfma_f32_16x16x32_bf16 v[60:63], v[140:143], v[156:159], v[60:63]
    ds_read_b64_tr_b16 v[102:103], v13 offset:1024
    v_mfma_f32_16x16x32_bf16 v[64:67], v[144:147], v[152:155], v[64:67]
    ds_read_b64_tr_b16 v[104:105], v14 offset:0
    v_add_u32 v253, s71, v247
    ds_read_b64_tr_b16 a[12:13], v253 offset:0
    ds_read_b64_tr_b16 a[14:15], v253 offset:1024
    v_mfma_f32_16x16x32_bf16 v[68:71], v[144:147], v[156:159], v[68:71]
    s_waitcnt lgkmcnt(7)
    ds_read_b64_tr_b16 v[106:107], v14 offset:1024
    v_mfma_f32_16x16x32_bf16 v[72:75], v[148:151], v[152:155], v[72:75]
    ds_read_b64_tr_b16 v[108:109], v15 offset:0
    v_mfma_f32_16x16x32_bf16 v[76:79], v[148:151], v[156:159], v[76:79]
    ds_read_b64_tr_b16 v[110:111], v15 offset:1024
    v_mfma_f32_16x16x32_bf16 v[16:19], v[80:83], v[112:115], v[16:19]
    ds_read_b128 v[152:155], v233 offset:0
    ds_read_b128 v[156:159], v233 offset:2048
    s_add_u32 s71, s82, 135168
    v_add_u32 v253, s71, v244
    ds_read_b64_tr_b16 a[16:17], v253 offset:0
    ds_read_b64_tr_b16 a[18:19], v253 offset:1024
    v_mfma_f32_16x16x32_bf16 v[20:23], v[80:83], v[116:119], v[20:23]
    ds_read_b64_tr_b16 v[120:121], v8 offset:8192
    v_mfma_f32_16x16x32_bf16 v[24:27], v[84:87], v[112:115], v[24:27]
    s_waitcnt lgkmcnt(7)
    ds_read_b64_tr_b16 v[122:123], v8 offset:9216
    ds_read_b64_tr_b16 v[124:125], v9 offset:8192
    v_mfma_f32_16x16x32_bf16 v[28:31], v[84:87], v[116:119], v[28:31]
    ds_read_b64_tr_b16 v[126:127], v9 offset:9216
    v_add_u32 v253, s71, v245
    ds_read_b64_tr_b16 a[20:21], v253 offset:0
    ds_read_b64_tr_b16 a[22:23], v253 offset:1024
    v_mfma_f32_16x16x32_bf16 v[32:35], v[88:91], v[112:115], v[32:35]
    ds_read_b64_tr_b16 v[128:129], v10 offset:8192
    ds_read_b64_tr_b16 v[130:131], v10 offset:9216
    v_mfma_f32_16x16x32_bf16 v[36:39], v[88:91], v[116:119], v[36:39]
    ds_read_b64_tr_b16 v[132:133], v11 offset:8192
    v_mfma_f32_16x16x32_bf16 v[40:43], v[92:95], v[112:115], v[40:43]
    s_waitcnt lgkmcnt(7)
    ds_read_b64_tr_b16 v[134:135], v11 offset:9216
    ds_read_b64_tr_b16 v[136:137], v12 offset:8192
    v_add_u32 v253, s71, v246
    ds_read_b64_tr_b16 a[24:25], v253 offset:0
    ds_read_b64_tr_b16 a[26:27], v253 offset:1024
    v_mfma_f32_16x16x32_bf16 v[44:47], v[92:95], v[116:119], v[44:47]
    ds_read_b64_tr_b16 v[138:139], v12 offset:9216
    v_mfma_f32_16x16x32_bf16 v[48:51], v[96:99], v[112:115], v[48:51]
    ds_read_b64_tr_b16 v[140:141], v13 offset:8192
    ds_read_b64_tr_b16 v[142:143], v13 offset:9216
    v_mfma_f32_16x16x32_bf16 v[52:55], v[96:99], v[116:119], v[52:55]
    ds_read_b64_tr_b16 v[144:145], v14 offset:8192
    v_add_u32 v253, s71, v247
    s_waitcnt lgkmcnt(7)
    ds_read_b64_tr_b16 a[28:29], v253 offset:0
    ds_read_b64_tr_b16 a[30:31], v253 offset:1024
    v_mfma_f32_16x16x32_bf16 v[56:59], v[100:103], v[112:115], v[56:59]
    ds_read_b64_tr_b16 v[146:147], v14 offset:9216
    ds_read_b64_tr_b16 v[148:149], v15 offset:8192
    v_mfma_f32_16x16x32_bf16 v[60:63], v[100:103], v[116:119], v[60:63]
    ds_read_b64_tr_b16 v[150:151], v15 offset:9216
    v_mfma_f32_16x16x32_bf16 v[64:67], v[104:107], v[112:115], v[64:67]
    v_mfma_f32_16x16x32_bf16 v[68:71], v[104:107], v[116:119], v[68:71]
    v_mfma_f32_16x16x32_bf16 v[72:75], v[108:111], v[112:115], v[72:75]
    v_mfma_f32_16x16x32_bf16 v[76:79], v[108:111], v[116:119], v[76:79]
    s_waitcnt lgkmcnt(0)
    s_waitcnt vmcnt(16)
    s_barrier
    v_mfma_f32_16x16x32_bf16 v[16:19], v[120:123], v[152:155], v[16:19]
    ds_read_b128 v[112:115], v232 offset:4096
    ds_read_b128 v[116:119], v232 offset:6144
    s_add_u32 m0, s81, 0
    s_add_u32 s87, s4, 65536
    buffer_load_dwordx4 v4, s[48:51], s87 offen offset:0 lds
    v_mfma_f32_16x16x32_bf16 v[20:23], v[120:123], v[156:159], v[20:23]
    ds_read_b64_tr_b16 v[80:81], v8 offset:16384
    buffer_load_dwordx4 v5, s[48:51], s87 offen offset:1024 lds
    v_mfma_f32_16x16x32_bf16 v[24:27], v[124:127], v[152:155], v[24:27]
    ds_read_b64_tr_b16 v[82:83], v8 offset:17408
    buffer_load_dwordx4 v6, s[48:51], s87 offen offset:2048 lds
    v_mfma_f32_16x16x32_bf16 v[28:31], v[124:127], v[156:159], v[28:31]
    ds_read_b64_tr_b16 v[84:85], v9 offset:16384
    buffer_load_dwordx4 v7, s[48:51], s87 offen offset:3072 lds
    v_mfma_f32_16x16x32_bf16 v[32:35], v[128:131], v[152:155], v[32:35]
    ds_read_b64_tr_b16 v[86:87], v9 offset:17408
    s_add_u32 m0, s78, 0
    s_add_u32 s87, s4, 81920
    buffer_load_dwordx4 v4, s[48:51], s87 offen offset:0 lds
    v_mfma_f32_16x16x32_bf16 v[36:39], v[128:131], v[156:159], v[36:39]
    ds_read_b64_tr_b16 v[88:89], v10 offset:16384
    buffer_load_dwordx4 v5, s[48:51], s87 offen offset:1024 lds
    v_mfma_f32_16x16x32_bf16 v[40:43], v[132:135], v[152:155], v[40:43]
    ds_read_b64_tr_b16 v[90:91], v10 offset:17408
    buffer_load_dwordx4 v6, s[48:51], s87 offen offset:2048 lds
    v_mfma_f32_16x16x32_bf16 v[44:47], v[132:135], v[156:159], v[44:47]
    ds_read_b64_tr_b16 v[92:93], v11 offset:16384
    buffer_load_dwordx4 v7, s[48:51], s87 offen offset:3072 lds
    v_mfma_f32_16x16x32_bf16 v[48:51], v[136:139], v[152:155], v[48:51]
    ds_read_b64_tr_b16 v[94:95], v11 offset:17408
    ds_read_b64_tr_b16 v[96:97], v12 offset:16384
    v_mfma_f32_16x16x32_bf16 v[52:55], v[136:139], v[156:159], v[52:55]
    ds_read_b64_tr_b16 v[98:99], v12 offset:17408
    v_mfma_f32_16x16x32_bf16 v[56:59], v[140:143], v[152:155], v[56:59]
    ds_read_b64_tr_b16 v[100:101], v13 offset:16384
    v_mfma_f32_16x16x32_bf16 v[60:63], v[140:143], v[156:159], v[60:63]
    ds_read_b64_tr_b16 v[102:103], v13 offset:17408
    v_mfma_f32_16x16x32_bf16 v[64:67], v[144:147], v[152:155], v[64:67]
    ds_read_b64_tr_b16 v[104:105], v14 offset:16384
    v_mfma_f32_16x16x32_bf16 v[68:71], v[144:147], v[156:159], v[68:71]
    s_waitcnt lgkmcnt(7)
    ds_read_b64_tr_b16 v[106:107], v14 offset:17408
    v_mfma_f32_16x16x32_bf16 v[72:75], v[148:151], v[152:155], v[72:75]
    ds_read_b64_tr_b16 v[108:109], v15 offset:16384
    v_mfma_f32_16x16x32_bf16 v[76:79], v[148:151], v[156:159], v[76:79]
    ds_read_b64_tr_b16 v[110:111], v15 offset:17408
    v_mfma_f32_16x16x32_bf16 v[16:19], v[80:83], v[112:115], v[16:19]
    ds_read_b128 v[152:155], v233 offset:4096
    ds_read_b128 v[156:159], v233 offset:6144
    v_mfma_f32_16x16x32_bf16 v[20:23], v[80:83], v[116:119], v[20:23]
    ds_read_b64_tr_b16 v[120:121], v8 offset:24576
    v_mfma_f32_16x16x32_bf16 v[24:27], v[84:87], v[112:115], v[24:27]
    ds_read_b64_tr_b16 v[122:123], v8 offset:25600
    ds_read_b64_tr_b16 v[124:125], v9 offset:24576
    v_mfma_f32_16x16x32_bf16 v[28:31], v[84:87], v[116:119], v[28:31]
    s_waitcnt lgkmcnt(7)
    ds_read_b64_tr_b16 v[126:127], v9 offset:25600
    v_mfma_f32_16x16x32_bf16 v[32:35], v[88:91], v[112:115], v[32:35]
    ds_read_b64_tr_b16 v[128:129], v10 offset:24576
    ds_read_b64_tr_b16 v[130:131], v10 offset:25600
    v_mfma_f32_16x16x32_bf16 v[36:39], v[88:91], v[116:119], v[36:39]
    ds_read_b64_tr_b16 v[132:133], v11 offset:24576
    v_mfma_f32_16x16x32_bf16 v[40:43], v[92:95], v[112:115], v[40:43]
    ds_read_b64_tr_b16 v[134:135], v11 offset:25600
    ds_read_b64_tr_b16 v[136:137], v12 offset:24576
    v_mfma_f32_16x16x32_bf16 v[44:47], v[92:95], v[116:119], v[44:47]
    ds_read_b64_tr_b16 v[138:139], v12 offset:25600
    v_mfma_f32_16x16x32_bf16 v[48:51], v[96:99], v[112:115], v[48:51]
    ds_read_b64_tr_b16 v[140:141], v13 offset:24576
    s_waitcnt lgkmcnt(7)
    ds_read_b64_tr_b16 v[142:143], v13 offset:25600
    v_mfma_f32_16x16x32_bf16 v[52:55], v[96:99], v[116:119], v[52:55]
    ds_read_b64_tr_b16 v[144:145], v14 offset:24576
    v_mfma_f32_16x16x32_bf16 v[56:59], v[100:103], v[112:115], v[56:59]
    ds_read_b64_tr_b16 v[146:147], v14 offset:25600
    ds_read_b64_tr_b16 v[148:149], v15 offset:24576
    v_mfma_f32_16x16x32_bf16 v[60:63], v[100:103], v[116:119], v[60:63]
    ds_read_b64_tr_b16 v[150:151], v15 offset:25600
    v_mfma_f32_16x16x32_bf16 v[64:67], v[104:107], v[112:115], v[64:67]
    v_mfma_f32_16x16x32_bf16 v[68:71], v[104:107], v[116:119], v[68:71]
    v_mfma_f32_16x16x32_bf16 v[72:75], v[108:111], v[112:115], v[72:75]
    v_mfma_f32_16x16x32_bf16 v[76:79], v[108:111], v[116:119], v[76:79]
    s_waitcnt lgkmcnt(0)
    s_waitcnt vmcnt(16)
    s_barrier
    v_mfma_f32_16x16x32_bf16 v[16:19], v[120:123], v[152:155], v[16:19]
    ds_read_b128 v[112:115], v232 offset:8192
    ds_read_b128 v[116:119], v232 offset:10240
    v_mfma_f32_16x16x32_bf16 v[20:23], v[120:123], v[156:159], v[20:23]
    ds_read_b64_tr_b16 v[80:81], v8 offset:32768
    v_mfma_f32_16x16x32_bf16 v[24:27], v[124:127], v[152:155], v[24:27]
    ds_read_b64_tr_b16 v[82:83], v8 offset:33792
    v_mfma_f32_16x16x32_bf16 v[28:31], v[124:127], v[156:159], v[28:31]
    ds_read_b64_tr_b16 v[84:85], v9 offset:32768
    v_mfma_f32_16x16x32_bf16 v[32:35], v[128:131], v[152:155], v[32:35]
    ds_read_b64_tr_b16 v[86:87], v9 offset:33792
    v_mfma_f32_16x16x32_bf16 v[36:39], v[128:131], v[156:159], v[36:39]
    ds_read_b64_tr_b16 v[88:89], v10 offset:32768
    v_mfma_f32_16x16x32_bf16 v[40:43], v[132:135], v[152:155], v[40:43]
    ds_read_b64_tr_b16 v[90:91], v10 offset:33792
    v_mfma_f32_16x16x32_bf16 v[44:47], v[132:135], v[156:159], v[44:47]
    ds_read_b64_tr_b16 v[92:93], v11 offset:32768
    v_mfma_f32_16x16x32_bf16 v[48:51], v[136:139], v[152:155], v[48:51]
    ds_read_b64_tr_b16 v[94:95], v11 offset:33792
    ds_read_b64_tr_b16 v[96:97], v12 offset:32768
    v_mfma_f32_16x16x32_bf16 v[52:55], v[136:139], v[156:159], v[52:55]
    ds_read_b64_tr_b16 v[98:99], v12 offset:33792
    v_mfma_f32_16x16x32_bf16 v[56:59], v[140:143], v[152:155], v[56:59]
    ds_read_b64_tr_b16 v[100:101], v13 offset:32768
    v_mfma_f32_16x16x32_bf16 v[60:63], v[140:143], v[156:159], v[60:63]
    ds_read_b64_tr_b16 v[102:103], v13 offset:33792
    v_mfma_f32_16x16x32_bf16 v[64:67], v[144:147], v[152:155], v[64:67]
    ds_read_b64_tr_b16 v[104:105], v14 offset:32768
    v_mfma_f32_16x16x32_bf16 v[68:71], v[144:147], v[156:159], v[68:71]
    s_waitcnt lgkmcnt(7)
    ds_read_b64_tr_b16 v[106:107], v14 offset:33792
    v_mfma_f32_16x16x32_bf16 v[72:75], v[148:151], v[152:155], v[72:75]
    ds_read_b64_tr_b16 v[108:109], v15 offset:32768
    v_mfma_f32_16x16x32_bf16 v[76:79], v[148:151], v[156:159], v[76:79]
    ds_read_b64_tr_b16 v[110:111], v15 offset:33792
    v_mfma_f32_16x16x32_bf16 v[16:19], v[80:83], v[112:115], v[16:19]
    ds_read_b128 v[152:155], v233 offset:8192
    ds_read_b128 v[156:159], v233 offset:10240
    v_mfma_f32_16x16x32_bf16 v[20:23], v[80:83], v[116:119], v[20:23]
    ds_read_b64_tr_b16 v[120:121], v8 offset:40960
    v_mfma_f32_16x16x32_bf16 v[24:27], v[84:87], v[112:115], v[24:27]
    ds_read_b64_tr_b16 v[122:123], v8 offset:41984
    ds_read_b64_tr_b16 v[124:125], v9 offset:40960
    v_mfma_f32_16x16x32_bf16 v[28:31], v[84:87], v[116:119], v[28:31]
    s_waitcnt lgkmcnt(7)
    ds_read_b64_tr_b16 v[126:127], v9 offset:41984
    v_mfma_f32_16x16x32_bf16 v[32:35], v[88:91], v[112:115], v[32:35]
    ds_read_b64_tr_b16 v[128:129], v10 offset:40960
    ds_read_b64_tr_b16 v[130:131], v10 offset:41984
    v_mfma_f32_16x16x32_bf16 v[36:39], v[88:91], v[116:119], v[36:39]
    ds_read_b64_tr_b16 v[132:133], v11 offset:40960
    v_mfma_f32_16x16x32_bf16 v[40:43], v[92:95], v[112:115], v[40:43]
    ds_read_b64_tr_b16 v[134:135], v11 offset:41984
    ds_read_b64_tr_b16 v[136:137], v12 offset:40960
    v_mfma_f32_16x16x32_bf16 v[44:47], v[92:95], v[116:119], v[44:47]
    ds_read_b64_tr_b16 v[138:139], v12 offset:41984
    v_mfma_f32_16x16x32_bf16 v[48:51], v[96:99], v[112:115], v[48:51]
    ds_read_b64_tr_b16 v[140:141], v13 offset:40960
    s_waitcnt lgkmcnt(7)
    ds_read_b64_tr_b16 v[142:143], v13 offset:41984
    v_mfma_f32_16x16x32_bf16 v[52:55], v[96:99], v[116:119], v[52:55]
    ds_read_b64_tr_b16 v[144:145], v14 offset:40960
    v_mfma_f32_16x16x32_bf16 v[56:59], v[100:103], v[112:115], v[56:59]
    ds_read_b64_tr_b16 v[146:147], v14 offset:41984
    ds_read_b64_tr_b16 v[148:149], v15 offset:40960
    v_mfma_f32_16x16x32_bf16 v[60:63], v[100:103], v[116:119], v[60:63]
    ds_read_b64_tr_b16 v[150:151], v15 offset:41984
    v_mfma_f32_16x16x32_bf16 v[64:67], v[104:107], v[112:115], v[64:67]
    v_mfma_f32_16x16x32_bf16 v[68:71], v[104:107], v[116:119], v[68:71]
    v_mfma_f32_16x16x32_bf16 v[72:75], v[108:111], v[112:115], v[72:75]
    v_mfma_f32_16x16x32_bf16 v[76:79], v[108:111], v[116:119], v[76:79]
    s_waitcnt lgkmcnt(0)
    s_waitcnt vmcnt(8)
    s_barrier
    v_mfma_f32_16x16x32_bf16 v[16:19], v[120:123], v[152:155], v[16:19]
    ds_read_b128 v[112:115], v232 offset:12288
    ds_read_b128 v[116:119], v232 offset:14336
    v_mfma_f32_16x16x32_bf16 v[20:23], v[120:123], v[156:159], v[20:23]
    ds_read_b64_tr_b16 v[80:81], v8 offset:49152
    v_mfma_f32_16x16x32_bf16 v[24:27], v[124:127], v[152:155], v[24:27]
    ds_read_b64_tr_b16 v[82:83], v8 offset:50176
    v_mfma_f32_16x16x32_bf16 v[28:31], v[124:127], v[156:159], v[28:31]
    ds_read_b64_tr_b16 v[84:85], v9 offset:49152
    v_mfma_f32_16x16x32_bf16 v[32:35], v[128:131], v[152:155], v[32:35]
    ds_read_b64_tr_b16 v[86:87], v9 offset:50176
    v_mfma_f32_16x16x32_bf16 v[36:39], v[128:131], v[156:159], v[36:39]
    ds_read_b64_tr_b16 v[88:89], v10 offset:49152
    v_mfma_f32_16x16x32_bf16 v[40:43], v[132:135], v[152:155], v[40:43]
    ds_read_b64_tr_b16 v[90:91], v10 offset:50176
    v_mfma_f32_16x16x32_bf16 v[44:47], v[132:135], v[156:159], v[44:47]
    ds_read_b64_tr_b16 v[92:93], v11 offset:49152
    v_mfma_f32_16x16x32_bf16 v[48:51], v[136:139], v[152:155], v[48:51]
    ds_read_b64_tr_b16 v[94:95], v11 offset:50176
    ds_read_b64_tr_b16 v[96:97], v12 offset:49152
    v_mfma_f32_16x16x32_bf16 v[52:55], v[136:139], v[156:159], v[52:55]
    ds_read_b64_tr_b16 v[98:99], v12 offset:50176
    v_mfma_f32_16x16x32_bf16 v[56:59], v[140:143], v[152:155], v[56:59]
    ds_read_b64_tr_b16 v[100:101], v13 offset:49152
    v_mfma_f32_16x16x32_bf16 v[60:63], v[140:143], v[156:159], v[60:63]
    ds_read_b64_tr_b16 v[102:103], v13 offset:50176
    v_mfma_f32_16x16x32_bf16 v[64:67], v[144:147], v[152:155], v[64:67]
    ds_read_b64_tr_b16 v[104:105], v14 offset:49152
    v_mfma_f32_16x16x32_bf16 v[68:71], v[144:147], v[156:159], v[68:71]
    s_waitcnt lgkmcnt(7)
    ds_read_b64_tr_b16 v[106:107], v14 offset:50176
    v_mfma_f32_16x16x32_bf16 v[72:75], v[148:151], v[152:155], v[72:75]
    ds_read_b64_tr_b16 v[108:109], v15 offset:49152
    v_mfma_f32_16x16x32_bf16 v[76:79], v[148:151], v[156:159], v[76:79]
    ds_read_b64_tr_b16 v[110:111], v15 offset:50176
    v_mfma_f32_16x16x32_bf16 v[16:19], v[80:83], v[112:115], v[16:19]
    ds_read_b128 v[152:155], v233 offset:12288
    ds_read_b128 v[156:159], v233 offset:14336
    v_mfma_f32_16x16x32_bf16 v[20:23], v[80:83], v[116:119], v[20:23]
    ds_read_b64_tr_b16 v[120:121], v8 offset:57344
    v_mfma_f32_16x16x32_bf16 v[24:27], v[84:87], v[112:115], v[24:27]
    ds_read_b64_tr_b16 v[122:123], v8 offset:58368
    ds_read_b64_tr_b16 v[124:125], v9 offset:57344
    v_mfma_f32_16x16x32_bf16 v[28:31], v[84:87], v[116:119], v[28:31]
    s_waitcnt lgkmcnt(7)
    ds_read_b64_tr_b16 v[126:127], v9 offset:58368
    v_mfma_f32_16x16x32_bf16 v[32:35], v[88:91], v[112:115], v[32:35]
    ds_read_b64_tr_b16 v[128:129], v10 offset:57344
    ds_read_b64_tr_b16 v[130:131], v10 offset:58368
    v_mfma_f32_16x16x32_bf16 v[36:39], v[88:91], v[116:119], v[36:39]
    ds_read_b64_tr_b16 v[132:133], v11 offset:57344
    v_mfma_f32_16x16x32_bf16 v[40:43], v[92:95], v[112:115], v[40:43]
    ds_read_b64_tr_b16 v[134:135], v11 offset:58368
    ds_read_b64_tr_b16 v[136:137], v12 offset:57344
    v_mfma_f32_16x16x32_bf16 v[44:47], v[92:95], v[116:119], v[44:47]
    ds_read_b64_tr_b16 v[138:139], v12 offset:58368
    v_mfma_f32_16x16x32_bf16 v[48:51], v[96:99], v[112:115], v[48:51]
    ds_read_b64_tr_b16 v[140:141], v13 offset:57344
    s_waitcnt lgkmcnt(7)
    ds_read_b64_tr_b16 v[142:143], v13 offset:58368
    v_mfma_f32_16x16x32_bf16 v[52:55], v[96:99], v[116:119], v[52:55]
    ds_read_b64_tr_b16 v[144:145], v14 offset:57344
    v_mfma_f32_16x16x32_bf16 v[56:59], v[100:103], v[112:115], v[56:59]
    ds_read_b64_tr_b16 v[146:147], v14 offset:58368
    ds_read_b64_tr_b16 v[148:149], v15 offset:57344
    v_mfma_f32_16x16x32_bf16 v[60:63], v[100:103], v[116:119], v[60:63]
    ds_read_b64_tr_b16 v[150:151], v15 offset:58368
    v_mfma_f32_16x16x32_bf16 v[64:67], v[104:107], v[112:115], v[64:67]
    v_mfma_f32_16x16x32_bf16 v[68:71], v[104:107], v[116:119], v[68:71]
    v_mfma_f32_16x16x32_bf16 v[72:75], v[108:111], v[112:115], v[72:75]
    v_mfma_f32_16x16x32_bf16 v[76:79], v[108:111], v[116:119], v[76:79]
    s_branch L_common
L_p1_2:
    s_waitcnt vmcnt(9)
    s_barrier
    ds_read_b128 v[112:115], v232 offset:0
    ds_read_b128 v[116:119], v232 offset:2048
    s_add_u32 m0, s78, 8192
    s_add_u32 s87, s92, 128
    buffer_load_dwordx4 v228, s[32:35], s87 offen offset:0 lds
    ds_read_b64_tr_b16 v[80:81], v8 offset:0
    buffer_load_dwordx4 v229, s[32:35], s87 offen offset:1024 lds
    ds_read_b64_tr_b16 v[82:83], v8 offset:1024
    buffer_load_dwordx4 v230, s[32:35], s87 offen offset:2048 lds
    ds_read_b64_tr_b16 v[84:85], v9 offset:0
    v_lshrrev_b32 v254, 4, v0
    v_bfe_u32 v255, v0, 2, 2
    v_xor_b32 v255, v255, v254
    ds_read_b64_tr_b16 v[86:87], v9 offset:1024
    v_lshlrev_b32 v255, 6, v255
    v_lshl_add_u32 v4, v254, 11, v255
    v_and_b32 v255, 3, v0
    ds_read_b64_tr_b16 v[88:89], v10 offset:0
    buffer_load_dwordx4 v231, s[32:35], s87 offen offset:3072 lds
    ds_read_b64_tr_b16 v[90:91], v10 offset:1024
    v_lshl_add_u32 v4, v255, 4, v4
    v_add_u32 v5, 31744, v4
    v_add_u32 v6, 6144, v4
    ds_read_b64_tr_b16 v[92:93], v11 offset:0
    s_add_u32 m0, s81, 32768
    s_add_u32 s87, s88, 524288
    buffer_load_dwordx4 v224, s[44:47], s87 offen offset:0 lds
    ds_read_b64_tr_b16 v[94:95], v11 offset:1024
    ds_read_b64_tr_b16 v[96:97], v12 offset:0
    v_add_u32 v7, 37888, v4
    v_bfe_u32 v251, v0, 2, 2
    v_lshrrev_b32 v254, 5, v0
    ds_read_b64_tr_b16 v[98:99], v12 offset:1024
    v_lshl_add_u32 v254, v254, 3, v251
    v_lshlrev_b32 v250, 8, v254
    v_bfe_u32 v254, v0, 4, 1
    ds_read_b64_tr_b16 v[100:101], v13 offset:0
    buffer_load_dwordx4 v225, s[44:47], s87 offen offset:1024 lds
    ds_read_b64_tr_b16 v[102:103], v13 offset:1024
    v_lshl_add_u32 v250, v254, 5, v250
    v_and_b32 v254, 1, v0
    v_lshl_add_u32 v250, v254, 4, v250
    ds_read_b64_tr_b16 v[104:105], v14 offset:0
    v_bfe_u32 v254, v0, 1, 1
    v_lshl_add_u32 v250, v254, 3, v250
    s_add_u32 s100, s64, 0
    s_waitcnt lgkmcnt(7)
    ds_read_b64_tr_b16 v[106:107], v14 offset:1024
    buffer_load_dwordx4 v226, s[44:47], s87 offen offset:2048 lds
    ds_read_b64_tr_b16 v[108:109], v15 offset:0
    s_and_b32 s100, s100, 3
    v_xor_b32 v254, s100, v251
    v_lshl_add_u32 v244, v254, 6, v250
    ds_read_b64_tr_b16 v[110:111], v15 offset:1024
    buffer_load_dwordx4 v227, s[44:47], s87 offen offset:3072 lds
    v_mfma_f32_16x16x32_bf16 v[16:19], v[80:83], v[112:115], 0
    ds_read_b128 v[152:155], v233 offset:0
    ds_read_b128 v[156:159], v233 offset:2048
    s_add_u32 s100, s64, 1
    v_mfma_f32_16x16x32_bf16 v[20:23], v[80:83], v[116:119], 0
    ds_read_b64_tr_b16 v[120:121], v8 offset:8192
    s_and_b32 s100, s100, 3
    v_mfma_f32_16x16x32_bf16 v[24:27], v[84:87], v[112:115], 0
    ds_read_b64_tr_b16 v[122:123], v8 offset:9216
    ds_read_b64_tr_b16 v[124:125], v9 offset:8192
    s_add_u32 m0, s78, 12288
    s_add_u32 s87, s92, 384
    buffer_load_dwordx4 v228, s[32:35], s87 offen offset:0 lds
    v_mfma_f32_16x16x32_bf16 v[28:31], v[84:87], v[116:119], 0
    s_waitcnt lgkmcnt(7)
    ds_read_b64_tr_b16 v[126:127], v9 offset:9216
    v_xor_b32 v254, s100, v251
    v_mfma_f32_16x16x32_bf16 v[32:35], v[88:91], v[112:115], 0
    ds_read_b64_tr_b16 v[128:129], v10 offset:8192
    ds_read_b64_tr_b16 v[130:131], v10 offset:9216
    v_lshl_add_u32 v245, v254, 6, v250
    v_mfma_f32_16x16x32_bf16 v[36:39], v[88:91], v[116:119], 0
    ds_read_b64_tr_b16 v[132:133], v11 offset:8192
    buffer_load_dwordx4 v229, s[32:35], s87 offen offset:1024 lds
    v_mfma_f32_16x16x32_bf16 v[40:43], v[92:95], v[112:115], 0
    ds_read_b64_tr_b16 v[134:135], v11 offset:9216
    ds_read_b64_tr_b16 v[136:137], v12 offset:8192
    s_add_u32 s100, s64, 2
    v_mfma_f32_16x16x32_bf16 v[44:47], v[92:95], v[116:119], 0
    ds_read_b64_tr_b16 v[138:139], v12 offset:9216
    buffer_load_dwordx4 v230, s[32:35], s87 offen offset:2048 lds
    v_mfma_f32_16x16x32_bf16 v[48:51], v[96:99], v[112:115], 0
    ds_read_b64_tr_b16 v[140:141], v13 offset:8192
    s_waitcnt lgkmcnt(7)
    ds_read_b64_tr_b16 v[142:143], v13 offset:9216
    s_and_b32 s100, s100, 3
    v_mfma_f32_16x16x32_bf16 v[52:55], v[96:99], v[116:119], 0
    ds_read_b64_tr_b16 v[144:145], v14 offset:8192
    v_xor_b32 v254, s100, v251
    v_mfma_f32_16x16x32_bf16 v[56:59], v[100:103], v[112:115], 0
    ds_read_b64_tr_b16 v[146:147], v14 offset:9216
    ds_read_b64_tr_b16 v[148:149], v15 offset:8192
    buffer_load_dwordx4 v231, s[32:35], s87 offen offset:3072 lds
    v_mfma_f32_16x16x32_bf16 v[60:63], v[100:103], v[116:119], 0
    ds_read_b64_tr_b16 v[150:151], v15 offset:9216
    v_lshl_add_u32 v246, v254, 6, v250
    v_mfma_f32_16x16x32_bf16 v[64:67], v[104:107], v[112:115], 0
    s_add_u32 s100, s64, 3
    v_mfma_f32_16x16x32_bf16 v[68:71], v[104:107], v[116:119], 0
    s_add_u32 m0, s81, 49152
    s_add_u32 s87, s88, 1572864
    buffer_load_dwordx4 v224, s[44:47], s87 offen offset:0 lds
    v_mfma_f32_16x16x32_bf16 v[72:75], v[108:111], v[112:115], 0
    s_and_b32 s100, s100, 3
    v_mfma_f32_16x16x32_bf16 v[76:79], v[108:111], v[116:119], 0
    buffer_load_dwordx4 v225, s[44:47], s87 offen offset:1024 lds
    s_waitcnt lgkmcnt(0)
    s_waitcnt vmcnt(15)
    s_barrier
    v_mfma_f32_16x16x32_bf16 v[16:19], v[120:123], v[152:155], v[16:19]
    ds_read_b128 v[112:115], v232 offset:4096
    ds_read_b128 v[116:119], v232 offset:6144
    v_xor_b32 v254, s100, v251
    v_mfma_f32_16x16x32_bf16 v[20:23], v[120:123], v[156:159], v[20:23]
    ds_read_b64_tr_b16 v[80:81], v8 offset:16384
    v_lshl_add_u32 v247, v254, 6, v250
    v_mfma_f32_16x16x32_bf16 v[24:27], v[124:127], v[152:155], v[24:27]
    ds_read_b64_tr_b16 v[82:83], v8 offset:17408
    buffer_load_dwordx4 v226, s[44:47], s87 offen offset:2048 lds
    v_mfma_f32_16x16x32_bf16 v[28:31], v[124:127], v[156:159], v[28:31]
    ds_read_b64_tr_b16 v[84:85], v9 offset:16384
    v_and_b32 v254, 3, v0
    v_mfma_f32_16x16x32_bf16 v[32:35], v[128:131], v[152:155], v[32:35]
    ds_read_b64_tr_b16 v[86:87], v9 offset:17408
    v_lshl_add_u32 v254, v251, 3, v254
    v_mfma_f32_16x16x32_bf16 v[36:39], v[128:131], v[156:159], v[36:39]
    ds_read_b64_tr_b16 v[88:89], v10 offset:16384
    buffer_load_dwordx4 v227, s[44:47], s87 offen offset:3072 lds
    v_mfma_f32_16x16x32_bf16 v[40:43], v[132:135], v[152:155], v[40:43]
    ds_read_b64_tr_b16 v[90:91], v10 offset:17408
    v_and_b32 v255, 15, v254
    v_mfma_f32_16x16x32_bf16 v[44:47], v[132:135], v[156:159], v[44:47]
    ds_read_b64_tr_b16 v[92:93], v11 offset:16384
    s_add_u32 m0, s78, 0
    s_add_u32 s87, s92, 768
    buffer_load_dwordx4 v228, s[32:35], s87 offen offset:0 lds
    v_mfma_f32_16x16x32_bf16 v[48:51], v[136:139], v[152:155], v[48:51]
    ds_read_b64_tr_b16 v[94:95], v11 offset:17408
    ds_read_b64_tr_b16 v[96:97], v12 offset:16384
    v_lshrrev_b32 v248, 5, v0
    v_mfma_f32_16x16x32_bf16 v[52:55], v[136:139], v[156:159], v[52:55]
    ds_read_b64_tr_b16 v[98:99], v12 offset:17408
    v_xor_b32 v255, v255, v248
    v_mfma_f32_16x16x32_bf16 v[56:59], v[140:143], v[152:155], v[56:59]
    ds_read_b64_tr_b16 v[100:101], v13 offset:16384
    buffer_load_dwordx4 v229, s[32:35], s87 offen offset:1024 lds
    v_mfma_f32_16x16x32_bf16 v[60:63], v[140:143], v[156:159], v[60:63]
    ds_read_b64_tr_b16 v[102:103], v13 offset:17408
    v_lshlrev_b32 v255, 4, v255
    v_mfma_f32_16x16x32_bf16 v[64:67], v[144:147], v[152:155], v[64:67]
    ds_read_b64_tr_b16 v[104:105], v14 offset:16384
    v_lshl_add_u32 v254, v254, 8, v255
    v_mfma_f32_16x16x32_bf16 v[68:71], v[144:147], v[156:159], v[68:71]
    s_waitcnt lgkmcnt(7)
    ds_read_b64_tr_b16 v[106:107], v14 offset:17408
    buffer_load_dwordx4 v230, s[32:35], s87 offen offset:2048 lds
    v_mfma_f32_16x16x32_bf16 v[72:75], v[148:151], v[152:155], v[72:75]
    ds_read_b64_tr_b16 v[108:109], v15 offset:16384
    v_bfe_u32 v255, v0, 4, 1
    v_mfma_f32_16x16x32_bf16 v[76:79], v[148:151], v[156:159], v[76:79]
    ds_read_b64_tr_b16 v[110:111], v15 offset:17408
    buffer_load_dwordx4 v231, s[32:35], s87 offen offset:3072 lds
    v_mfma_f32_16x16x32_bf16 v[16:19], v[80:83], v[112:115], v[16:19]
    ds_read_b128 v[152:155], v233 offset:4096
    ds_read_b128 v[156:159], v233 offset:6144
    v_lshl_add_u32 v254, v255, 3, v254
    v_mfma_f32_16x16x32_bf16 v[20:23], v[80:83], v[116:119], v[20:23]
    ds_read_b64_tr_b16 v[120:121], v8 offset:24576
    s_add_u32 s100, s82, 131072
    v_mfma_f32_16x16x32_bf16 v[24:27], v[84:87], v[112:115], v[24:27]
    ds_read_b64_tr_b16 v[122:123], v8 offset:25600
    ds_read_b64_tr_b16 v[124:125], v9 offset:24576
    s_add_u32 m0, s81, 0
    s_add_u32 s87, s88, 3145728
    buffer_load_dwordx4 v224, s[44:47], s87 offen offset:0 lds
    v_mfma_f32_16x16x32_bf16 v[28:31], v[84:87], v[116:119], v[28:31]
    s_waitcnt lgkmcnt(7)
    ds_read_b64_tr_b16 v[126:127], v9 offset:25600
    v_add_u32 v248, s100, v254
    v_mfma_f32_16x16x32_bf16 v[32:35], v[88:91], v[112:115], v[32:35]
    ds_read_b64_tr_b16 v[128:129], v10 offset:24576
    ds_read_b64_tr_b16 v[130:131], v10 offset:25600
    v_lshlrev_b32 v249, 4, v0
    v_mfma_f32_16x16x32_bf16 v[36:39], v[88:91], v[116:119], v[36:39]
    ds_read_b64_tr_b16 v[132:133], v11 offset:24576
    buffer_load_dwordx4 v225, s[44:47], s87 offen offset:1024 lds
    v_mfma_f32_16x16x32_bf16 v[40:43], v[92:95], v[112:115], v[40:43]
    ds_read_b64_tr_b16 v[134:135], v11 offset:25600
    ds_read_b64_tr_b16 v[136:137], v12 offset:24576
    v_mov_b32 v241, 0
    v_mfma_f32_16x16x32_bf16 v[44:47], v[92:95], v[116:119], v[44:47]
    ds_read_b64_tr_b16 v[138:139], v12 offset:25600
    buffer_load_dwordx4 v226, s[44:47], s87 offen offset:2048 lds
    v_mfma_f32_16x16x32_bf16 v[48:51], v[96:99], v[112:115], v[48:51]
    ds_read_b64_tr_b16 v[140:141], v13 offset:24576
    s_waitcnt lgkmcnt(7)
    ds_read_b64_tr_b16 v[142:143], v13 offset:25600
    s_lshl_b32 s98, s66, 2
    v_mfma_f32_16x16x32_bf16 v[52:55], v[96:99], v[116:119], v[52:55]
    ds_read_b64_tr_b16 v[144:145], v14 offset:24576
    s_add_u32 s98, s98, s64
    v_mfma_f32_16x16x32_bf16 v[56:59], v[100:103], v[112:115], v[56:59]
    ds_read_b64_tr_b16 v[146:147], v14 offset:25600
    ds_read_b64_tr_b16 v[148:149], v15 offset:24576
    buffer_load_dwordx4 v227, s[44:47], s87 offen offset:3072 lds
    v_mfma_f32_16x16x32_bf16 v[60:63], v[100:103], v[116:119], v[60:63]
    ds_read_b64_tr_b16 v[150:151], v15 offset:25600
    s_lshl_b32 s99, s98, 19
    v_mfma_f32_16x16x32_bf16 v[64:67], v[104:107], v[112:115], v[64:67]
    s_add_u32 s83, s67, 1
    v_mfma_f32_16x16x32_bf16 v[68:71], v[104:107], v[116:119], v[68:71]
    s_add_u32 m0, s82, 131072
    s_add_u32 s87, s80, 0
    v_xor_b32 v240, 0, v2
    buffer_load_dwordx4 v240, s[36:39], s87 offen offset:0 nt lds
    v_mfma_f32_16x16x32_bf16 v[72:75], v[108:111], v[112:115], v[72:75]
    s_and_b32 s83, s83, 7
    v_mfma_f32_16x16x32_bf16 v[76:79], v[108:111], v[116:119], v[76:79]
    v_xor_b32 v240, 64, v2
    buffer_load_dwordx4 v240, s[36:39], s87 offen offset:1024 nt lds
    s_waitcnt lgkmcnt(0)
    s_waitcnt vmcnt(18)
    s_barrier
    v_mfma_f32_16x16x32_bf16 v[16:19], v[120:123], v[152:155], v[16:19]
    ds_read_b128 v[112:115], v232 offset:8192
    ds_read_b128 v[116:119], v232 offset:10240
    s_lshl_b32 s100, s83, 8
    v_mfma_f32_16x16x32_bf16 v[20:23], v[120:123], v[156:159], v[20:23]
    ds_read_b64_tr_b16 v[80:81], v8 offset:32768
    s_add_u32 s99, s99, s100
    v_mfma_f32_16x16x32_bf16 v[24:27], v[124:127], v[152:155], v[24:27]
    ds_read_b64_tr_b16 v[82:83], v8 offset:33792
    v_xor_b32 v240, 128, v2
    buffer_load_dwordx4 v240, s[36:39], s87 offen offset:2048 nt lds
    v_mfma_f32_16x16x32_bf16 v[28:31], v[124:127], v[156:159], v[28:31]
    ds_read_b64_tr_b16 v[84:85], v9 offset:32768
    s_add_u32 s100, s79, 0
    v_mfma_f32_16x16x32_bf16 v[32:35], v[128:131], v[152:155], v[32:35]
    ds_read_b64_tr_b16 v[86:87], v9 offset:33792
    s_and_b32 s100, s100, 3
    v_mfma_f32_16x16x32_bf16 v[36:39], v[128:131], v[156:159], v[36:39]
    ds_read_b64_tr_b16 v[88:89], v10 offset:32768
    v_xor_b32 v240, 192, v2
    buffer_load_dwordx4 v240, s[36:39], s87 offen offset:3072 nt lds
    v_mfma_f32_16x16x32_bf16 v[40:43], v[132:135], v[152:155], v[40:43]
    ds_read_b64_tr_b16 v[90:91], v10 offset:33792
    s_lshl_b32 s101, s100, 17
    v_mfma_f32_16x16x32_bf16 v[44:47], v[132:135], v[156:159], v[44:47]
    ds_read_b64_tr_b16 v[92:93], v11 offset:32768
    s_add_u32 m0, s82, 135168
    s_add_u32 s87, s80, 4096
    v_xor_b32 v240, 0, v2
    buffer_load_dwordx4 v240, s[36:39], s87 offen offset:0 nt lds
    v_mfma_f32_16x16x32_bf16 v[48:51], v[136:139], v[152:155], v[48:51]
    ds_read_b64_tr_b16 v[94:95], v11 offset:33792
    ds_read_b64_tr_b16 v[96:97], v12 offset:32768
    s_add_u32 s4, s99, s101
    v_mfma_f32_16x16x32_bf16 v[52:55], v[136:139], v[156:159], v[52:55]
    ds_read_b64_tr_b16 v[98:99], v12 offset:33792
    s_lshl_b32 s8, s100, 12
    v_mfma_f32_16x16x32_bf16 v[56:59], v[140:143], v[152:155], v[56:59]
    ds_read_b64_tr_b16 v[100:101], v13 offset:32768
    v_xor_b32 v240, 64, v2
    buffer_load_dwordx4 v240, s[36:39], s87 offen offset:1024 nt lds
    v_mfma_f32_16x16x32_bf16 v[60:63], v[140:143], v[156:159], v[60:63]
    ds_read_b64_tr_b16 v[102:103], v13 offset:33792
    s_add_u32 s12, s66, 1
    v_mfma_f32_16x16x32_bf16 v[64:67], v[144:147], v[152:155], v[64:67]
    ds_read_b64_tr_b16 v[104:105], v14 offset:32768
    s_and_b32 s12, s12, 3
    v_mfma_f32_16x16x32_bf16 v[68:71], v[144:147], v[156:159], v[68:71]
    s_waitcnt lgkmcnt(7)
    ds_read_b64_tr_b16 v[106:107], v14 offset:33792
    v_xor_b32 v240, 128, v2
    buffer_load_dwordx4 v240, s[36:39], s87 offen offset:2048 nt lds
    v_mfma_f32_16x16x32_bf16 v[72:75], v[148:151], v[152:155], v[72:75]
    ds_read_b64_tr_b16 v[108:109], v15 offset:32768
    s_add_u32 s100, s79, 1
    v_mfma_f32_16x16x32_bf16 v[76:79], v[148:151], v[156:159], v[76:79]
    ds_read_b64_tr_b16 v[110:111], v15 offset:33792
    v_xor_b32 v240, 192, v2
    buffer_load_dwordx4 v240, s[36:39], s87 offen offset:3072 nt lds
    v_mfma_f32_16x16x32_bf16 v[16:19], v[80:83], v[112:115], v[16:19]
    ds_read_b128 v[152:155], v233 offset:8192
    ds_read_b128 v[156:159], v233 offset:10240
    s_and_b32 s100, s100, 3
    v_mfma_f32_16x16x32_bf16 v[20:23], v[80:83], v[116:119], v[20:23]
    ds_read_b64_tr_b16 v[120:121], v8 offset:40960
    s_lshl_b32 s101, s100, 17
    v_mfma_f32_16x16x32_bf16 v[24:27], v[84:87], v[112:115], v[24:27]
    ds_read_b64_tr_b16 v[122:123], v8 offset:41984
    ds_read_b64_tr_b16 v[124:125], v9 offset:40960
    s_add_u32 m0, s78, 4096
    s_add_u32 s87, s92, 512
    buffer_load_dwordx4 v228, s[32:35], s87 offen offset:0 lds
    v_mfma_f32_16x16x32_bf16 v[28:31], v[84:87], v[116:119], v[28:31]
    s_waitcnt lgkmcnt(7)
    ds_read_b64_tr_b16 v[126:127], v9 offset:41984
    s_add_u32 s5, s99, s101
    v_mfma_f32_16x16x32_bf16 v[32:35], v[88:91], v[112:115], v[32:35]
    ds_read_b64_tr_b16 v[128:129], v10 offset:40960
    ds_read_b64_tr_b16 v[130:131], v10 offset:41984
    s_lshl_b32 s9, s100, 12
    v_mfma_f32_16x16x32_bf16 v[36:39], v[88:91], v[116:119], v[36:39]
    ds_read_b64_tr_b16 v[132:133], v11 offset:40960
    buffer_load_dwordx4 v229, s[32:35], s87 offen offset:1024 lds
    v_mfma_f32_16x16x32_bf16 v[40:43], v[92:95], v[112:115], v[40:43]
    ds_read_b64_tr_b16 v[134:135], v11 offset:41984
    ds_read_b64_tr_b16 v[136:137], v12 offset:40960
    s_add_u32 s13, s66, 2
    v_mfma_f32_16x16x32_bf16 v[44:47], v[92:95], v[116:119], v[44:47]
    ds_read_b64_tr_b16 v[138:139], v12 offset:41984
    s_and_b32 s13, s13, 3
    v_mfma_f32_16x16x32_bf16 v[48:51], v[96:99], v[112:115], v[48:51]
    ds_read_b64_tr_b16 v[140:141], v13 offset:40960
    s_waitcnt lgkmcnt(7)
    ds_read_b64_tr_b16 v[142:143], v13 offset:41984
    buffer_load_dwordx4 v230, s[32:35], s87 offen offset:2048 lds
    v_mfma_f32_16x16x32_bf16 v[52:55], v[96:99], v[116:119], v[52:55]
    ds_read_b64_tr_b16 v[144:145], v14 offset:40960
    s_add_u32 s100, s79, 2
    v_mfma_f32_16x16x32_bf16 v[56:59], v[100:103], v[112:115], v[56:59]
    ds_read_b64_tr_b16 v[146:147], v14 offset:41984
    ds_read_b64_tr_b16 v[148:149], v15 offset:40960
    buffer_load_dwordx4 v231, s[32:35], s87 offen offset:3072 lds
    v_mfma_f32_16x16x32_bf16 v[60:63], v[100:103], v[116:119], v[60:63]
    ds_read_b64_tr_b16 v[150:151], v15 offset:41984
    s_and_b32 s100, s100, 3
    v_mfma_f32_16x16x32_bf16 v[64:67], v[104:107], v[112:115], v[64:67]
    s_lshl_b32 s101, s100, 17
    v_mfma_f32_16x16x32_bf16 v[68:71], v[104:107], v[116:119], v[68:71]
    s_add_u32 m0, s81, 16384
    s_add_u32 s87, s88, 2097152
    buffer_load_dwordx4 v224, s[44:47], s87 offen offset:0 lds
    v_mfma_f32_16x16x32_bf16 v[72:75], v[108:111], v[112:115], v[72:75]
    s_add_u32 s6, s99, s101
    v_mfma_f32_16x16x32_bf16 v[76:79], v[108:111], v[116:119], v[76:79]
    s_lshl_b32 s10, s100, 12
    s_waitcnt lgkmcnt(0)
    s_waitcnt vmcnt(21)
    s_barrier
    v_mfma_f32_16x16x32_bf16 v[16:19], v[120:123], v[152:155], v[16:19]
    ds_read_b128 v[112:115], v232 offset:12288
    ds_read_b128 v[116:119], v232 offset:14336
    buffer_load_dwordx4 v225, s[44:47], s87 offen offset:1024 lds
    v_mfma_f32_16x16x32_bf16 v[20:23], v[120:123], v[156:159], v[20:23]
    ds_read_b64_tr_b16 v[80:81], v8 offset:49152
    s_add_u32 s14, s66, 3
    v_mfma_f32_16x16x32_bf16 v[24:27], v[124:127], v[152:155], v[24:27]
    ds_read_b64_tr_b16 v[82:83], v8 offset:50176
    buffer_load_dwordx4 v226, s[44:47], s87 offen offset:2048 lds
    v_mfma_f32_16x16x32_bf16 v[28:31], v[124:127], v[156:159], v[28:31]
    ds_read_b64_tr_b16 v[84:85], v9 offset:49152
    s_and_b32 s14, s14, 3
    v_mfma_f32_16x16x32_bf16 v[32:35], v[128:131], v[152:155], v[32:35]
    ds_read_b64_tr_b16 v[86:87], v9 offset:50176
    s_add_u32 s100, s79, 3
    v_mfma_f32_16x16x32_bf16 v[36:39], v[128:131], v[156:159], v[36:39]
    ds_read_b64_tr_b16 v[88:89], v10 offset:49152
    buffer_load_dwordx4 v227, s[44:47], s87 offen offset:3072 lds
    v_mfma_f32_16x16x32_bf16 v[40:43], v[132:135], v[152:155], v[40:43]
    ds_read_b64_tr_b16 v[90:91], v10 offset:50176
    s_and_b32 s100, s100, 3
    v_mfma_f32_16x16x32_bf16 v[44:47], v[132:135], v[156:159], v[44:47]
    ds_read_b64_tr_b16 v[92:93], v11 offset:49152
    s_lshl_b32 s101, s100, 17
    v_mfma_f32_16x16x32_bf16 v[48:51], v[136:139], v[152:155], v[48:51]
    ds_read_b64_tr_b16 v[94:95], v11 offset:50176
    ds_read_b64_tr_b16 v[96:97], v12 offset:49152
    s_add_u32 m0, s78, 8192
    s_add_u32 s87, s92, 640
    buffer_load_dwordx4 v228, s[32:35], s87 offen offset:0 lds
    v_mfma_f32_16x16x32_bf16 v[52:55], v[136:139], v[156:159], v[52:55]
    ds_read_b64_tr_b16 v[98:99], v12 offset:50176
    s_add_u32 s7, s99, s101
    v_mfma_f32_16x16x32_bf16 v[56:59], v[140:143], v[152:155], v[56:59]
    ds_read_b64_tr_b16 v[100:101], v13 offset:49152
    buffer_load_dwordx4 v229, s[32:35], s87 offen offset:1024 lds
    v_mfma_f32_16x16x32_bf16 v[60:63], v[140:143], v[156:159], v[60:63]
    ds_read_b64_tr_b16 v[102:103], v13 offset:50176
    s_lshl_b32 s11, s100, 12
    v_mfma_f32_16x16x32_bf16 v[64:67], v[144:147], v[152:155], v[64:67]
    ds_read_b64_tr_b16 v[104:105], v14 offset:49152
    s_add_u32 s15, s66, 4
    v_mfma_f32_16x16x32_bf16 v[68:71], v[144:147], v[156:159], v[68:71]
    s_waitcnt lgkmcnt(7)
    ds_read_b64_tr_b16 v[106:107], v14 offset:50176
    buffer_load_dwordx4 v230, s[32:35], s87 offen offset:2048 lds
    v_mfma_f32_16x16x32_bf16 v[72:75], v[148:151], v[152:155], v[72:75]
    ds_read_b64_tr_b16 v[108:109], v15 offset:49152
    s_and_b32 s15, s15, 3
    v_mfma_f32_16x16x32_bf16 v[76:79], v[148:151], v[156:159], v[76:79]
    ds_read_b64_tr_b16 v[110:111], v15 offset:50176
    s_lshl_b32 s99, s65, 2
    v_mfma_f32_16x16x32_bf16 v[16:19], v[80:83], v[112:115], v[16:19]
    ds_read_b128 v[152:155], v233 offset:12288
    ds_read_b128 v[156:159], v233 offset:14336
    buffer_load_dwordx4 v231, s[32:35], s87 offen offset:3072 lds
    v_mfma_f32_16x16x32_bf16 v[20:23], v[80:83], v[116:119], v[20:23]
    ds_read_b64_tr_b16 v[120:121], v8 offset:57344
    s_add_u32 s99, s99, s68
    v_mfma_f32_16x16x32_bf16 v[24:27], v[84:87], v[112:115], v[24:27]
    ds_read_b64_tr_b16 v[122:123], v8 offset:58368
    ds_read_b64_tr_b16 v[124:125], v9 offset:57344
    s_add_u32 m0, s81, 32768
    s_add_u32 s87, s88, 2621440
    buffer_load_dwordx4 v224, s[44:47], s87 offen offset:0 lds
    v_mfma_f32_16x16x32_bf16 v[28:31], v[84:87], v[116:119], v[28:31]
    s_waitcnt lgkmcnt(7)
    ds_read_b64_tr_b16 v[126:127], v9 offset:58368
    s_lshl_b32 s99, s99, 21
    v_mfma_f32_16x16x32_bf16 v[32:35], v[88:91], v[112:115], v[32:35]
    ds_read_b64_tr_b16 v[128:129], v10 offset:57344
    ds_read_b64_tr_b16 v[130:131], v10 offset:58368
    s_lshl_b32 s100, s98, 14
    v_mfma_f32_16x16x32_bf16 v[36:39], v[88:91], v[116:119], v[36:39]
    ds_read_b64_tr_b16 v[132:133], v11 offset:57344
    buffer_load_dwordx4 v225, s[44:47], s87 offen offset:1024 lds
    v_mfma_f32_16x16x32_bf16 v[40:43], v[92:95], v[112:115], v[40:43]
    ds_read_b64_tr_b16 v[134:135], v11 offset:58368
    ds_read_b64_tr_b16 v[136:137], v12 offset:57344
    s_add_u32 s16, s99, s100
    v_mfma_f32_16x16x32_bf16 v[44:47], v[92:95], v[116:119], v[44:47]
    ds_read_b64_tr_b16 v[138:139], v12 offset:58368
    s_and_b32 s100, s80, 0xfffff
    v_mfma_f32_16x16x32_bf16 v[48:51], v[96:99], v[112:115], v[48:51]
    ds_read_b64_tr_b16 v[140:141], v13 offset:57344
    s_waitcnt lgkmcnt(7)
    ds_read_b64_tr_b16 v[142:143], v13 offset:58368
    buffer_load_dwordx4 v226, s[44:47], s87 offen offset:2048 lds
    v_mfma_f32_16x16x32_bf16 v[52:55], v[96:99], v[116:119], v[52:55]
    ds_read_b64_tr_b16 v[144:145], v14 offset:57344
    s_add_u32 s22, s99, s100
    v_mfma_f32_16x16x32_bf16 v[56:59], v[100:103], v[112:115], v[56:59]
    ds_read_b64_tr_b16 v[146:147], v14 offset:58368
    ds_read_b64_tr_b16 v[148:149], v15 offset:57344
    buffer_load_dwordx4 v227, s[44:47], s87 offen offset:3072 lds
    v_mfma_f32_16x16x32_bf16 v[60:63], v[100:103], v[116:119], v[60:63]
    ds_read_b64_tr_b16 v[150:151], v15 offset:58368
    s_add_u32 s23, s22, 4096
    v_mfma_f32_16x16x32_bf16 v[64:67], v[104:107], v[112:115], v[64:67]
    s_add_u32 s99, s99, 1048576
    v_mfma_f32_16x16x32_bf16 v[68:71], v[104:107], v[116:119], v[68:71]
    s_mul_i32 s100, s66, 40960
    v_mfma_f32_16x16x32_bf16 v[72:75], v[108:111], v[112:115], v[72:75]
    s_add_u32 s100, s100, s99
    v_mfma_f32_16x16x32_bf16 v[76:79], v[108:111], v[116:119], v[76:79]
    s_lshl_b32 s101, s64, 10
    s_waitcnt lgkmcnt(0)
    s_waitcnt vmcnt(24)
    s_barrier
    v_mfma_f32_16x16x32_bf16 v[16:19], v[120:123], v[152:155], v[16:19]
    ds_read_b128 v[112:115], v232 offset:0
    ds_read_b128 v[116:119], v232 offset:2048
    s_add_u32 m0, s78, 12288
    s_add_u32 s87, s92, 896
    buffer_load_dwordx4 v228, s[32:35], s87 offen offset:0 lds
    v_mfma_f32_16x16x32_bf16 v[20:23], v[120:123], v[156:159], v[20:23]
    ds_read_b64_tr_b16 v[80:81], v8 offset:0
    buffer_load_dwordx4 v229, s[32:35], s87 offen offset:1024 lds
    v_mfma_f32_16x16x32_bf16 v[24:27], v[124:127], v[152:155], v[24:27]
    ds_read_b64_tr_b16 v[82:83], v8 offset:1024
    buffer_load_dwordx4 v230, s[32:35], s87 offen offset:2048 lds
    v_mfma_f32_16x16x32_bf16 v[28:31], v[124:127], v[156:159], v[28:31]
    ds_read_b64_tr_b16 v[84:85], v9 offset:0
    s_add_u32 s19, s100, s101
    v_mfma_f32_16x16x32_bf16 v[32:35], v[128:131], v[152:155], v[32:35]
    ds_read_b64_tr_b16 v[86:87], v9 offset:1024
    s_lshl_b32 s101, s67, 2
    v_mfma_f32_16x16x32_bf16 v[36:39], v[128:131], v[156:159], v[36:39]
    ds_read_b64_tr_b16 v[88:89], v10 offset:0
    buffer_load_dwordx4 v231, s[32:35], s87 offen offset:3072 lds
    v_mfma_f32_16x16x32_bf16 v[40:43], v[132:135], v[152:155], v[40:43]
    ds_read_b64_tr_b16 v[90:91], v10 offset:1024
    s_add_u32 s101, s101, s64
    v_mfma_f32_16x16x32_bf16 v[44:47], v[132:135], v[156:159], v[44:47]
    ds_read_b64_tr_b16 v[92:93], v11 offset:0
    s_lshl_b32 s101, s101, 7
    v_mfma_f32_16x16x32_bf16 v[48:51], v[136:139], v[152:155], v[48:51]
    ds_read_b64_tr_b16 v[94:95], v11 offset:1024
    ds_read_b64_tr_b16 v[96:97], v12 offset:0
    s_add_u32 m0, s81, 49152
    s_add_u32 s87, s88, 3670016
    buffer_load_dwordx4 v224, s[44:47], s87 offen offset:0 lds
    v_mfma_f32_16x16x32_bf16 v[52:55], v[136:139], v[156:159], v[52:55]
    ds_read_b64_tr_b16 v[98:99], v12 offset:1024
    s_add_u32 s18, s100, s101
    v_mfma_f32_16x16x32_bf16 v[56:59], v[140:143], v[152:155], v[56:59]
    ds_read_b64_tr_b16 v[100:101], v13 offset:0
    buffer_load_dwordx4 v225, s[44:47], s87 offen offset:1024 lds
    v_mfma_f32_16x16x32_bf16 v[60:63], v[140:143], v[156:159], v[60:63]
    ds_read_b64_tr_b16 v[102:103], v13 offset:1024
    s_lshl_b32 s100, s83, 17
    v_mfma_f32_16x16x32_bf16 v[64:67], v[144:147], v[152:155], v[64:67]
    ds_read_b64_tr_b16 v[104:105], v14 offset:0
    s_add_u32 s100, s100, s99
    v_mfma_f32_16x16x32_bf16 v[68:71], v[144:147], v[156:159], v[68:71]
    s_waitcnt lgkmcnt(7)
    ds_read_b64_tr_b16 v[106:107], v14 offset:1024
    buffer_load_dwordx4 v226, s[44:47], s87 offen offset:2048 lds
    v_mfma_f32_16x16x32_bf16 v[72:75], v[148:151], v[152:155], v[72:75]
    ds_read_b64_tr_b16 v[108:109], v15 offset:0
    s_lshl_b32 s101, s98, 11
    v_mfma_f32_16x16x32_bf16 v[76:79], v[148:151], v[156:159], v[76:79]
    ds_read_b64_tr_b16 v[110:111], v15 offset:1024
    s_add_u32 s17, s100, s101
    v_mfma_f32_16x16x32_bf16 v[16:19], v[80:83], v[112:115], v[16:19]
    ds_read_b128 v[152:155], v233 offset:0
    ds_read_b128 v[156:159], v233 offset:2048
    buffer_load_dwordx4 v227, s[44:47], s87 offen offset:3072 lds
    v_mfma_f32_16x16x32_bf16 v[20:23], v[80:83], v[116:119], v[20:23]
    ds_read_b64_tr_b16 v[120:121], v8 offset:8192
    s_lshl_b32 s101, s66, 15
    v_mfma_f32_16x16x32_bf16 v[24:27], v[84:87], v[112:115], v[24:27]
    ds_read_b64_tr_b16 v[122:123], v8 offset:9216
    ds_read_b64_tr_b16 v[124:125], v9 offset:8192
    s_add_u32 s21, s100, s101
    v_mfma_f32_16x16x32_bf16 v[28:31], v[84:87], v[116:119], v[28:31]
    s_waitcnt lgkmcnt(7)
    ds_read_b64_tr_b16 v[126:127], v9 offset:9216
    s_lshl_b32 s101, s64, 11
    v_mfma_f32_16x16x32_bf16 v[32:35], v[88:91], v[112:115], v[32:35]
    ds_read_b64_tr_b16 v[128:129], v10 offset:8192
    ds_read_b64_tr_b16 v[130:131], v10 offset:9216
    s_add_u32 s21, s21, s101
    v_mfma_f32_16x16x32_bf16 v[36:39], v[88:91], v[116:119], v[36:39]
    ds_read_b64_tr_b16 v[132:133], v11 offset:8192
    s_lshl_b32 s100, s68, 2
    v_mfma_f32_16x16x32_bf16 v[40:43], v[92:95], v[112:115], v[40:43]
    ds_read_b64_tr_b16 v[134:135], v11 offset:9216
    ds_read_b64_tr_b16 v[136:137], v12 offset:8192
    s_add_u32 s100, s100, s66
    v_mfma_f32_16x16x32_bf16 v[44:47], v[92:95], v[116:119], v[44:47]
    ds_read_b64_tr_b16 v[138:139], v12 offset:9216
    s_lshl_b32 s100, s100, 17
    v_mfma_f32_16x16x32_bf16 v[48:51], v[96:99], v[112:115], v[48:51]
    ds_read_b64_tr_b16 v[140:141], v13 offset:8192
    s_waitcnt lgkmcnt(7)
    ds_read_b64_tr_b16 v[142:143], v13 offset:9216
    s_lshl_b32 s101, s65, 11
    v_mfma_f32_16x16x32_bf16 v[52:55], v[96:99], v[116:119], v[52:55]
    ds_read_b64_tr_b16 v[144:145], v14 offset:8192
    s_add_u32 s100, s100, s101
    v_mfma_f32_16x16x32_bf16 v[56:59], v[100:103], v[112:115], v[56:59]
    ds_read_b64_tr_b16 v[146:147], v14 offset:9216
    ds_read_b64_tr_b16 v[148:149], v15 offset:8192
    s_lshl_b32 s101, s83, 8
    v_mfma_f32_16x16x32_bf16 v[60:63], v[100:103], v[116:119], v[60:63]
    ds_read_b64_tr_b16 v[150:151], v15 offset:9216
    s_add_u32 s100, s100, s101
    v_mfma_f32_16x16x32_bf16 v[64:67], v[104:107], v[112:115], v[64:67]
    s_lshl_b32 s101, s64, 6
    v_mfma_f32_16x16x32_bf16 v[68:71], v[104:107], v[116:119], v[68:71]
    s_add_u32 s20, s100, s101
    v_mfma_f32_16x16x32_bf16 v[72:75], v[108:111], v[112:115], v[72:75]
    v_mfma_f32_16x16x32_bf16 v[76:79], v[108:111], v[116:119], v[76:79]
    s_waitcnt lgkmcnt(0)
    s_waitcnt vmcnt(16)
    s_barrier
    v_mfma_f32_16x16x32_bf16 v[16:19], v[120:123], v[152:155], v[16:19]
    ds_read_b128 v[112:115], v232 offset:4096
    ds_read_b128 v[116:119], v232 offset:6144
    s_add_u32 m0, s78, 0
    s_add_u32 s87, s93, 256
    buffer_load_dwordx4 v228, s[32:35], s87 offen offset:0 lds
    v_mfma_f32_16x16x32_bf16 v[20:23], v[120:123], v[156:159], v[20:23]
    ds_read_b64_tr_b16 v[80:81], v8 offset:16384
    buffer_load_dwordx4 v229, s[32:35], s87 offen offset:1024 lds
    v_xor_b32 v253, 0, v248
    ds_read_b64 v[160:161], v253 offset:0
    v_mfma_f32_16x16x32_bf16 v[24:27], v[124:127], v[152:155], v[24:27]
    ds_read_b64_tr_b16 v[82:83], v8 offset:17408
    buffer_load_dwordx4 v230, s[32:35], s87 offen offset:2048 lds
    v_mfma_f32_16x16x32_bf16 v[28:31], v[124:127], v[156:159], v[28:31]
    ds_read_b64_tr_b16 v[84:85], v9 offset:16384
    buffer_load_dwordx4 v231, s[32:35], s87 offen offset:3072 lds
    v_xor_b32 v253, 32, v248
    ds_read_b64 v[162:163], v253 offset:0
    v_mfma_f32_16x16x32_bf16 v[32:35], v[128:131], v[152:155], v[32:35]
    ds_read_b64_tr_b16 v[86:87], v9 offset:17408
    s_add_u32 m0, s81, 0
    s_add_u32 s87, s89, 1048576
    buffer_load_dwordx4 v224, s[44:47], s87 offen offset:0 lds
    v_xor_b32 v253, 64, v248
    ds_read_b64 v[164:165], v253 offset:0
    v_mfma_f32_16x16x32_bf16 v[36:39], v[128:131], v[156:159], v[36:39]
    ds_read_b64_tr_b16 v[88:89], v10 offset:16384
    buffer_load_dwordx4 v225, s[44:47], s87 offen offset:1024 lds
    v_mfma_f32_16x16x32_bf16 v[40:43], v[132:135], v[152:155], v[40:43]
    ds_read_b64_tr_b16 v[90:91], v10 offset:17408
    buffer_load_dwordx4 v226, s[44:47], s87 offen offset:2048 lds
    v_xor_b32 v253, 96, v248
    ds_read_b64 v[166:167], v253 offset:0
    v_mfma_f32_16x16x32_bf16 v[44:47], v[132:135], v[156:159], v[44:47]
    ds_read_b64_tr_b16 v[92:93], v11 offset:16384
    buffer_load_dwordx4 v227, s[44:47], s87 offen offset:3072 lds
    v_mfma_f32_16x16x32_bf16 v[48:51], v[136:139], v[152:155], v[48:51]
    ds_read_b64_tr_b16 v[94:95], v11 offset:17408
    ds_read_b64_tr_b16 v[96:97], v12 offset:16384
    v_xor_b32 v253, 128, v248
    s_waitcnt lgkmcnt(7)
    ds_read_b64 v[168:169], v253 offset:0
    v_mfma_f32_16x16x32_bf16 v[52:55], v[136:139], v[156:159], v[52:55]
    ds_read_b64_tr_b16 v[98:99], v12 offset:17408
    v_xor_b32 v253, 160, v248
    ds_read_b64 v[170:171], v253 offset:0
    v_mfma_f32_16x16x32_bf16 v[56:59], v[140:143], v[152:155], v[56:59]
    ds_read_b64_tr_b16 v[100:101], v13 offset:16384
    v_mfma_f32_16x16x32_bf16 v[60:63], v[140:143], v[156:159], v[60:63]
    ds_read_b64_tr_b16 v[102:103], v13 offset:17408
    v_xor_b32 v253, 192, v248
    ds_read_b64 v[172:173], v253 offset:0
    v_mfma_f32_16x16x32_bf16 v[64:67], v[144:147], v[152:155], v[64:67]
    ds_read_b64_tr_b16 v[104:105], v14 offset:16384
    v_xor_b32 v253, 224, v248
    ds_read_b64 v[174:175], v253 offset:0
    v_mfma_f32_16x16x32_bf16 v[68:71], v[144:147], v[156:159], v[68:71]
    s_waitcnt lgkmcnt(7)
    ds_read_b64_tr_b16 v[106:107], v14 offset:17408
    v_mfma_f32_16x16x32_bf16 v[72:75], v[148:151], v[152:155], v[72:75]
    ds_read_b64_tr_b16 v[108:109], v15 offset:16384
    v_xor_b32 v253, 64, v248
    ds_read_b64 v[176:177], v253 offset:1024
    v_mfma_f32_16x16x32_bf16 v[76:79], v[148:151], v[156:159], v[76:79]
    ds_read_b64_tr_b16 v[110:111], v15 offset:17408
    v_mfma_f32_16x16x32_bf16 v[16:19], v[80:83], v[112:115], v[16:19]
    ds_read_b128 v[152:155], v233 offset:4096
    ds_read_b128 v[156:159], v233 offset:6144
    v_xor_b32 v253, 96, v248
    ds_read_b64 v[178:179], v253 offset:1024
    v_mfma_f32_16x16x32_bf16 v[20:23], v[80:83], v[116:119], v[20:23]
    ds_read_b64_tr_b16 v[120:121], v8 offset:24576
    v_xor_b32 v253, 0, v248
    s_waitcnt lgkmcnt(7)
    ds_read_b64 v[180:181], v253 offset:1024
    v_mfma_f32_16x16x32_bf16 v[24:27], v[84:87], v[112:115], v[24:27]
    ds_read_b64_tr_b16 v[122:123], v8 offset:25600
    ds_read_b64_tr_b16 v[124:125], v9 offset:24576
    v_mfma_f32_16x16x32_bf16 v[28:31], v[84:87], v[116:119], v[28:31]
    ds_read_b64_tr_b16 v[126:127], v9 offset:25600
    v_xor_b32 v253, 32, v248
    ds_read_b64 v[182:183], v253 offset:1024
    v_mfma_f32_16x16x32_bf16 v[32:35], v[88:91], v[112:115], v[32:35]
    ds_read_b64_tr_b16 v[128:129], v10 offset:24576
    ds_read_b64_tr_b16 v[130:131], v10 offset:25600
    v_mfma_f32_16x16x32_bf16 v[36:39], v[88:91], v[116:119], v[36:39]
    ds_read_b64_tr_b16 v[132:133], v11 offset:24576
    v_xor_b32 v253, 192, v248
    s_waitcnt lgkmcnt(7)
    ds_read_b64 v[184:185], v253 offset:1024
    v_mfma_f32_16x16x32_bf16 v[40:43], v[92:95], v[112:115], v[40:43]
    ds_read_b64_tr_b16 v[134:135], v11 offset:25600
    ds_read_b64_tr_b16 v[136:137], v12 offset:24576
    v_xor_b32 v253, 224, v248
    ds_read_b64 v[186:187], v253 offset:1024
    v_mfma_f32_16x16x32_bf16 v[44:47], v[92:95], v[116:119], v[44:47]
    ds_read_b64_tr_b16 v[138:139], v12 offset:25600
    v_mfma_f32_16x16x32_bf16 v[48:51], v[96:99], v[112:115], v[48:51]
    ds_read_b64_tr_b16 v[140:141], v13 offset:24576
    ds_read_b64_tr_b16 v[142:143], v13 offset:25600
    v_xor_b32 v253, 128, v248
    ds_read_b64 v[188:189], v253 offset:1024
    v_mfma_f32_16x16x32_bf16 v[52:55], v[96:99], v[116:119], v[52:55]
    s_waitcnt lgkmcnt(7)
    ds_read_b64_tr_b16 v[144:145], v14 offset:24576
    v_xor_b32 v253, 160, v248
    ds_read_b64 v[190:191], v253 offset:1024
    v_mfma_f32_16x16x32_bf16 v[56:59], v[100:103], v[112:115], v[56:59]
    ds_read_b64_tr_b16 v[146:147], v14 offset:25600
    ds_read_b64_tr_b16 v[148:149], v15 offset:24576
    v_mfma_f32_16x16x32_bf16 v[60:63], v[100:103], v[116:119], v[60:63]
    ds_read_b64_tr_b16 v[150:151], v15 offset:25600
    v_mfma_f32_16x16x32_bf16 v[64:67], v[104:107], v[112:115], v[64:67]
    v_mfma_f32_16x16x32_bf16 v[68:71], v[104:107], v[116:119], v[68:71]
    v_mfma_f32_16x16x32_bf16 v[72:75], v[108:111], v[112:115], v[72:75]
    v_mfma_f32_16x16x32_bf16 v[76:79], v[108:111], v[116:119], v[76:79]
    s_waitcnt lgkmcnt(0)
    s_waitcnt vmcnt(16)
    s_barrier
    v_mfma_f32_16x16x32_bf16 v[16:19], v[120:123], v[152:155], v[16:19]
    ds_read_b128 v[112:115], v232 offset:8192
    ds_read_b128 v[116:119], v232 offset:10240
    s_add_u32 m0, s82, 131072
    s_add_u32 s87, s80, 0
    buffer_load_dwordx4 v3, s[40:43], s87 offen offset:0 nt lds
    v_mfma_f32_16x16x32_bf16 v[20:23], v[120:123], v[156:159], v[20:23]
    ds_read_b64_tr_b16 v[80:81], v8 offset:32768
    buffer_load_dwordx4 v3, s[40:43], s87 offen offset:1024 nt lds
    v_mfma_f32_16x16x32_bf16 v[24:27], v[124:127], v[152:155], v[24:27]
    ds_read_b64_tr_b16 v[82:83], v8 offset:33792
    v_xor_b32 v240, 32, v3
    buffer_load_dwordx4 v240, s[40:43], s87 offen offset:2048 nt lds
    v_mfma_f32_16x16x32_bf16 v[28:31], v[124:127], v[156:159], v[28:31]
    ds_read_b64_tr_b16 v[84:85], v9 offset:32768
    buffer_load_dwordx4 v240, s[40:43], s87 offen offset:3072 nt lds
    v_mfma_f32_16x16x32_bf16 v[32:35], v[128:131], v[152:155], v[32:35]
    ds_read_b64_tr_b16 v[86:87], v9 offset:33792
    s_add_u32 m0, s82, 135168
    s_add_u32 s87, s80, 4096
    buffer_load_dwordx4 v3, s[40:43], s87 offen offset:0 nt lds
    v_mfma_f32_16x16x32_bf16 v[36:39], v[128:131], v[156:159], v[36:39]
    ds_read_b64_tr_b16 v[88:89], v10 offset:32768
    buffer_load_dwordx4 v3, s[40:43], s87 offen offset:1024 nt lds
    v_mfma_f32_16x16x32_bf16 v[40:43], v[132:135], v[152:155], v[40:43]
    ds_read_b64_tr_b16 v[90:91], v10 offset:33792
    v_xor_b32 v240, 32, v3
    buffer_load_dwordx4 v240, s[40:43], s87 offen offset:2048 nt lds
    v_mfma_f32_16x16x32_bf16 v[44:47], v[132:135], v[156:159], v[44:47]
    ds_read_b64_tr_b16 v[92:93], v11 offset:32768
    buffer_load_dwordx4 v240, s[40:43], s87 offen offset:3072 nt lds
    v_mfma_f32_16x16x32_bf16 v[48:51], v[136:139], v[152:155], v[48:51]
    ds_read_b64_tr_b16 v[94:95], v11 offset:33792
    ds_read_b64_tr_b16 v[96:97], v12 offset:32768
    s_add_u32 m0, s78, 4096
    s_add_u32 s87, s93, 0
    buffer_load_dwordx4 v228, s[32:35], s87 offen offset:0 lds
    v_mfma_f32_16x16x32_bf16 v[52:55], v[136:139], v[156:159], v[52:55]
    ds_read_b64_tr_b16 v[98:99], v12 offset:33792
    buffer_load_dwordx4 v229, s[32:35], s87 offen offset:1024 lds
    v_mfma_f32_16x16x32_bf16 v[56:59], v[140:143], v[152:155], v[56:59]
    ds_read_b64_tr_b16 v[100:101], v13 offset:32768
    v_mfma_f32_16x16x32_bf16 v[60:63], v[140:143], v[156:159], v[60:63]
    ds_read_b64_tr_b16 v[102:103], v13 offset:33792
    v_mfma_f32_16x16x32_bf16 v[64:67], v[144:147], v[152:155], v[64:67]
    ds_read_b64_tr_b16 v[104:105], v14 offset:32768
    v_mfma_f32_16x16x32_bf16 v[68:71], v[144:147], v[156:159], v[68:71]
    s_waitcnt lgkmcnt(7)
    ds_read_b64_tr_b16 v[106:107], v14 offset:33792
    v_mfma_f32_16x16x32_bf16 v[72:75], v[148:151], v[152:155], v[72:75]
    ds_read_b64_tr_b16 v[108:109], v15 offset:32768
    v_mfma_f32_16x16x32_bf16 v[76:79], v[148:151], v[156:159], v[76:79]
    ds_read_b64_tr_b16 v[110:111], v15 offset:33792
    v_mfma_f32_16x16x32_bf16 v[16:19], v[80:83], v[112:115], v[16:19]
    ds_read_b128 v[152:155], v233 offset:8192
    ds_read_b128 v[156:159], v233 offset:10240
    v_mfma_f32_16x16x32_bf16 v[20:23], v[80:83], v[116:119], v[20:23]
    ds_read_b64_tr_b16 v[120:121], v8 offset:40960
    v_mfma_f32_16x16x32_bf16 v[24:27], v[84:87], v[112:115], v[24:27]
    ds_read_b64_tr_b16 v[122:123], v8 offset:41984
    ds_read_b64_tr_b16 v[124:125], v9 offset:40960
    v_mfma_f32_16x16x32_bf16 v[28:31], v[84:87], v[116:119], v[28:31]
    s_waitcnt lgkmcnt(7)
    ds_read_b64_tr_b16 v[126:127], v9 offset:41984
    v_mfma_f32_16x16x32_bf16 v[32:35], v[88:91], v[112:115], v[32:35]
    ds_read_b64_tr_b16 v[128:129], v10 offset:40960
    ds_read_b64_tr_b16 v[130:131], v10 offset:41984
    buffer_load_dwordx4 v230, s[32:35], s87 offen offset:2048 lds
    v_mfma_f32_16x16x32_bf16 v[36:39], v[88:91], v[116:119], v[36:39]
    ds_read_b64_tr_b16 v[132:133], v11 offset:40960
    v_mfma_f32_16x16x32_bf16 v[40:43], v[92:95], v[112:115], v[40:43]
    ds_read_b64_tr_b16 v[134:135], v11 offset:41984
    ds_read_b64_tr_b16 v[136:137], v12 offset:40960
    v_mfma_f32_16x16x32_bf16 v[44:47], v[92:95], v[116:119], v[44:47]
    ds_read_b64_tr_b16 v[138:139], v12 offset:41984
    buffer_load_dwordx4 v231, s[32:35], s87 offen offset:3072 lds
    v_mfma_f32_16x16x32_bf16 v[48:51], v[96:99], v[112:115], v[48:51]
    ds_read_b64_tr_b16 v[140:141], v13 offset:40960
    s_waitcnt lgkmcnt(7)
    ds_read_b64_tr_b16 v[142:143], v13 offset:41984
    v_mfma_f32_16x16x32_bf16 v[52:55], v[96:99], v[116:119], v[52:55]
    ds_read_b64_tr_b16 v[144:145], v14 offset:40960
    v_mfma_f32_16x16x32_bf16 v[56:59], v[100:103], v[112:115], v[56:59]
    ds_read_b64_tr_b16 v[146:147], v14 offset:41984
    ds_read_b64_tr_b16 v[148:149], v15 offset:40960
    s_add_u32 m0, s81, 16384
    s_add_u32 s87, s89, 0
    buffer_load_dwordx4 v224, s[44:47], s87 offen offset:0 lds
    v_mfma_f32_16x16x32_bf16 v[60:63], v[100:103], v[116:119], v[60:63]
    ds_read_b64_tr_b16 v[150:151], v15 offset:41984
    v_mfma_f32_16x16x32_bf16 v[64:67], v[104:107], v[112:115], v[64:67]
    buffer_load_dwordx4 v225, s[44:47], s87 offen offset:1024 lds
    v_mfma_f32_16x16x32_bf16 v[68:71], v[104:107], v[116:119], v[68:71]
    v_mfma_f32_16x16x32_bf16 v[72:75], v[108:111], v[112:115], v[72:75]
    v_mfma_f32_16x16x32_bf16 v[76:79], v[108:111], v[116:119], v[76:79]
    buffer_load_dwordx4 v226, s[44:47], s87 offen offset:2048 lds
    s_waitcnt lgkmcnt(0)
    s_waitcnt vmcnt(23)
    s_barrier
    v_mfma_f32_16x16x32_bf16 v[16:19], v[120:123], v[152:155], v[16:19]
    ds_read_b128 v[112:115], v232 offset:12288
    ds_read_b128 v[116:119], v232 offset:14336
    v_mfma_f32_16x16x32_bf16 v[20:23], v[120:123], v[156:159], v[20:23]
    ds_read_b64_tr_b16 v[80:81], v8 offset:49152
    v_mfma_f32_16x16x32_bf16 v[24:27], v[124:127], v[152:155], v[24:27]
    ds_read_b64_tr_b16 v[82:83], v8 offset:50176
    buffer_load_dwordx4 v227, s[44:47], s87 offen offset:3072 lds
    v_mfma_f32_16x16x32_bf16 v[28:31], v[124:127], v[156:159], v[28:31]
    ds_read_b64_tr_b16 v[84:85], v9 offset:49152
    v_mfma_f32_16x16x32_bf16 v[32:35], v[128:131], v[152:155], v[32:35]
    ds_read_b64_tr_b16 v[86:87], v9 offset:50176
    s_add_u32 m0, s78, 8192
    s_add_u32 s87, s93, 128
    buffer_load_dwordx4 v228, s[32:35], s87 offen offset:0 lds
    v_mfma_f32_16x16x32_bf16 v[36:39], v[128:131], v[156:159], v[36:39]
    ds_read_b64_tr_b16 v[88:89], v10 offset:49152
    v_mfma_f32_16x16x32_bf16 v[40:43], v[132:135], v[152:155], v[40:43]
    ds_read_b64_tr_b16 v[90:91], v10 offset:50176
    v_mfma_f32_16x16x32_bf16 v[44:47], v[132:135], v[156:159], v[44:47]
    ds_read_b64_tr_b16 v[92:93], v11 offset:49152
    buffer_load_dwordx4 v229, s[32:35], s87 offen offset:1024 lds
    v_mfma_f32_16x16x32_bf16 v[48:51], v[136:139], v[152:155], v[48:51]
    ds_read_b64_tr_b16 v[94:95], v11 offset:50176
    ds_read_b64_tr_b16 v[96:97], v12 offset:49152
    v_mfma_f32_16x16x32_bf16 v[52:55], v[136:139], v[156:159], v[52:55]
    ds_read_b64_tr_b16 v[98:99], v12 offset:50176
    v_mfma_f32_16x16x32_bf16 v[56:59], v[140:143], v[152:155], v[56:59]
    ds_read_b64_tr_b16 v[100:101], v13 offset:49152
    buffer_load_dwordx4 v230, s[32:35], s87 offen offset:2048 lds
    v_mfma_f32_16x16x32_bf16 v[60:63], v[140:143], v[156:159], v[60:63]
    ds_read_b64_tr_b16 v[102:103], v13 offset:50176
    v_mfma_f32_16x16x32_bf16 v[64:67], v[144:147], v[152:155], v[64:67]
    ds_read_b64_tr_b16 v[104:105], v14 offset:49152
    buffer_load_dwordx4 v231, s[32:35], s87 offen offset:3072 lds
    v_mfma_f32_16x16x32_bf16 v[68:71], v[144:147], v[156:159], v[68:71]
    s_waitcnt lgkmcnt(7)
    ds_read_b64_tr_b16 v[106:107], v14 offset:50176
    v_mfma_f32_16x16x32_bf16 v[72:75], v[148:151], v[152:155], v[72:75]
    ds_read_b64_tr_b16 v[108:109], v15 offset:49152
    v_mfma_f32_16x16x32_bf16 v[76:79], v[148:151], v[156:159], v[76:79]
    ds_read_b64_tr_b16 v[110:111], v15 offset:50176
    s_add_u32 m0, s81, 32768
    s_add_u32 s87, s89, 524288
    buffer_load_dwordx4 v224, s[44:47], s87 offen offset:0 lds
    v_mfma_f32_16x16x32_bf16 v[16:19], v[80:83], v[112:115], v[16:19]
    ds_read_b128 v[152:155], v233 offset:12288
    ds_read_b128 v[156:159], v233 offset:14336
    v_mfma_f32_16x16x32_bf16 v[20:23], v[80:83], v[116:119], v[20:23]
    ds_read_b64_tr_b16 v[120:121], v8 offset:57344
    v_mfma_f32_16x16x32_bf16 v[24:27], v[84:87], v[112:115], v[24:27]
    ds_read_b64_tr_b16 v[122:123], v8 offset:58368
    ds_read_b64_tr_b16 v[124:125], v9 offset:57344
    buffer_load_dwordx4 v225, s[44:47], s87 offen offset:1024 lds
    v_mfma_f32_16x16x32_bf16 v[28:31], v[84:87], v[116:119], v[28:31]
    s_waitcnt lgkmcnt(7)
    ds_read_b64_tr_b16 v[126:127], v9 offset:58368
    v_mfma_f32_16x16x32_bf16 v[32:35], v[88:91], v[112:115], v[32:35]
    ds_read_b64_tr_b16 v[128:129], v10 offset:57344
    ds_read_b64_tr_b16 v[130:131], v10 offset:58368
    buffer_load_dwordx4 v226, s[44:47], s87 offen offset:2048 lds
    v_mfma_f32_16x16x32_bf16 v[36:39], v[88:91], v[116:119], v[36:39]
    ds_read_b64_tr_b16 v[132:133], v11 offset:57344
    v_mfma_f32_16x16x32_bf16 v[40:43], v[92:95], v[112:115], v[40:43]
    ds_read_b64_tr_b16 v[134:135], v11 offset:58368
    ds_read_b64_tr_b16 v[136:137], v12 offset:57344
    v_mfma_f32_16x16x32_bf16 v[44:47], v[92:95], v[116:119], v[44:47]
    ds_read_b64_tr_b16 v[138:139], v12 offset:58368
    buffer_load_dwordx4 v227, s[44:47], s87 offen offset:3072 lds
    v_mfma_f32_16x16x32_bf16 v[48:51], v[96:99], v[112:115], v[48:51]
    ds_read_b64_tr_b16 v[140:141], v13 offset:57344
    s_waitcnt lgkmcnt(7)
    ds_read_b64_tr_b16 v[142:143], v13 offset:58368
    v_mfma_f32_16x16x32_bf16 v[52:55], v[96:99], v[116:119], v[52:55]
    ds_read_b64_tr_b16 v[144:145], v14 offset:57344
    v_mfma_f32_16x16x32_bf16 v[56:59], v[100:103], v[112:115], v[56:59]
    ds_read_b64_tr_b16 v[146:147], v14 offset:58368
    ds_read_b64_tr_b16 v[148:149], v15 offset:57344
    v_mfma_f32_16x16x32_bf16 v[60:63], v[100:103], v[116:119], v[60:63]
    ds_read_b64_tr_b16 v[150:151], v15 offset:58368
    v_mfma_f32_16x16x32_bf16 v[64:67], v[104:107], v[112:115], v[64:67]
    v_mfma_f32_16x16x32_bf16 v[68:71], v[104:107], v[116:119], v[68:71]
    v_mfma_f32_16x16x32_bf16 v[72:75], v[108:111], v[112:115], v[72:75]
    v_mfma_f32_16x16x32_bf16 v[76:79], v[108:111], v[116:119], v[76:79]
    s_waitcnt lgkmcnt(0)
    s_waitcnt vmcnt(24)
    s_barrier
    v_mfma_f32_16x16x32_bf16 v[16:19], v[120:123], v[152:155], v[16:19]
    ds_read_b128 v[112:115], v232 offset:0
    ds_read_b128 v[116:119], v232 offset:2048
    s_add_u32 m0, s78, 12288
    s_add_u32 s87, s93, 384
    buffer_load_dwordx4 v228, s[32:35], s87 offen offset:0 lds
    v_mfma_f32_16x16x32_bf16 v[20:23], v[120:123], v[156:159], v[20:23]
    ds_read_b64_tr_b16 v[80:81], v8 offset:0
    buffer_load_dwordx4 v229, s[32:35], s87 offen offset:1024 lds
    v_mfma_f32_16x16x32_bf16 v[24:27], v[124:127], v[152:155], v[24:27]
    ds_read_b64_tr_b16 v[82:83], v8 offset:1024
    buffer_load_dwordx4 v230, s[32:35], s87 offen offset:2048 lds
    v_mfma_f32_16x16x32_bf16 v[28:31], v[124:127], v[156:159], v[28:31]
    ds_read_b64_tr_b16 v[84:85], v9 offset:0
    buffer_load_dwordx4 v231, s[32:35], s87 offen offset:3072 lds
    v_mfma_f32_16x16x32_bf16 v[32:35], v[128:131], v[152:155], v[32:35]
    ds_read_b64_tr_b16 v[86:87], v9 offset:1024
    s_add_u32 m0, s81, 49152
    s_add_u32 s87, s89, 1572864
    buffer_load_dwordx4 v224, s[44:47], s87 offen offset:0 lds
    v_mfma_f32_16x16x32_bf16 v[36:39], v[128:131], v[156:159], v[36:39]
    ds_read_b64_tr_b16 v[88:89], v10 offset:0
    v_mfma_f32_16x16x32_bf16 v[40:43], v[132:135], v[152:155], v[40:43]
    ds_read_b64_tr_b16 v[90:91], v10 offset:1024
    v_mfma_f32_16x16x32_bf16 v[44:47], v[132:135], v[156:159], v[44:47]
    ds_read_b64_tr_b16 v[92:93], v11 offset:0
    buffer_load_dwordx4 v225, s[44:47], s87 offen offset:1024 lds
    v_mfma_f32_16x16x32_bf16 v[48:51], v[136:139], v[152:155], v[48:51]
    ds_read_b64_tr_b16 v[94:95], v11 offset:1024
    ds_read_b64_tr_b16 v[96:97], v12 offset:0
    v_mfma_f32_16x16x32_bf16 v[52:55], v[136:139], v[156:159], v[52:55]
    ds_read_b64_tr_b16 v[98:99], v12 offset:1024
    v_mfma_f32_16x16x32_bf16 v[56:59], v[140:143], v[152:155], v[56:59]
    ds_read_b64_tr_b16 v[100:101], v13 offset:0
    buffer_load_dwordx4 v226, s[44:47], s87 offen offset:2048 lds
    v_mfma_f32_16x16x32_bf16 v[60:63], v[140:143], v[156:159], v[60:63]
    ds_read_b64_tr_b16 v[102:103], v13 offset:1024
    v_mfma_f32_16x16x32_bf16 v[64:67], v[144:147], v[152:155], v[64:67]
    ds_read_b64_tr_b16 v[104:105], v14 offset:0
    buffer_load_dwordx4 v227, s[44:47], s87 offen offset:3072 lds
    v_mfma_f32_16x16x32_bf16 v[68:71], v[144:147], v[156:159], v[68:71]
    s_waitcnt lgkmcnt(7)
    ds_read_b64_tr_b16 v[106:107], v14 offset:1024
    v_mfma_f32_16x16x32_bf16 v[72:75], v[148:151], v[152:155], v[72:75]
    ds_read_b64_tr_b16 v[108:109], v15 offset:0
    v_mfma_f32_16x16x32_bf16 v[76:79], v[148:151], v[156:159], v[76:79]
    ds_read_b64_tr_b16 v[110:111], v15 offset:1024
    v_mfma_f32_16x16x32_bf16 v[16:19], v[80:83], v[112:115], v[16:19]
    ds_read_b128 v[152:155], v233 offset:0
    ds_read_b128 v[156:159], v233 offset:2048
    v_mfma_f32_16x16x32_bf16 v[20:23], v[80:83], v[116:119], v[20:23]
    ds_read_b64_tr_b16 v[120:121], v8 offset:8192
    v_mfma_f32_16x16x32_bf16 v[24:27], v[84:87], v[112:115], v[24:27]
    ds_read_b64_tr_b16 v[122:123], v8 offset:9216
    ds_read_b64_tr_b16 v[124:125], v9 offset:8192
    v_mfma_f32_16x16x32_bf16 v[28:31], v[84:87], v[116:119], v[28:31]
    s_waitcnt lgkmcnt(7)
    ds_read_b64_tr_b16 v[126:127], v9 offset:9216
    v_mfma_f32_16x16x32_bf16 v[32:35], v[88:91], v[112:115], v[32:35]
    ds_read_b64_tr_b16 v[128:129], v10 offset:8192
    ds_read_b64_tr_b16 v[130:131], v10 offset:9216
    v_mfma_f32_16x16x32_bf16 v[36:39], v[88:91], v[116:119], v[36:39]
    ds_read_b64_tr_b16 v[132:133], v11 offset:8192
    v_mfma_f32_16x16x32_bf16 v[40:43], v[92:95], v[112:115], v[40:43]
    ds_read_b64_tr_b16 v[134:135], v11 offset:9216
    ds_read_b64_tr_b16 v[136:137], v12 offset:8192
    v_mfma_f32_16x16x32_bf16 v[44:47], v[92:95], v[116:119], v[44:47]
    ds_read_b64_tr_b16 v[138:139], v12 offset:9216
    v_mfma_f32_16x16x32_bf16 v[48:51], v[96:99], v[112:115], v[48:51]
    ds_read_b64_tr_b16 v[140:141], v13 offset:8192
    s_waitcnt lgkmcnt(7)
    ds_read_b64_tr_b16 v[142:143], v13 offset:9216
    v_mfma_f32_16x16x32_bf16 v[52:55], v[96:99], v[116:119], v[52:55]
    ds_read_b64_tr_b16 v[144:145], v14 offset:8192
    v_mfma_f32_16x16x32_bf16 v[56:59], v[100:103], v[112:115], v[56:59]
    ds_read_b64_tr_b16 v[146:147], v14 offset:9216
    ds_read_b64_tr_b16 v[148:149], v15 offset:8192
    v_mfma_f32_16x16x32_bf16 v[60:63], v[100:103], v[116:119], v[60:63]
    ds_read_b64_tr_b16 v[150:151], v15 offset:9216
    v_mfma_f32_16x16x32_bf16 v[64:67], v[104:107], v[112:115], v[64:67]
    v_mfma_f32_16x16x32_bf16 v[68:71], v[104:107], v[116:119], v[68:71]
    v_mfma_f32_16x16x32_bf16 v[72:75], v[108:111], v[112:115], v[72:75]
    v_mfma_f32_16x16x32_bf16 v[76:79], v[108:111], v[116:119], v[76:79]
    s_waitcnt lgkmcnt(0)
    s_waitcnt vmcnt(16)
    s_barrier
    v_mfma_f32_16x16x32_bf16 v[16:19], v[120:123], v[152:155], v[16:19]
    ds_read_b128 v[112:115], v232 offset:4096
    ds_read_b128 v[116:119], v232 offset:6144
    s_add_u32 m0, s78, 0
    s_add_u32 s87, s93, 768
    buffer_load_dwordx4 v228, s[32:35], s87 offen offset:0 lds
    v_mfma_f32_16x16x32_bf16 v[20:23], v[120:123], v[156:159], v[20:23]
    ds_read_b64_tr_b16 v[80:81], v8 offset:16384
    buffer_load_dwordx4 v229, s[32:35], s87 offen offset:1024 lds
    v_mfma_f32_16x16x32_bf16 v[24:27], v[124:127], v[152:155], v[24:27]
    ds_read_b64_tr_b16 v[82:83], v8 offset:17408
    buffer_load_dwordx4 v230, s[32:35], s87 offen offset:2048 lds
    v_mfma_f32_16x16x32_bf16 v[28:31], v[124:127], v[156:159], v[28:31]
    ds_read_b64_tr_b16 v[84:85], v9 offset:16384
    buffer_load_dwordx4 v231, s[32:35], s87 offen offset:3072 lds
    s_add_u32 s71, s82, 131072
    v_add_u32 v253, s71, v8
    ds_read_b64_tr_b16 v[192:193], v253 offset:0
    ds_read_b64_tr_b16 v[194:195], v253 offset:1024
    v_mfma_f32_16x16x32_bf16 v[32:35], v[128:131], v[152:155], v[32:35]
    ds_read_b64_tr_b16 v[86:87], v9 offset:17408
    s_add_u32 m0, s81, 0
    s_add_u32 s87, s89, 3145728
    buffer_load_dwordx4 v224, s[44:47], s87 offen offset:0 lds
    v_mfma_f32_16x16x32_bf16 v[36:39], v[128:131], v[156:159], v[36:39]
    ds_read_b64_tr_b16 v[88:89], v10 offset:16384
    buffer_load_dwordx4 v225, s[44:47], s87 offen offset:1024 lds
    v_mfma_f32_16x16x32_bf16 v[40:43], v[132:135], v[152:155], v[40:43]
    ds_read_b64_tr_b16 v[90:91], v10 offset:17408
    buffer_load_dwordx4 v226, s[44:47], s87 offen offset:2048 lds
    v_add_u32 v253, s71, v9
    ds_read_b64_tr_b16 v[196:197], v253 offset:0
    ds_read_b64_tr_b16 v[198:199], v253 offset:1024
    v_mfma_f32_16x16x32_bf16 v[44:47], v[132:135], v[156:159], v[44:47]
    ds_read_b64_tr_b16 v[92:93], v11 offset:16384
    buffer_load_dwordx4 v227, s[44:47], s87 offen offset:3072 lds
    v_mfma_f32_16x16x32_bf16 v[48:51], v[136:139], v[152:155], v[48:51]
    ds_read_b64_tr_b16 v[94:95], v11 offset:17408
    ds_read_b64_tr_b16 v[96:97], v12 offset:16384
    v_mfma_f32_16x16x32_bf16 v[52:55], v[136:139], v[156:159], v[52:55]
    s_waitcnt lgkmcnt(7)
    ds_read_b64_tr_b16 v[98:99], v12 offset:17408
    v_add_u32 v253, s71, v10
    ds_read_b64_tr_b16 v[200:201], v253 offset:0
    ds_read_b64_tr_b16 v[202:203], v253 offset:1024
    v_mfma_f32_16x16x32_bf16 v[56:59], v[140:143], v[152:155], v[56:59]
    ds_read_b64_tr_b16 v[100:101], v13 offset:16384
    v_mfma_f32_16x16x32_bf16 v[60:63], v[140:143], v[156:159], v[60:63]
    ds_read_b64_tr_b16 v[102:103], v13 offset:17408
    v_mfma_f32_16x16x32_bf16 v[64:67], v[144:147], v[152:155], v[64:67]
    ds_read_b64_tr_b16 v[104:105], v14 offset:16384
    v_add_u32 v253, s71, v11
    ds_read_b64_tr_b16 v[204:205], v253 offset:0
    ds_read_b64_tr_b16 v[206:207], v253 offset:1024
    v_mfma_f32_16x16x32_bf16 v[68:71], v[144:147], v[156:159], v[68:71]
    s_waitcnt lgkmcnt(7)
    ds_read_b64_tr_b16 v[106:107], v14 offset:17408
    v_mfma_f32_16x16x32_bf16 v[72:75], v[148:151], v[152:155], v[72:75]
    ds_read_b64_tr_b16 v[108:109], v15 offset:16384
    v_mfma_f32_16x16x32_bf16 v[76:79], v[148:151], v[156:159], v[76:79]
    ds_read_b64_tr_b16 v[110:111], v15 offset:17408
    v_mfma_f32_16x16x32_bf16 v[16:19], v[80:83], v[112:115], v[16:19]
    ds_read_b128 v[152:155], v233 offset:4096
    ds_read_b128 v[156:159], v233 offset:6144
    v_add_u32 v253, s71, v12
    ds_read_b64_tr_b16 v[208:209], v253 offset:0
    ds_read_b64_tr_b16 v[210:211], v253 offset:1024
    v_mfma_f32_16x16x32_bf16 v[20:23], v[80:83], v[116:119], v[20:23]
    ds_read_b64_tr_b16 v[120:121], v8 offset:24576
    v_mfma_f32_16x16x32_bf16 v[24:27], v[84:87], v[112:115], v[24:27]
    s_waitcnt lgkmcnt(7)
    ds_read_b64_tr_b16 v[122:123], v8 offset:25600
    ds_read_b64_tr_b16 v[124:125], v9 offset:24576
    v_mfma_f32_16x16x32_bf16 v[28:31], v[84:87], v[116:119], v[28:31]
    ds_read_b64_tr_b16 v[126:127], v9 offset:25600
    v_add_u32 v253, s71, v13
    ds_read_b64_tr_b16 v[212:213], v253 offset:0
    ds_read_b64_tr_b16 v[214:215], v253 offset:1024
    v_mfma_f32_16x16x32_bf16 v[32:35], v[88:91], v[112:115], v[32:35]
    ds_read_b64_tr_b16 v[128:129], v10 offset:24576
    ds_read_b64_tr_b16 v[130:131], v10 offset:25600
    v_mfma_f32_16x16x32_bf16 v[36:39], v[88:91], v[116:119], v[36:39]
    ds_read_b64_tr_b16 v[132:133], v11 offset:24576
    v_mfma_f32_16x16x32_bf16 v[40:43], v[92:95], v[112:115], v[40:43]
    s_waitcnt lgkmcnt(7)
    ds_read_b64_tr_b16 v[134:135], v11 offset:25600
    ds_read_b64_tr_b16 v[136:137], v12 offset:24576
    v_add_u32 v253, s71, v14
    ds_read_b64_tr_b16 v[216:217], v253 offset:0
    ds_read_b64_tr_b16 v[218:219], v253 offset:1024
    v_mfma_f32_16x16x32_bf16 v[44:47], v[92:95], v[116:119], v[44:47]
    ds_read_b64_tr_b16 v[138:139], v12 offset:25600
    v_mfma_f32_16x16x32_bf16 v[48:51], v[96:99], v[112:115], v[48:51]
    ds_read_b64_tr_b16 v[140:141], v13 offset:24576
    ds_read_b64_tr_b16 v[142:143], v13 offset:25600
    v_mfma_f32_16x16x32_bf16 v[52:55], v[96:99], v[116:119], v[52:55]
    ds_read_b64_tr_b16 v[144:145], v14 offset:24576
    v_add_u32 v253, s71, v15
    s_waitcnt lgkmcnt(7)
    ds_read_b64_tr_b16 v[220:221], v253 offset:0
    ds_read_b64_tr_b16 v[222:223], v253 offset:1024
    v_mfma_f32_16x16x32_bf16 v[56:59], v[100:103], v[112:115], v[56:59]
    ds_read_b64_tr_b16 v[146:147], v14 offset:25600
    ds_read_b64_tr_b16 v[148:149], v15 offset:24576
    v_mfma_f32_16x16x32_bf16 v[60:63], v[100:103], v[116:119], v[60:63]
    ds_read_b64_tr_b16 v[150:151], v15 offset:25600
    v_mfma_f32_16x16x32_bf16 v[64:67], v[104:107], v[112:115], v[64:67]
    v_mfma_f32_16x16x32_bf16 v[68:71], v[104:107], v[116:119], v[68:71]
    v_mfma_f32_16x16x32_bf16 v[72:75], v[108:111], v[112:115], v[72:75]
    v_mfma_f32_16x16x32_bf16 v[76:79], v[108:111], v[116:119], v[76:79]
    s_waitcnt lgkmcnt(0)
    s_waitcnt vmcnt(16)
    s_barrier
    v_mfma_f32_16x16x32_bf16 v[16:19], v[120:123], v[152:155], v[16:19]
    ds_read_b128 v[112:115], v232 offset:8192
    ds_read_b128 v[116:119], v232 offset:10240
    s_add_u32 m0, s82, 131072
    s_add_u32 s87, s4, 0
    buffer_load_dwordx4 v4, s[48:51], s87 offen offset:0 lds
    v_mfma_f32_16x16x32_bf16 v[20:23], v[120:123], v[156:159], v[20:23]
    ds_read_b64_tr_b16 v[80:81], v8 offset:32768
    buffer_load_dwordx4 v5, s[48:51], s87 offen offset:1024 lds
    v_mfma_f32_16x16x32_bf16 v[24:27], v[124:127], v[152:155], v[24:27]
    ds_read_b64_tr_b16 v[82:83], v8 offset:33792
    buffer_load_dwordx4 v6, s[48:51], s87 offen offset:2048 lds
    v_mfma_f32_16x16x32_bf16 v[28:31], v[124:127], v[156:159], v[28:31]
    ds_read_b64_tr_b16 v[84:85], v9 offset:32768
    buffer_load_dwordx4 v7, s[48:51], s87 offen offset:3072 lds
    v_mfma_f32_16x16x32_bf16 v[32:35], v[128:131], v[152:155], v[32:35]
    ds_read_b64_tr_b16 v[86:87], v9 offset:33792
    s_add_u32 m0, s82, 135168
    s_add_u32 s87, s4, 16384
    buffer_load_dwordx4 v4, s[48:51], s87 offen offset:0 lds
    v_mfma_f32_16x16x32_bf16 v[36:39], v[128:131], v[156:159], v[36:39]
    ds_read_b64_tr_b16 v[88:89], v10 offset:32768
    buffer_load_dwordx4 v5, s[48:51], s87 offen offset:1024 lds
    v_mfma_f32_16x16x32_bf16 v[40:43], v[132:135], v[152:155], v[40:43]
    ds_read_b64_tr_b16 v[90:91], v10 offset:33792
    buffer_load_dwordx4 v6, s[48:51], s87 offen offset:2048 lds
    v_mfma_f32_16x16x32_bf16 v[44:47], v[132:135], v[156:159], v[44:47]
    ds_read_b64_tr_b16 v[92:93], v11 offset:32768
    buffer_load_dwordx4 v7, s[48:51], s87 offen offset:3072 lds
    v_mfma_f32_16x16x32_bf16 v[48:51], v[136:139], v[152:155], v[48:51]
    ds_read_b64_tr_b16 v[94:95], v11 offset:33792
    ds_read_b64_tr_b16 v[96:97], v12 offset:32768
    buffer_load_dword v252, v241, s[60:63], 0 offen sc1
    v_mfma_f32_16x16x32_bf16 v[52:55], v[136:139], v[156:159], v[52:55]
    ds_read_b64_tr_b16 v[98:99], v12 offset:33792
    buffer_load_dword v242, v241, s[52:55], s18 offen
    v_mfma_f32_16x16x32_bf16 v[56:59], v[140:143], v[152:155], v[56:59]
    ds_read_b64_tr_b16 v[100:101], v13 offset:32768
    v_mfma_f32_16x16x32_bf16 v[60:63], v[140:143], v[156:159], v[60:63]
    ds_read_b64_tr_b16 v[102:103], v13 offset:33792
    v_mfma_f32_16x16x32_bf16 v[64:67], v[144:147], v[152:155], v[64:67]
    ds_read_b64_tr_b16 v[104:105], v14 offset:32768
    v_mfma_f32_16x16x32_bf16 v[68:71], v[144:147], v[156:159], v[68:71]
    s_waitcnt lgkmcnt(7)
    ds_read_b64_tr_b16 v[106:107], v14 offset:33792
    v_mfma_f32_16x16x32_bf16 v[72:75], v[148:151], v[152:155], v[72:75]
    ds_read_b64_tr_b16 v[108:109], v15 offset:32768
    v_mfma_f32_16x16x32_bf16 v[76:79], v[148:151], v[156:159], v[76:79]
    ds_read_b64_tr_b16 v[110:111], v15 offset:33792
    v_mfma_f32_16x16x32_bf16 v[16:19], v[80:83], v[112:115], v[16:19]
    ds_read_b128 v[152:155], v233 offset:8192
    ds_read_b128 v[156:159], v233 offset:10240
    v_mfma_f32_16x16x32_bf16 v[20:23], v[80:83], v[116:119], v[20:23]
    ds_read_b64_tr_b16 v[120:121], v8 offset:40960
    v_mfma_f32_16x16x32_bf16 v[24:27], v[84:87], v[112:115], v[24:27]
    ds_read_b64_tr_b16 v[122:123], v8 offset:41984
    ds_read_b64_tr_b16 v[124:125], v9 offset:40960
    v_mfma_f32_16x16x32_bf16 v[28:31], v[84:87], v[116:119], v[28:31]
    s_waitcnt lgkmcnt(7)
    ds_read_b64_tr_b16 v[126:127], v9 offset:41984
    v_mfma_f32_16x16x32_bf16 v[32:35], v[88:91], v[112:115], v[32:35]
    ds_read_b64_tr_b16 v[128:129], v10 offset:40960
    ds_read_b64_tr_b16 v[130:131], v10 offset:41984
    s_add_u32 m0, s78, 4096
    s_add_u32 s87, s93, 512
    buffer_load_dwordx4 v228, s[32:35], s87 offen offset:0 lds
    v_mfma_f32_16x16x32_bf16 v[36:39], v[88:91], v[116:119], v[36:39]
    ds_read_b64_tr_b16 v[132:133], v11 offset:40960
    v_mfma_f32_16x16x32_bf16 v[40:43], v[92:95], v[112:115], v[40:43]
    ds_read_b64_tr_b16 v[134:135], v11 offset:41984
    ds_read_b64_tr_b16 v[136:137], v12 offset:40960
    v_mfma_f32_16x16x32_bf16 v[44:47], v[92:95], v[116:119], v[44:47]
    ds_read_b64_tr_b16 v[138:139], v12 offset:41984
    buffer_load_dwordx4 v229, s[32:35], s87 offen offset:1024 lds
    v_mfma_f32_16x16x32_bf16 v[48:51], v[96:99], v[112:115], v[48:51]
    ds_read_b64_tr_b16 v[140:141], v13 offset:40960
    s_waitcnt lgkmcnt(7)
    ds_read_b64_tr_b16 v[142:143], v13 offset:41984
    v_mfma_f32_16x16x32_bf16 v[52:55], v[96:99], v[116:119], v[52:55]
    ds_read_b64_tr_b16 v[144:145], v14 offset:40960
    v_mfma_f32_16x16x32_bf16 v[56:59], v[100:103], v[112:115], v[56:59]
    ds_read_b64_tr_b16 v[146:147], v14 offset:41984
    ds_read_b64_tr_b16 v[148:149], v15 offset:40960
    buffer_load_dwordx4 v230, s[32:35], s87 offen offset:2048 lds
    v_mfma_f32_16x16x32_bf16 v[60:63], v[100:103], v[116:119], v[60:63]
    ds_read_b64_tr_b16 v[150:151], v15 offset:41984
    v_mfma_f32_16x16x32_bf16 v[64:67], v[104:107], v[112:115], v[64:67]
    v_mfma_f32_16x16x32_bf16 v[68:71], v[104:107], v[116:119], v[68:71]
    buffer_load_dwordx4 v231, s[32:35], s87 offen offset:3072 lds
    v_mfma_f32_16x16x32_bf16 v[72:75], v[108:111], v[112:115], v[72:75]
    v_mfma_f32_16x16x32_bf16 v[76:79], v[108:111], v[116:119], v[76:79]
    s_add_u32 m0, s81, 16384
    s_add_u32 s87, s89, 2097152
    buffer_load_dwordx4 v224, s[44:47], s87 offen offset:0 lds
    s_waitcnt lgkmcnt(0)
    s_waitcnt vmcnt(23)
    s_barrier
    v_mfma_f32_16x16x32_bf16 v[16:19], v[120:123], v[152:155], v[16:19]
    ds_read_b128 v[112:115], v232 offset:12288
    ds_read_b128 v[116:119], v232 offset:14336
    v_mfma_f32_16x16x32_bf16 v[20:23], v[120:123], v[156:159], v[20:23]
    ds_read_b64_tr_b16 v[80:81], v8 offset:49152
    v_mfma_f32_16x16x32_bf16 v[24:27], v[124:127], v[152:155], v[24:27]
    ds_read_b64_tr_b16 v[82:83], v8 offset:50176
    buffer_load_dwordx4 v225, s[44:47], s87 offen offset:1024 lds
    v_mfma_f32_16x16x32_bf16 v[28:31], v[124:127], v[156:159], v[28:31]
    ds_read_b64_tr_b16 v[84:85], v9 offset:49152
    v_mfma_f32_16x16x32_bf16 v[32:35], v[128:131], v[152:155], v[32:35]
    ds_read_b64_tr_b16 v[86:87], v9 offset:50176
    v_mfma_f32_16x16x32_bf16 v[36:39], v[128:131], v[156:159], v[36:39]
    ds_read_b64_tr_b16 v[88:89], v10 offset:49152
    buffer_load_dwordx4 v226, s[44:47], s87 offen offset:2048 lds
    v_mfma_f32_16x16x32_bf16 v[40:43], v[132:135], v[152:155], v[40:43]
    ds_read_b64_tr_b16 v[90:91], v10 offset:50176
    v_mfma_f32_16x16x32_bf16 v[44:47], v[132:135], v[156:159], v[44:47]
    ds_read_b64_tr_b16 v[92:93], v11 offset:49152
    buffer_load_dwordx4 v227, s[44:47], s87 offen offset:3072 lds
    v_mfma_f32_16x16x32_bf16 v[48:51], v[136:139], v[152:155], v[48:51]
    ds_read_b64_tr_b16 v[94:95], v11 offset:50176
    ds_read_b64_tr_b16 v[96:97], v12 offset:49152
    s_add_u32 m0, s78, 8192
    s_add_u32 s87, s93, 640
    buffer_load_dwordx4 v228, s[32:35], s87 offen offset:0 lds
    v_mfma_f32_16x16x32_bf16 v[52:55], v[136:139], v[156:159], v[52:55]
    ds_read_b64_tr_b16 v[98:99], v12 offset:50176
    buffer_load_dwordx4 v229, s[32:35], s87 offen offset:1024 lds
    v_mfma_f32_16x16x32_bf16 v[56:59], v[140:143], v[152:155], v[56:59]
    ds_read_b64_tr_b16 v[100:101], v13 offset:49152
    v_mfma_f32_16x16x32_bf16 v[60:63], v[140:143], v[156:159], v[60:63]
    ds_read_b64_tr_b16 v[102:103], v13 offset:50176
    buffer_load_dwordx4 v230, s[32:35], s87 offen offset:2048 lds
    v_mfma_f32_16x16x32_bf16 v[64:67], v[144:147], v[152:155], v[64:67]
    ds_read_b64_tr_b16 v[104:105], v14 offset:49152
    v_mfma_f32_16x16x32_bf16 v[68:71], v[144:147], v[156:159], v[68:71]
    s_waitcnt lgkmcnt(7)
    ds_read_b64_tr_b16 v[106:107], v14 offset:50176
    v_mfma_f32_16x16x32_bf16 v[72:75], v[148:151], v[152:155], v[72:75]
    ds_read_b64_tr_b16 v[108:109], v15 offset:49152
    buffer_load_dwordx4 v231, s[32:35], s87 offen offset:3072 lds
    v_mfma_f32_16x16x32_bf16 v[76:79], v[148:151], v[156:159], v[76:79]
    ds_read_b64_tr_b16 v[110:111], v15 offset:50176
    v_mfma_f32_16x16x32_bf16 v[16:19], v[80:83], v[112:115], v[16:19]
    ds_read_b128 v[152:155], v233 offset:12288
    ds_read_b128 v[156:159], v233 offset:14336
    s_add_u32 m0, s81, 32768
    s_add_u32 s87, s89, 2621440
    buffer_load_dwordx4 v224, s[44:47], s87 offen offset:0 lds
    v_mfma_f32_16x16x32_bf16 v[20:23], v[80:83], v[116:119], v[20:23]
    ds_read_b64_tr_b16 v[120:121], v8 offset:57344
    v_mfma_f32_16x16x32_bf16 v[24:27], v[84:87], v[112:115], v[24:27]
    ds_read_b64_tr_b16 v[122:123], v8 offset:58368
    ds_read_b64_tr_b16 v[124:125], v9 offset:57344
    v_mfma_f32_16x16x32_bf16 v[28:31], v[84:87], v[116:119], v[28:31]
    s_waitcnt lgkmcnt(7)
    ds_read_b64_tr_b16 v[126:127], v9 offset:58368
    buffer_load_dwordx4 v225, s[44:47], s87 offen offset:1024 lds
    v_mfma_f32_16x16x32_bf16 v[32:35], v[88:91], v[112:115], v[32:35]
    ds_read_b64_tr_b16 v[128:129], v10 offset:57344
    ds_read_b64_tr_b16 v[130:131], v10 offset:58368
    v_mfma_f32_16x16x32_bf16 v[36:39], v[88:91], v[116:119], v[36:39]
    ds_read_b64_tr_b16 v[132:133], v11 offset:57344
    v_mfma_f32_16x16x32_bf16 v[40:43], v[92:95], v[112:115], v[40:43]
    ds_read_b64_tr_b16 v[134:135], v11 offset:58368
    ds_read_b64_tr_b16 v[136:137], v12 offset:57344
    buffer_load_dwordx4 v226, s[44:47], s87 offen offset:2048 lds
    v_mfma_f32_16x16x32_bf16 v[44:47], v[92:95], v[116:119], v[44:47]
    ds_read_b64_tr_b16 v[138:139], v12 offset:58368
    v_mfma_f32_16x16x32_bf16 v[48:51], v[96:99], v[112:115], v[48:51]
    ds_read_b64_tr_b16 v[140:141], v13 offset:57344
    s_waitcnt lgkmcnt(7)
    ds_read_b64_tr_b16 v[142:143], v13 offset:58368
    buffer_load_dwordx4 v227, s[44:47], s87 offen offset:3072 lds
    v_mfma_f32_16x16x32_bf16 v[52:55], v[96:99], v[116:119], v[52:55]
    ds_read_b64_tr_b16 v[144:145], v14 offset:57344
    v_mfma_f32_16x16x32_bf16 v[56:59], v[100:103], v[112:115], v[56:59]
    ds_read_b64_tr_b16 v[146:147], v14 offset:58368
    ds_read_b64_tr_b16 v[148:149], v15 offset:57344
    v_mfma_f32_16x16x32_bf16 v[60:63], v[100:103], v[116:119], v[60:63]
    ds_read_b64_tr_b16 v[150:151], v15 offset:58368
    v_mfma_f32_16x16x32_bf16 v[64:67], v[104:107], v[112:115], v[64:67]
    v_mfma_f32_16x16x32_bf16 v[68:71], v[104:107], v[116:119], v[68:71]
    v_mfma_f32_16x16x32_bf16 v[72:75], v[108:111], v[112:115], v[72:75]
    v_mfma_f32_16x16x32_bf16 v[76:79], v[108:111], v[116:119], v[76:79]
    s_waitcnt lgkmcnt(0)
    s_waitcnt vmcnt(26)
    s_barrier
    v_mfma_f32_16x16x32_bf16 v[16:19], v[120:123], v[152:155], v[16:19]
    ds_read_b128 v[112:115], v232 offset:0
    ds_read_b128 v[116:119], v232 offset:2048
    s_add_u32 m0, s78, 12288
    s_add_u32 s87, s93, 896
    buffer_load_dwordx4 v228, s[32:35], s87 offen offset:0 lds
    v_mfma_f32_16x16x32_bf16 v[20:23], v[120:123], v[156:159], v[20:23]
    ds_read_b64_tr_b16 v[80:81], v8 offset:0
    buffer_load_dwordx4 v229, s[32:35], s87 offen offset:1024 lds
    v_mfma_f32_16x16x32_bf16 v[24:27], v[124:127], v[152:155], v[24:27]
    ds_read_b64_tr_b16 v[82:83], v8 offset:1024
    buffer_load_dwordx4 v230, s[32:35], s87 offen offset:2048 lds
    v_mfma_f32_16x16x32_bf16 v[28:31], v[124:127], v[156:159], v[28:31]
    ds_read_b64_tr_b16 v[84:85], v9 offset:0
    buffer_load_dwordx4 v231, s[32:35], s87 offen offset:3072 lds
    v_mfma_f32_16x16x32_bf16 v[32:35], v[128:131], v[152:155], v[32:35]
    ds_read_b64_tr_b16 v[86:87], v9 offset:1024
    v_mfma_f32_16x16x32_bf16 v[36:39], v[128:131], v[156:159], v[36:39]
    ds_read_b64_tr_b16 v[88:89], v10 offset:0
    v_mfma_f32_16x16x32_bf16 v[40:43], v[132:135], v[152:155], v[40:43]
    ds_read_b64_tr_b16 v[90:91], v10 offset:1024
    s_add_u32 m0, s81, 49152
    s_add_u32 s87, s89, 3670016
    buffer_load_dwordx4 v224, s[44:47], s87 offen offset:0 lds
    v_mfma_f32_16x16x32_bf16 v[44:47], v[132:135], v[156:159], v[44:47]
    ds_read_b64_tr_b16 v[92:93], v11 offset:0
    v_mfma_f32_16x16x32_bf16 v[48:51], v[136:139], v[152:155], v[48:51]
    ds_read_b64_tr_b16 v[94:95], v11 offset:1024
    ds_read_b64_tr_b16 v[96:97], v12 offset:0
    buffer_load_dwordx4 v225, s[44:47], s87 offen offset:1024 lds
    v_mfma_f32_16x16x32_bf16 v[52:55], v[136:139], v[156:159], v[52:55]
    ds_read_b64_tr_b16 v[98:99], v12 offset:1024
    v_mfma_f32_16x16x32_bf16 v[56:59], v[140:143], v[152:155], v[56:59]
    ds_read_b64_tr_b16 v[100:101], v13 offset:0
    v_mfma_f32_16x16x32_bf16 v[60:63], v[140:143], v[156:159], v[60:63]
    ds_read_b64_tr_b16 v[102:103], v13 offset:1024
    buffer_load_dwordx4 v226, s[44:47], s87 offen offset:2048 lds
    v_mfma_f32_16x16x32_bf16 v[64:67], v[144:147], v[152:155], v[64:67]
    ds_read_b64_tr_b16 v[104:105], v14 offset:0
    v_mfma_f32_16x16x32_bf16 v[68:71], v[144:147], v[156:159], v[68:71]
    s_waitcnt lgkmcnt(7)
    ds_read_b64_tr_b16 v[106:107], v14 offset:1024
    v_mfma_f32_16x16x32_bf16 v[72:75], v[148:151], v[152:155], v[72:75]
    ds_read_b64_tr_b16 v[108:109], v15 offset:0
    buffer_load_dwordx4 v227, s[44:47], s87 offen offset:3072 lds
    v_mfma_f32_16x16x32_bf16 v[76:79], v[148:151], v[156:159], v[76:79]
    ds_read_b64_tr_b16 v[110:111], v15 offset:1024
    v_mfma_f32_16x16x32_bf16 v[16:19], v[80:83], v[112:115], v[16:19]
    ds_read_b128 v[152:155], v233 offset:0
    ds_read_b128 v[156:159], v233 offset:2048
    v_mfma_f32_16x16x32_bf16 v[20:23], v[80:83], v[116:119], v[20:23]
    ds_read_b64_tr_b16 v[120:121], v8 offset:8192
    v_mfma_f32_16x16x32_bf16 v[24:27], v[84:87], v[112:115], v[24:27]
    ds_read_b64_tr_b16 v[122:123], v8 offset:9216
    ds_read_b64_tr_b16 v[124:125], v9 offset:8192
    v_mfma_f32_16x16x32_bf16 v[28:31], v[84:87], v[116:119], v[28:31]
    s_waitcnt lgkmcnt(7)
    ds_read_b64_tr_b16 v[126:127], v9 offset:9216
    v_mfma_f32_16x16x32_bf16 v[32:35], v[88:91], v[112:115], v[32:35]
    ds_read_b64_tr_b16 v[128:129], v10 offset:8192
    ds_read_b64_tr_b16 v[130:131], v10 offset:9216
    v_mfma_f32_16x16x32_bf16 v[36:39], v[88:91], v[116:119], v[36:39]
    ds_read_b64_tr_b16 v[132:133], v11 offset:8192
    v_mfma_f32_16x16x32_bf16 v[40:43], v[92:95], v[112:115], v[40:43]
    ds_read_b64_tr_b16 v[134:135], v11 offset:9216
    ds_read_b64_tr_b16 v[136:137], v12 offset:8192
    v_mfma_f32_16x16x32_bf16 v[44:47], v[92:95], v[116:119], v[44:47]
    ds_read_b64_tr_b16 v[138:139], v12 offset:9216
    v_mfma_f32_16x16x32_bf16 v[48:51], v[96:99], v[112:115], v[48:51]
    ds_read_b64_tr_b16 v[140:141], v13 offset:8192
    s_waitcnt lgkmcnt(7)
    ds_read_b64_tr_b16 v[142:143], v13 offset:9216
    v_mfma_f32_16x16x32_bf16 v[52:55], v[96:99], v[116:119], v[52:55]
    ds_read_b64_tr_b16 v[144:145], v14 offset:8192
    v_mfma_f32_16x16x32_bf16 v[56:59], v[100:103], v[112:115], v[56:59]
    ds_read_b64_tr_b16 v[146:147], v14 offset:9216
    ds_read_b64_tr_b16 v[148:149], v15 offset:8192
    v_mfma_f32_16x16x32_bf16 v[60:63], v[100:103], v[116:119], v[60:63]
    ds_read_b64_tr_b16 v[150:151], v15 offset:9216
    v_mfma_f32_16x16x32_bf16 v[64:67], v[104:107], v[112:115], v[64:67]
    v_mfma_f32_16x16x32_bf16 v[68:71], v[104:107], v[116:119], v[68:71]
    v_mfma_f32_16x16x32_bf16 v[72:75], v[108:111], v[112:115], v[72:75]
    v_mfma_f32_16x16x32_bf16 v[76:79], v[108:111], v[116:119], v[76:79]
    s_waitcnt lgkmcnt(0)
    s_waitcnt vmcnt(16)
    s_barrier
    v_mfma_f32_16x16x32_bf16 v[16:19], v[120:123], v[152:155], v[16:19]
    ds_read_b128 v[112:115], v232 offset:4096
    ds_read_b128 v[116:119], v232 offset:6144
    s_add_u32 m0, s81, 0
    s_add_u32 s87, s4, 65536
    buffer_load_dwordx4 v4, s[48:51], s87 offen offset:0 lds
    v_mfma_f32_16x16x32_bf16 v[20:23], v[120:123], v[156:159], v[20:23]
    ds_read_b64_tr_b16 v[80:81], v8 offset:16384
    buffer_load_dwordx4 v5, s[48:51], s87 offen offset:1024 lds
    v_mfma_f32_16x16x32_bf16 v[24:27], v[124:127], v[152:155], v[24:27]
    ds_read_b64_tr_b16 v[82:83], v8 offset:17408
    buffer_load_dwordx4 v6, s[48:51], s87 offen offset:2048 lds
    v_mfma_f32_16x16x32_bf16 v[28:31], v[124:127], v[156:159], v[28:31]
    ds_read_b64_tr_b16 v[84:85], v9 offset:16384
    buffer_load_dwordx4 v7, s[48:51], s87 offen offset:3072 lds
    s_add_u32 s71, s82, 131072
    v_add_u32 v253, s71, v244
    ds_read_b64_tr_b16 a[0:1], v253 offset:0
    ds_read_b64_tr_b16 a[2:3], v253 offset:1024
    v_mfma_f32_16x16x32_bf16 v[32:35], v[128:131], v[152:155], v[32:35]
    ds_read_b64_tr_b16 v[86:87], v9 offset:17408
    s_add_u32 m0, s78, 0
    s_add_u32 s87, s4, 81920
    buffer_load_dwordx4 v4, s[48:51], s87 offen offset:0 lds
    v_mfma_f32_16x16x32_bf16 v[36:39], v[128:131], v[156:159], v[36:39]
    ds_read_b64_tr_b16 v[88:89], v10 offset:16384
    buffer_load_dwordx4 v5, s[48:51], s87 offen offset:1024 lds
    v_mfma_f32_16x16x32_bf16 v[40:43], v[132:135], v[152:155], v[40:43]
    ds_read_b64_tr_b16 v[90:91], v10 offset:17408
    buffer_load_dwordx4 v6, s[48:51], s87 offen offset:2048 lds
    v_add_u32 v253, s71, v245
    ds_read_b64_tr_b16 a[4:5], v253 offset:0
    ds_read_b64_tr_b16 a[6:7], v253 offset:1024
    v_mfma_f32_16x16x32_bf16 v[44:47], v[132:135], v[156:159], v[44:47]
    ds_read_b64_tr_b16 v[92:93], v11 offset:16384
    buffer_load_dwordx4 v7, s[48:51], s87 offen offset:3072 lds
    v_mfma_f32_16x16x32_bf16 v[48:51], v[136:139], v[152:155], v[48:51]
    ds_read_b64_tr_b16 v[94:95], v11 offset:17408
    ds_read_b64_tr_b16 v[96:97], v12 offset:16384
    v_mfma_f32_16x16x32_bf16 v[52:55], v[136:139], v[156:159], v[52:55]
    s_waitcnt lgkmcnt(7)
    ds_read_b64_tr_b16 v[98:99], v12 offset:17408
    v_add_u32 v253, s71, v246
    ds_read_b64_tr_b16 a[8:9], v253 offset:0
    ds_read_b64_tr_b16 a[10:11], v253 offset:1024
    v_mfma_f32_16x16x32_bf16 v[56:59], v[140:143], v[152:155], v[56:59]
    ds_read_b64_tr_b16 v[100:101], v13 offset:16384
    v_mfma_f32_16x16x32_bf16 v[60:63], v[140:143], v[156:159], v[60:63]
    ds_read_b64_tr_b16 v[102:103], v13 offset:17408
    v_mfma_f32_16x16x32_bf16 v[64:67], v[144:147], v[152:155], v[64:67]
    ds_read_b64_tr_b16 v[104:105], v14 offset:16384
    v_add_u32 v253, s71, v247
    ds_read_b64_tr_b16 a[12:13], v253 offset:0
    ds_read_b64_tr_b16 a[14:15], v253 offset:1024
    v_mfma_f32_16x16x32_bf16 v[68:71], v[144:147], v[156:159], v[68:71]
    s_waitcnt lgkmcnt(7)
    ds_read_b64_tr_b16 v[106:107], v14 offset:17408
    v_mfma_f32_16x16x32_bf16 v[72:75], v[148:151], v[152:155], v[72:75]
    ds_read_b64_tr_b16 v[108:109], v15 offset:16384
    v_mfma_f32_16x16x32_bf16 v[76:79], v[148:151], v[156:159], v[76:79]
    ds_read_b64_tr_b16 v[110:111], v15 offset:17408
    v_mfma_f32_16x16x32_bf16 v[16:19], v[80:83], v[112:115], v[16:19]
    ds_read_b128 v[152:155], v233 offset:4096
    ds_read_b128 v[156:159], v233 offset:6144
    s_add_u32 s71, s82, 135168
    v_add_u32 v253, s71, v244
    ds_read_b64_tr_b16 a[16:17], v253 offset:0
    ds_read_b64_tr_b16 a[18:19], v253 offset:1024
    v_mfma_f32_16x16x32_bf16 v[20:23], v[80:83], v[116:119], v[20:23]
    ds_read_b64_tr_b16 v[120:121], v8 offset:24576
    v_mfma_f32_16x16x32_bf16 v[24:27], v[84:87], v[112:115], v[24:27]
    s_waitcnt lgkmcnt(7)
    ds_read_b64_tr_b16 v[122:123], v8 offset:25600
    ds_read_b64_tr_b16 v[124:125], v9 offset:24576
    v_mfma_f32_16x16x32_bf16 v[28:31], v[84:87], v[116:119], v[28:31]
    ds_read_b64_tr_b16 v[126:127], v9 offset:25600
    v_add_u32 v253, s71, v245
    ds_read_b64_tr_b16 a[20:21], v253 offset:0
    ds_read_b64_tr_b16 a[22:23], v253 offset:1024
    v_mfma_f32_16x16x32_bf16 v[32:35], v[88:91], v[112:115], v[32:35]
    ds_read_b64_tr_b16 v[128:129], v10 offset:24576
    ds_read_b64_tr_b16 v[130:131], v10 offset:25600
    v_mfma_f32_16x16x32_bf16 v[36:39], v[88:91], v[116:119], v[36:39]
    ds_read_b64_tr_b16 v[132:133], v11 offset:24576
    v_mfma_f32_16x16x32_bf16 v[40:43], v[92:95], v[112:115], v[40:43]
    s_waitcnt lgkmcnt(7)
    ds_read_b64_tr_b16 v[134:135], v11 offset:25600
    ds_read_b64_tr_b16 v[136:137], v12 offset:24576
    v_add_u32 v253, s71, v246
    ds_read_b64_tr_b16 a[24:25], v253 offset:0
    ds_read_b64_tr_b16 a[26:27], v253 offset:1024
    v_mfma_f32_16x16x32_bf16 v[44:47], v[92:95], v[116:119], v[44:47]
    ds_read_b64_tr_b16 v[138:139], v12 offset:25600
    v_mfma_f32_16x16x32_bf16 v[48:51], v[96:99], v[112:115], v[48:51]
    ds_read_b64_tr_b16 v[140:141], v13 offset:24576
    ds_read_b64_tr_b16 v[142:143], v13 offset:25600
    v_mfma_f32_16x16x32_bf16 v[52:55], v[96:99], v[116:119], v[52:55]
    ds_read_b64_tr_b16 v[144:145], v14 offset:24576
    v_add_u32 v253, s71, v247
    s_waitcnt lgkmcnt(7)
    ds_read_b64_tr_b16 a[28:29], v253 offset:0
    ds_read_b64_tr_b16 a[30:31], v253 offset:1024
    v_mfma_f32_16x16x32_bf16 v[56:59], v[100:103], v[112:115], v[56:59]
    ds_read_b64_tr_b16 v[146:147], v14 offset:25600
    ds_read_b64_tr_b16 v[148:149], v15 offset:24576
    v_mfma_f32_16x16x32_bf16 v[60:63], v[100:103], v[116:119], v[60:63]
    ds_read_b64_tr_b16 v[150:151], v15 offset:25600
    v_mfma_f32_16x16x32_bf16 v[64:67], v[104:107], v[112:115], v[64:67]
    v_mfma_f32_16x16x32_bf16 v[68:71], v[104:107], v[116:119], v[68:71]
    v_mfma_f32_16x16x32_bf16 v[72:75], v[108:111], v[112:115], v[72:75]
    v_mfma_f32_16x16x32_bf16 v[76:79], v[108:111], v[116:119], v[76:79]
    s_waitcnt lgkmcnt(0)
    s_waitcnt vmcnt(16)
    s_barrier
    v_mfma_f32_16x16x32_bf16 v[16:19], v[120:123], v[152:155], v[16:19]
    ds_read_b128 v[112:115], v232 offset:8192
    ds_read_b128 v[116:119], v232 offset:10240
    v_mfma_f32_16x16x32_bf16 v[20:23], v[120:123], v[156:159], v[20:23]
    ds_read_b64_tr_b16 v[80:81], v8 offset:32768
    v_mfma_f32_16x16x32_bf16 v[24:27], v[124:127], v[152:155], v[24:27]
    ds_read_b64_tr_b16 v[82:83], v8 offset:33792
    v_mfma_f32_16x16x32_bf16 v[28:31], v[124:127], v[156:159], v[28:31]
    ds_read_b64_tr_b16 v[84:85], v9 offset:32768
    v_mfma_f32_16x16x32_bf16 v[32:35], v[128:131], v[152:155], v[32:35]
    ds_read_b64_tr_b16 v[86:87], v9 offset:33792
    v_mfma_f32_16x16x32_bf16 v[36:39], v[128:131], v[156:159], v[36:39]
    ds_read_b64_tr_b16 v[88:89], v10 offset:32768
    v_mfma_f32_16x16x32_bf16 v[40:43], v[132:135], v[152:155], v[40:43]
    ds_read_b64_tr_b16 v[90:91], v10 offset:33792
    v_mfma_f32_16x16x32_bf16 v[44:47], v[132:135], v[156:159], v[44:47]
    ds_read_b64_tr_b16 v[92:93], v11 offset:32768
    v_mfma_f32_16x16x32_bf16 v[48:51], v[136:139], v[152:155], v[48:51]
    ds_read_b64_tr_b16 v[94:95], v11 offset:33792
    ds_read_b64_tr_b16 v[96:97], v12 offset:32768
    v_mfma_f32_16x16x32_bf16 v[52:55], v[136:139], v[156:159], v[52:55]
    ds_read_b64_tr_b16 v[98:99], v12 offset:33792
    v_mfma_f32_16x16x32_bf16 v[56:59], v[140:143], v[152:155], v[56:59]
    ds_read_b64_tr_b16 v[100:101], v13 offset:32768
    v_mfma_f32_16x16x32_bf16 v[60:63], v[140:143], v[156:159], v[60:63]
    ds_read_b64_tr_b16 v[102:103], v13 offset:33792
    v_mfma_f32_16x16x32_bf16 v[64:67], v[144:147], v[152:155], v[64:67]
    ds_read_b64_tr_b16 v[104:105], v14 offset:32768
    v_mfma_f32_16x16x32_bf16 v[68:71], v[144:147], v[156:159], v[68:71]
    s_waitcnt lgkmcnt(7)
    ds_read_b64_tr_b16 v[106:107], v14 offset:33792
    v_mfma_f32_16x16x32_bf16 v[72:75], v[148:151], v[152:155], v[72:75]
    ds_read_b64_tr_b16 v[108:109], v15 offset:32768
    v_mfma_f32_16x16x32_bf16 v[76:79], v[148:151], v[156:159], v[76:79]
    ds_read_b64_tr_b16 v[110:111], v15 offset:33792
    v_mfma_f32_16x16x32_bf16 v[16:19], v[80:83], v[112:115], v[16:19]
    ds_read_b128 v[152:155], v233 offset:8192
    ds_read_b128 v[156:159], v233 offset:10240
    v_mfma_f32_16x16x32_bf16 v[20:23], v[80:83], v[116:119], v[20:23]
    ds_read_b64_tr_b16 v[120:121], v8 offset:40960
    v_mfma_f32_16x16x32_bf16 v[24:27], v[84:87], v[112:115], v[24:27]
    ds_read_b64_tr_b16 v[122:123], v8 offset:41984
    ds_read_b64_tr_b16 v[124:125], v9 offset:40960
    v_mfma_f32_16x16x32_bf16 v[28:31], v[84:87], v[116:119], v[28:31]
    s_waitcnt lgkmcnt(7)
    ds_read_b64_tr_b16 v[126:127], v9 offset:41984
    v_mfma_f32_16x16x32_bf16 v[32:35], v[88:91], v[112:115], v[32:35]
    ds_read_b64_tr_b16 v[128:129], v10 offset:40960
    ds_read_b64_tr_b16 v[130:131], v10 offset:41984
    v_mfma_f32_16x16x32_bf16 v[36:39], v[88:91], v[116:119], v[36:39]
    ds_read_b64_tr_b16 v[132:133], v11 offset:40960
    v_mfma_f32_16x16x32_bf16 v[40:43], v[92:95], v[112:115], v[40:43]
    ds_read_b64_tr_b16 v[134:135], v11 offset:41984
    ds_read_b64_tr_b16 v[136:137], v12 offset:40960
    v_mfma_f32_16x16x32_bf16 v[44:47], v[92:95], v[116:119], v[44:47]
    ds_read_b64_tr_b16 v[138:139], v12 offset:41984
    v_mfma_f32_16x16x32_bf16 v[48:51], v[96:99], v[112:115], v[48:51]
    ds_read_b64_tr_b16 v[140:141], v13 offset:40960
    s_waitcnt lgkmcnt(7)
    ds_read_b64_tr_b16 v[142:143], v13 offset:41984
    v_mfma_f32_16x16x32_bf16 v[52:55], v[96:99], v[116:119], v[52:55]
    ds_read_b64_tr_b16 v[144:145], v14 offset:40960
    v_mfma_f32_16x16x32_bf16 v[56:59], v[100:103], v[112:115], v[56:59]
    ds_read_b64_tr_b16 v[146:147], v14 offset:41984
    ds_read_b64_tr_b16 v[148:149], v15 offset:40960
    v_mfma_f32_16x16x32_bf16 v[60:63], v[100:103], v[116:119], v[60:63]
    ds_read_b64_tr_b16 v[150:151], v15 offset:41984
    v_mfma_f32_16x16x32_bf16 v[64:67], v[104:107], v[112:115], v[64:67]
    v_mfma_f32_16x16x32_bf16 v[68:71], v[104:107], v[116:119], v[68:71]
    v_mfma_f32_16x16x32_bf16 v[72:75], v[108:111], v[112:115], v[72:75]
    v_mfma_f32_16x16x32_bf16 v[76:79], v[108:111], v[116:119], v[76:79]
    s_waitcnt lgkmcnt(0)
    s_waitcnt vmcnt(8)
    s_barrier
    v_mfma_f32_16x16x32_bf16 v[16:19], v[120:123], v[152:155], v[16:19]
    ds_read_b128 v[112:115], v232 offset:12288
    ds_read_b128 v[116:119], v232 offset:14336
    v_mfma_f32_16x16x32_bf16 v[20:23], v[120:123], v[156:159], v[20:23]
    ds_read_b64_tr_b16 v[80:81], v8 offset:49152
    v_mfma_f32_16x16x32_bf16 v[24:27], v[124:127], v[152:155], v[24:27]
    ds_read_b64_tr_b16 v[82:83], v8 offset:50176
    v_mfma_f32_16x16x32_bf16 v[28:31], v[124:127], v[156:159], v[28:31]
    ds_read_b64_tr_b16 v[84:85], v9 offset:49152
    v_mfma_f32_16x16x32_bf16 v[32:35], v[128:131], v[152:155], v[32:35]
    ds_read_b64_tr_b16 v[86:87], v9 offset:50176
    v_mfma_f32_16x16x32_bf16 v[36:39], v[128:131], v[156:159], v[36:39]
    ds_read_b64_tr_b16 v[88:89], v10 offset:49152
    v_mfma_f32_16x16x32_bf16 v[40:43], v[132:135], v[152:155], v[40:43]
    ds_read_b64_tr_b16 v[90:91], v10 offset:50176
    v_mfma_f32_16x16x32_bf16 v[44:47], v[132:135], v[156:159], v[44:47]
    ds_read_b64_tr_b16 v[92:93], v11 offset:49152
    v_mfma_f32_16x16x32_bf16 v[48:51], v[136:139], v[152:155], v[48:51]
    ds_read_b64_tr_b16 v[94:95], v11 offset:50176
    ds_read_b64_tr_b16 v[96:97], v12 offset:49152
    v_mfma_f32_16x16x32_bf16 v[52:55], v[136:139], v[156:159], v[52:55]
    ds_read_b64_tr_b16 v[98:99], v12 offset:50176
    v_mfma_f32_16x16x32_bf16 v[56:59], v[140:143], v[152:155], v[56:59]
    ds_read_b64_tr_b16 v[100:101], v13 offset:49152
    v_mfma_f32_16x16x32_bf16 v[60:63], v[140:143], v[156:159], v[60:63]
    ds_read_b64_tr_b16 v[102:103], v13 offset:50176
    v_mfma_f32_16x16x32_bf16 v[64:67], v[144:147], v[152:155], v[64:67]
    ds_read_b64_tr_b16 v[104:105], v14 offset:49152
    v_mfma_f32_16x16x32_bf16 v[68:71], v[144:147], v[156:159], v[68:71]
    s_waitcnt lgkmcnt(7)
    ds_read_b64_tr_b16 v[106:107], v14 offset:50176
    v_mfma_f32_16x16x32_bf16 v[72:75], v[148:151], v[152:155], v[72:75]
    ds_read_b64_tr_b16 v[108:109], v15 offset:49152
    v_mfma_f32_16x16x32_bf16 v[76:79], v[148:151], v[156:159], v[76:79]
    ds_read_b64_tr_b16 v[110:111], v15 offset:50176
    v_mfma_f32_16x16x32_bf16 v[16:19], v[80:83], v[112:115], v[16:19]
    ds_read_b128 v[152:155], v233 offset:12288
    ds_read_b128 v[156:159], v233 offset:14336
    v_mfma_f32_16x16x32_bf16 v[20:23], v[80:83], v[116:119], v[20:23]
    ds_read_b64_tr_b16 v[120:121], v8 offset:57344
    v_mfma_f32_16x16x32_bf16 v[24:27], v[84:87], v[112:115], v[24:27]
    ds_read_b64_tr_b16 v[122:123], v8 offset:58368
    ds_read_b64_tr_b16 v[124:125], v9 offset:57344
    v_mfma_f32_16x16x32_bf16 v[28:31], v[84:87], v[116:119], v[28:31]
    s_waitcnt lgkmcnt(7)
    ds_read_b64_tr_b16 v[126:127], v9 offset:58368
    v_mfma_f32_16x16x32_bf16 v[32:35], v[88:91], v[112:115], v[32:35]
    ds_read_b64_tr_b16 v[128:129], v10 offset:57344
    ds_read_b64_tr_b16 v[130:131], v10 offset:58368
    v_mfma_f32_16x16x32_bf16 v[36:39], v[88:91], v[116:119], v[36:39]
    ds_read_b64_tr_b16 v[132:133], v11 offset:57344
    v_mfma_f32_16x16x32_bf16 v[40:43], v[92:95], v[112:115], v[40:43]
    ds_read_b64_tr_b16 v[134:135], v11 offset:58368
    ds_read_b64_tr_b16 v[136:137], v12 offset:57344
    v_mfma_f32_16x16x32_bf16 v[44:47], v[92:95], v[116:119], v[44:47]
    ds_read_b64_tr_b16 v[138:139], v12 offset:58368
    v_mfma_f32_16x16x32_bf16 v[48:51], v[96:99], v[112:115], v[48:51]
    ds_read_b64_tr_b16 v[140:141], v13 offset:57344
    s_waitcnt lgkmcnt(7)
    ds_read_b64_tr_b16 v[142:143], v13 offset:58368
    v_mfma_f32_16x16x32_bf16 v[52:55], v[96:99], v[116:119], v[52:55]
    ds_read_b64_tr_b16 v[144:145], v14 offset:57344
    v_mfma_f32_16x16x32_bf16 v[56:59], v[100:103], v[112:115], v[56:59]
    ds_read_b64_tr_b16 v[146:147], v14 offset:58368
    ds_read_b64_tr_b16 v[148:149], v15 offset:57344
    v_mfma_f32_16x16x32_bf16 v[60:63], v[100:103], v[116:119], v[60:63]
    ds_read_b64_tr_b16 v[150:151], v15 offset:58368
    v_mfma_f32_16x16x32_bf16 v[64:67], v[104:107], v[112:115], v[64:67]
    v_mfma_f32_16x16x32_bf16 v[68:71], v[104:107], v[116:119], v[68:71]
    v_mfma_f32_16x16x32_bf16 v[72:75], v[108:111], v[112:115], v[72:75]
    v_mfma_f32_16x16x32_bf16 v[76:79], v[108:111], v[116:119], v[76:79]
    s_branch L_common
L_p1_3:
    s_waitcnt vmcnt(9)
    s_barrier
    ds_read_b128 v[112:115], v232 offset:0
    ds_read_b128 v[116:119], v232 offset:2048
    s_add_u32 m0, s78, 8192
    s_add_u32 s87, s92, 128
    buffer_load_dwordx4 v228, s[32:35], s87 offen offset:0 lds
    ds_read_b64_tr_b16 v[80:81], v8 offset:0
    buffer_load_dwordx4 v229, s[32:35], s87 offen offset:1024 lds
    ds_read_b64_tr_b16 v[82:83], v8 offset:1024
    buffer_load_dwordx4 v230, s[32:35], s87 offen offset:2048 lds
    ds_read_b64_tr_b16 v[84:85], v9 offset:0
    v_lshrrev_b32 v254, 4, v0
    v_bfe_u32 v255, v0, 2, 2
    v_xor_b32 v255, v255, v254
    ds_read_b64_tr_b16 v[86:87], v9 offset:1024
    v_lshlrev_b32 v255, 6, v255
    v_lshl_add_u32 v4, v254, 11, v255
    v_and_b32 v255, 3, v0
    ds_read_b64_tr_b16 v[88:89], v10 offset:0
    buffer_load_dwordx4 v231, s[32:35], s87 offen offset:3072 lds
    ds_read_b64_tr_b16 v[90:91], v10 offset:1024
    v_lshl_add_u32 v4, v255, 4, v4
    v_add_u32 v5, 31744, v4
    v_add_u32 v6, 6144, v4
    ds_read_b64_tr_b16 v[92:93], v11 offset:0
    s_add_u32 m0, s81, 32768
    s_add_u32 s87, s88, 524288
    buffer_load_dwordx4 v224, s[44:47], s87 offen offset:0 lds
    ds_read_b64_tr_b16 v[94:95], v11 offset:1024
    ds_read_b64_tr_b16 v[96:97], v12 offset:0
    v_add_u32 v7, 37888, v4
    v_bfe_u32 v251, v0, 2, 2
    v_lshrrev_b32 v254, 5, v0
    ds_read_b64_tr_b16 v[98:99], v12 offset:1024
    v_lshl_add_u32 v254, v254, 3, v251
    v_lshlrev_b32 v250, 8, v254
    v_bfe_u32 v254, v0, 4, 1
    ds_read_b64_tr_b16 v[100:101], v13 offset:0
    buffer_load_dwordx4 v225, s[44:47], s87 offen offset:1024 lds
    ds_read_b64_tr_b16 v[102:103], v13 offset:1024
    v_lshl_add_u32 v250, v254, 5, v250
    v_and_b32 v254, 1, v0
    v_lshl_add_u32 v250, v254, 4, v250
    ds_read_b64_tr_b16 v[104:105], v14 offset:0
    v_bfe_u32 v254, v0, 1, 1
    v_lshl_add_u32 v250, v254, 3, v250
    s_add_u32 s100, s64, 0
    s_waitcnt lgkmcnt(7)
    ds_read_b64_tr_b16 v[106:107], v14 offset:1024
    buffer_load_dwordx4 v226, s[44:47], s87 offen offset:2048 lds
    ds_read_b64_tr_b16 v[108:109], v15 offset:0
    s_and_b32 s100, s100, 3
    v_xor_b32 v254, s100, v251
    v_lshl_add_u32 v244, v254, 6, v250
    ds_read_b64_tr_b16 v[110:111], v15 offset:1024
    buffer_load_dwordx4 v227, s[44:47], s87 offen offset:3072 lds
    v_mfma_f32_16x16x32_bf16 v[16:19], v[80:83], v[112:115], 0
    ds_read_b128 v[152:155], v233 offset:0
    ds_read_b128 v[156:159], v233 offset:2048
    s_add_u32 s100, s64, 1
    v_mfma_f32_16x16x32_bf16 v[20:23], v[80:83], v[116:119], 0
    ds_read_b64_tr_b16 v[120:121], v8 offset:8192
    s_and_b32 s100, s100, 3
    v_mfma_f32_16x16x32_bf16 v[24:27], v[84:87], v[112:115], 0
    ds_read_b64_tr_b16 v[122:123], v8 offset:9216
    ds_read_b64_tr_b16 v[124:125], v9 offset:8192
    s_add_u32 m0, s78, 12288
    s_add_u32 s87, s92, 256
    buffer_load_dwordx4 v228, s[32:35], s87 offen offset:0 lds
    v_mfma_f32_16x16x32_bf16 v[28:31], v[84:87], v[116:119], 0
    s_waitcnt lgkmcnt(7)
    ds_read_b64_tr_b16 v[126:127], v9 offset:9216
    v_xor_b32 v254, s100, v251
    v_mfma_f32_16x16x32_bf16 v[32:35], v[88:91], v[112:115], 0
    ds_read_b64_tr_b16 v[128:129], v10 offset:8192
    ds_read_b64_tr_b16 v[130:131], v10 offset:9216
    v_lshl_add_u32 v245, v254, 6, v250
    v_mfma_f32_16x16x32_bf16 v[36:39], v[88:91], v[116:119], 0
    ds_read_b64_tr_b16 v[132:133], v11 offset:8192
    buffer_load_dwordx4 v229, s[32:35], s87 offen offset:1024 lds
    v_mfma_f32_16x16x32_bf16 v[40:43], v[92:95], v[112:115], 0
    ds_read_b64_tr_b16 v[134:135], v11 offset:9216
    ds_read_b64_tr_b16 v[136:137], v12 offset:8192
    s_add_u32 s100, s64, 2
    v_mfma_f32_16x16x32_bf16 v[44:47], v[92:95], v[116:119], 0
    ds_read_b64_tr_b16 v[138:139], v12 offset:9216
    buffer_load_dwordx4 v230, s[32:35], s87 offen offset:2048 lds
    v_mfma_f32_16x16x32_bf16 v[48:51], v[96:99], v[112:115], 0
    ds_read_b64_tr_b16 v[140:141], v13 offset:8192
    s_waitcnt lgkmcnt(7)
    ds_read_b64_tr_b16 v[142:143], v13 offset:9216
    s_and_b32 s100, s100, 3
    v_mfma_f32_16x16x32_bf16 v[52:55], v[96:99], v[116:119], 0
    ds_read_b64_tr_b16 v[144:145], v14 offset:8192
    v_xor_b32 v254, s100, v251
    v_mfma_f32_16x16x32_bf16 v[56:59], v[100:103], v[112:115], 0
    ds_read_b64_tr_b16 v[146:147], v14 offset:9216
    ds_read_b64_tr_b16 v[148:149], v15 offset:8192
    buffer_load_dwordx4 v231, s[32:35], s87 offen offset:3072 lds
    v_mfma_f32_16x16x32_bf16 v[60:63], v[100:103], v[116:119], 0
    ds_read_b64_tr_b16 v[150:151], v15 offset:9216
    v_lshl_add_u32 v246, v254, 6, v250
    v_mfma_f32_16x16x32_bf16 v[64:67], v[104:107], v[112:115], 0
    s_add_u32 s100, s64, 3
    v_mfma_f32_16x16x32_bf16 v[68:71], v[104:107], v[116:119], 0
    s_add_u32 m0, s81, 49152
    s_add_u32 s87, s88, 1048576
    buffer_load_dwordx4 v224, s[44:47], s87 offen offset:0 lds
    v_mfma_f32_16x16x32_bf16 v[72:75], v[108:111], v[112:115], 0
    s_and_b32 s100, s100, 3
    v_mfma_f32_16x16x32_bf16 v[76:79], v[108:111], v[116:119], 0
    buffer_load_dwordx4 v225, s[44:47], s87 offen offset:1024 lds
    s_waitcnt lgkmcnt(0)
    s_waitcnt vmcnt(15)
    s_barrier
    v_mfma_f32_16x16x32_bf16 v[16:19], v[120:123], v[152:155], v[16:19]
    ds_read_b128 v[112:115], v232 offset:4096
    ds_read_b128 v[116:119], v232 offset:6144
    v_xor_b32 v254, s100, v251
    v_mfma_f32_16x16x32_bf16 v[20:23], v[120:123], v[156:159], v[20:23]
    ds_read_b64_tr_b16 v[80:81], v8 offset:16384
    v_lshl_add_u32 v247, v254, 6, v250
    v_mfma_f32_16x16x32_bf16 v[24:27], v[124:127], v[152:155], v[24:27]
    ds_read_b64_tr_b16 v[82:83], v8 offset:17408
    buffer_load_dwordx4 v226, s[44:47], s87 offen offset:2048 lds
    v_mfma_f32_16x16x32_bf16 v[28:31], v[124:127], v[156:159], v[28:31]
    ds_read_b64_tr_b16 v[84:85], v9 offset:16384
    v_and_b32 v254, 3, v0
    v_mfma_f32_16x16x32_bf16 v[32:35], v[128:131], v[152:155], v[32:35]
    ds_read_b64_tr_b16 v[86:87], v9 offset:17408
    v_lshl_add_u32 v254, v251, 3, v254
    v_mfma_f32_16x16x32_bf16 v[36:39], v[128:131], v[156:159], v[36:39]
    ds_read_b64_tr_b16 v[88:89], v10 offset:16384
    buffer_load_dwordx4 v227, s[44:47], s87 offen offset:3072 lds
    v_mfma_f32_16x16x32_bf16 v[40:43], v[132:135], v[152:155], v[40:43]
    ds_read_b64_tr_b16 v[90:91], v10 offset:17408
    v_and_b32 v255, 15, v254
    v_mfma_f32_16x16x32_bf16 v[44:47], v[132:135], v[156:159], v[44:47]
    ds_read_b64_tr_b16 v[92:93], v11 offset:16384
    s_add_u32 m0, s78, 0
    s_add_u32 s87, s92, 512
    buffer_load_dwordx4 v228, s[32:35], s87 offen offset:0 lds
    v_mfma_f32_16x16x32_bf16 v[48:51], v[136:139], v[152:155], v[48:51]
    ds_read_b64_tr_b16 v[94:95], v11 offset:17408
    ds_read_b64_tr_b16 v[96:97], v12 offset:16384
    v_lshrrev_b32 v248, 5, v0
    v_mfma_f32_16x16x32_bf16 v[52:55], v[136:139], v[156:159], v[52:55]
    ds_read_b64_tr_b16 v[98:99], v12 offset:17408
    v_xor_b32 v255, v255, v248
    v_mfma_f32_16x16x32_bf16 v[56:59], v[140:143], v[152:155], v[56:59]
    ds_read_b64_tr_b16 v[100:101], v13 offset:16384
    buffer_load_dwordx4 v229, s[32:35], s87 offen offset:1024 lds
    v_mfma_f32_16x16x32_bf16 v[60:63], v[140:143], v[156:159], v[60:63]
    ds_read_b64_tr_b16 v[102:103], v13 offset:17408
    v_lshlrev_b32 v255, 4, v255
    v_mfma_f32_16x16x32_bf16 v[64:67], v[144:147], v[152:155], v[64:67]
    ds_read_b64_tr_b16 v[104:105], v14 offset:16384
    v_lshl_add_u32 v254, v254, 8, v255
    v_mfma_f32_16x16x32_bf16 v[68:71], v[144:147], v[156:159], v[68:71]
    s_waitcnt lgkmcnt(7)
    ds_read_b64_tr_b16 v[106:107], v14 offset:17408
    buffer_load_dwordx4 v230, s[32:35], s87 offen offset:2048 lds
    v_mfma_f32_16x16x32_bf16 v[72:75], v[148:151], v[152:155], v[72:75]
    ds_read_b64_tr_b16 v[108:109], v15 offset:16384
    v_bfe_u32 v255, v0, 4, 1
    v_mfma_f32_16x16x32_bf16 v[76:79], v[148:151], v[156:159], v[76:79]
    ds_read_b64_tr_b16 v[110:111], v15 offset:17408
    buffer_load_dwordx4 v231, s[32:35], s87 offen offset:3072 lds
    v_mfma_f32_16x16x32_bf16 v[16:19], v[80:83], v[112:115], v[16:19]
    ds_read_b128 v[152:155], v233 offset:4096
    ds_read_b128 v[156:159], v233 offset:6144
    v_lshl_add_u32 v254, v255, 3, v254
    v_mfma_f32_16x16x32_bf16 v[20:23], v[80:83], v[116:119], v[20:23]
    ds_read_b64_tr_b16 v[120:121], v8 offset:24576
    s_add_u32 s100, s82, 131072
    v_mfma_f32_16x16x32_bf16 v[24:27], v[84:87], v[112:115], v[24:27]
    ds_read_b64_tr_b16 v[122:123], v8 offset:25600
    ds_read_b64_tr_b16 v[124:125], v9 offset:24576
    s_add_u32 m0, s81, 0
    s_add_u32 s87, s88, 2097152
    buffer_load_dwordx4 v224, s[44:47], s87 offen offset:0 lds
    v_mfma_f32_16x16x32_bf16 v[28:31], v[84:87], v[116:119], v[28:31]
    s_waitcnt lgkmcnt(7)
    ds_read_b64_tr_b16 v[126:127], v9 offset:25600
    v_add_u32 v248, s100, v254
    v_mfma_f32_16x16x32_bf16 v[32:35], v[88:91], v[112:115], v[32:35]
    ds_read_b64_tr_b16 v[128:129], v10 offset:24576
    ds_read_b64_tr_b16 v[130:131], v10 offset:25600
    v_lshlrev_b32 v249, 4, v0
    v_mfma_f32_16x16x32_bf16 v[36:39], v[88:91], v[116:119], v[36:39]
    ds_read_b64_tr_b16 v[132:133], v11 offset:24576
    buffer_load_dwordx4 v225, s[44:47], s87 offen offset:1024 lds
    v_mfma_f32_16x16x32_bf16 v[40:43], v[92:95], v[112:115], v[40:43]
    ds_read_b64_tr_b16 v[134:135], v11 offset:25600
    ds_read_b64_tr_b16 v[136:137], v12 offset:24576
    v_mov_b32 v241, 0
    v_mfma_f32_16x16x32_bf16 v[44:47], v[92:95], v[116:119], v[44:47]
    ds_read_b64_tr_b16 v[138:139], v12 offset:25600
    buffer_load_dwordx4 v226, s[44:47], s87 offen offset:2048 lds
    v_mfma_f32_16x16x32_bf16 v[48:51], v[96:99], v[112:115], v[48:51]
    ds_read_b64_tr_b16 v[140:141], v13 offset:24576
    s_waitcnt lgkmcnt(7)
    ds_read_b64_tr_b16 v[142:143], v13 offset:25600
    s_lshl_b32 s98, s66, 2
    v_mfma_f32_16x16x32_bf16 v[52:55], v[96:99], v[116:119], v[52:55]
    ds_read_b64_tr_b16 v[144:145], v14 offset:24576
    s_add_u32 s98, s98, s64
    v_mfma_f32_16x16x32_bf16 v[56:59], v[100:103], v[112:115], v[56:59]
    ds_read_b64_tr_b16 v[146:147], v14 offset:25600
    ds_read_b64_tr_b16 v[148:149], v15 offset:24576
    buffer_load_dwordx4 v227, s[44:47], s87 offen offset:3072 lds
    v_mfma_f32_16x16x32_bf16 v[60:63], v[100:103], v[116:119], v[60:63]
    ds_read_b64_tr_b16 v[150:151], v15 offset:25600
    s_lshl_b32 s99, s98, 19
    v_mfma_f32_16x16x32_bf16 v[64:67], v[104:107], v[112:115], v[64:67]
    s_add_u32 s83, s67, 1
    v_mfma_f32_16x16x32_bf16 v[68:71], v[104:107], v[116:119], v[68:71]
    s_and_b32 s83, s83, 7
    v_mfma_f32_16x16x32_bf16 v[72:75], v[108:111], v[112:115], v[72:75]
    s_lshl_b32 s100, s83, 8
    v_mfma_f32_16x16x32_bf16 v[76:79], v[108:111], v[116:119], v[76:79]
    s_add_u32 s99, s99, s100
    s_waitcnt lgkmcnt(0)
    s_waitcnt vmcnt(16)
    s_barrier
    v_mfma_f32_16x16x32_bf16 v[16:19], v[120:123], v[152:155], v[16:19]
    ds_read_b128 v[112:115], v232 offset:8192
    ds_read_b128 v[116:119], v232 offset:10240
    s_add_u32 m0, s78, 4096
    s_add_u32 s87, s92, 896
    buffer_load_dwordx4 v228, s[32:35], s87 offen offset:0 lds
    v_mfma_f32_16x16x32_bf16 v[20:23], v[120:123], v[156:159], v[20:23]
    ds_read_b64_tr_b16 v[80:81], v8 offset:32768
    buffer_load_dwordx4 v229, s[32:35], s87 offen offset:1024 lds
    v_mfma_f32_16x16x32_bf16 v[24:27], v[124:127], v[152:155], v[24:27]
    ds_read_b64_tr_b16 v[82:83], v8 offset:33792
    buffer_load_dwordx4 v230, s[32:35], s87 offen offset:2048 lds
    v_mfma_f32_16x16x32_bf16 v[28:31], v[124:127], v[156:159], v[28:31]
    ds_read_b64_tr_b16 v[84:85], v9 offset:32768
    s_add_u32 s100, s79, 0
    v_mfma_f32_16x16x32_bf16 v[32:35], v[128:131], v[152:155], v[32:35]
    ds_read_b64_tr_b16 v[86:87], v9 offset:33792
    s_and_b32 s100, s100, 3
    v_mfma_f32_16x16x32_bf16 v[36:39], v[128:131], v[156:159], v[36:39]
    ds_read_b64_tr_b16 v[88:89], v10 offset:32768
    buffer_load_dwordx4 v231, s[32:35], s87 offen offset:3072 lds
    v_mfma_f32_16x16x32_bf16 v[40:43], v[132:135], v[152:155], v[40:43]
    ds_read_b64_tr_b16 v[90:91], v10 offset:33792
    s_lshl_b32 s101, s100, 17
    v_mfma_f32_16x16x32_bf16 v[44:47], v[132:135], v[156:159], v[44:47]
    ds_read_b64_tr_b16 v[92:93], v11 offset:32768
    s_add_u32 m0, s81, 16384
    s_add_u32 s87, s88, 3670016
    buffer_load_dwordx4 v224, s[44:47], s87 offen offset:0 lds
    v_mfma_f32_16x16x32_bf16 v[48:51], v[136:139], v[152:155], v[48:51]
    ds_read_b64_tr_b16 v[94:95], v11 offset:33792
    ds_read_b64_tr_b16 v[96:97], v12 offset:32768
    s_add_u32 s4, s99, s101
    v_mfma_f32_16x16x32_bf16 v[52:55], v[136:139], v[156:159], v[52:55]
    ds_read_b64_tr_b16 v[98:99], v12 offset:33792
    s_lshl_b32 s8, s100, 12
    v_mfma_f32_16x16x32_bf16 v[56:59], v[140:143], v[152:155], v[56:59]
    ds_read_b64_tr_b16 v[100:101], v13 offset:32768
    buffer_load_dwordx4 v225, s[44:47], s87 offen offset:1024 lds
    v_mfma_f32_16x16x32_bf16 v[60:63], v[140:143], v[156:159], v[60:63]
    ds_read_b64_tr_b16 v[102:103], v13 offset:33792
    s_add_u32 s12, s66, 1
    v_mfma_f32_16x16x32_bf16 v[64:67], v[144:147], v[152:155], v[64:67]
    ds_read_b64_tr_b16 v[104:105], v14 offset:32768
    s_and_b32 s12, s12, 3
    v_mfma_f32_16x16x32_bf16 v[68:71], v[144:147], v[156:159], v[68:71]
    s_waitcnt lgkmcnt(7)
    ds_read_b64_tr_b16 v[106:107], v14 offset:33792
    buffer_load_dwordx4 v226, s[44:47], s87 offen offset:2048 lds
    v_mfma_f32_16x16x32_bf16 v[72:75], v[148:151], v[152:155], v[72:75]
    ds_read_b64_tr_b16 v[108:109], v15 offset:32768
    s_add_u32 s100, s79, 1
    v_mfma_f32_16x16x32_bf16 v[76:79], v[148:151], v[156:159], v[76:79]
    ds_read_b64_tr_b16 v[110:111], v15 offset:33792
    buffer_load_dwordx4 v227, s[44:47], s87 offen offset:3072 lds
    v_mfma_f32_16x16x32_bf16 v[16:19], v[80:83], v[112:115], v[16:19]
    ds_read_b128 v[152:155], v233 offset:8192
    ds_read_b128 v[156:159], v233 offset:10240
    s_and_b32 s100, s100, 3
    v_mfma_f32_16x16x32_bf16 v[20:23], v[80:83], v[116:119], v[20:23]
    ds_read_b64_tr_b16 v[120:121], v8 offset:40960
    s_lshl_b32 s101, s100, 17
    v_mfma_f32_16x16x32_bf16 v[24:27], v[84:87], v[112:115], v[24:27]
    ds_read_b64_tr_b16 v[122:123], v8 offset:41984
    ds_read_b64_tr_b16 v[124:125], v9 offset:40960
    s_add_u32 m0, s82, 131072
    s_add_u32 s87, s80, 0
    v_xor_b32 v240, 0, v2
    buffer_load_dwordx4 v240, s[36:39], s87 offen offset:0 nt lds
    v_mfma_f32_16x16x32_bf16 v[28:31], v[84:87], v[116:119], v[28:31]
    s_waitcnt lgkmcnt(7)
    ds_read_b64_tr_b16 v[126:127], v9 offset:41984
    s_add_u32 s5, s99, s101
    v_mfma_f32_16x16x32_bf16 v[32:35], v[88:91], v[112:115], v[32:35]
    ds_read_b64_tr_b16 v[128:129], v10 offset:40960
    ds_read_b64_tr_b16 v[130:131], v10 offset:41984
    s_lshl_b32 s9, s100, 12
    v_mfma_f32_16x16x32_bf16 v[36:39], v[88:91], v[116:119], v[36:39]
    ds_read_b64_tr_b16 v[132:133], v11 offset:40960
    v_xor_b32 v240, 64, v2
    buffer_load_dwordx4 v240, s[36:39], s87 offen offset:1024 nt lds
    v_mfma_f32_16x16x32_bf16 v[40:43], v[92:95], v[112:115], v[40:43]
    ds_read_b64_tr_b16 v[134:135], v11 offset:41984
    ds_read_b64_tr_b16 v[136:137], v12 offset:40960
    s_add_u32 s13, s66, 2
    v_mfma_f32_16x16x32_bf16 v[44:47], v[92:95], v[116:119], v[44:47]
    ds_read_b64_tr_b16 v[138:139], v12 offset:41984
    s_and_b32 s13, s13, 3
    v_mfma_f32_16x16x32_bf16 v[48:51], v[96:99], v[112:115], v[48:51]
    ds_read_b64_tr_b16 v[140:141], v13 offset:40960
    s_waitcnt lgkmcnt(7)
    ds_read_b64_tr_b16 v[142:143], v13 offset:41984
    v_xor_b32 v240, 128, v2
    buffer_load_dwordx4 v240, s[36:39], s87 offen offset:2048 nt lds
    v_mfma_f32_16x16x32_bf16 v[52:55], v[96:99], v[116:119], v[52:55]
    ds_read_b64_tr_b16 v[144:145], v14 offset:40960
    s_add_u32 s100, s79, 2
    v_mfma_f32_16x16x32_bf16 v[56:59], v[100:103], v[112:115], v[56:59]
    ds_read_b64_tr_b16 v[146:147], v14 offset:41984
    ds_read_b64_tr_b16 v[148:149], v15 offset:40960
    v_xor_b32 v240, 192, v2
    buffer_load_dwordx4 v240, s[36:39], s87 offen offset:3072 nt lds
    v_mfma_f32_16x16x32_bf16 v[60:63], v[100:103], v[116:119], v[60:63]
    ds_read_b64_tr_b16 v[150:151], v15 offset:41984
    s_and_b32 s100, s100, 3
    v_mfma_f32_16x16x32_bf16 v[64:67], v[104:107], v[112:115], v[64:67]
    s_lshl_b32 s101, s100, 17
    v_mfma_f32_16x16x32_bf16 v[68:71], v[104:107], v[116:119], v[68:71]
    s_add_u32 m0, s82, 135168
    s_add_u32 s87, s80, 4096
    v_xor_b32 v240, 0, v2
    buffer_load_dwordx4 v240, s[36:39], s87 offen offset:0 nt lds
    v_mfma_f32_16x16x32_bf16 v[72:75], v[108:111], v[112:115], v[72:75]
    s_add_u32 s6, s99, s101
    v_mfma_f32_16x16x32_bf16 v[76:79], v[108:111], v[116:119], v[76:79]
    s_lshl_b32 s10, s100, 12
    s_waitcnt lgkmcnt(0)
    s_waitcnt vmcnt(21)
    s_barrier
    v_mfma_f32_16x16x32_bf16 v[16:19], v[120:123], v[152:155], v[16:19]
    ds_read_b128 v[112:115], v232 offset:12288
    ds_read_b128 v[116:119], v232 offset:14336
    v_xor_b32 v240, 64, v2
    buffer_load_dwordx4 v240, s[36:39], s87 offen offset:1024 nt lds
    v_mfma_f32_16x16x32_bf16 v[20:23], v[120:123], v[156:159], v[20:23]
    ds_read_b64_tr_b16 v[80:81], v8 offset:49152
    s_add_u32 s14, s66, 3
    v_mfma_f32_16x16x32_bf16 v[24:27], v[124:127], v[152:155], v[24:27]
    ds_read_b64_tr_b16 v[82:83], v8 offset:50176
    v_xor_b32 v240, 128, v2
    buffer_load_dwordx4 v240, s[36:39], s87 offen offset:2048 nt lds
    v_mfma_f32_16x16x32_bf16 v[28:31], v[124:127], v[156:159], v[28:31]
    ds_read_b64_tr_b16 v[84:85], v9 offset:49152
    s_and_b32 s14, s14, 3
    v_mfma_f32_16x16x32_bf16 v[32:35], v[128:131], v[152:155], v[32:35]
    ds_read_b64_tr_b16 v[86:87], v9 offset:50176
    s_add_u32 s100, s79, 3
    v_mfma_f32_16x16x32_bf16 v[36:39], v[128:131], v[156:159], v[36:39]
    ds_read_b64_tr_b16 v[88:89], v10 offset:49152
    v_xor_b32 v240, 192, v2
    buffer_load_dwordx4 v240, s[36:39], s87 offen offset:3072 nt lds
    v_mfma_f32_16x16x32_bf16 v[40:43], v[132:135], v[152:155], v[40:43]
    ds_read_b64_tr_b16 v[90:91], v10 offset:50176
    s_and_b32 s100, s100, 3
    v_mfma_f32_16x16x32_bf16 v[44:47], v[132:135], v[156:159], v[44:47]
    ds_read_b64_tr_b16 v[92:93], v11 offset:49152
    s_lshl_b32 s101, s100, 17
    v_mfma_f32_16x16x32_bf16 v[48:51], v[136:139], v[152:155], v[48:51]
    ds_read_b64_tr_b16 v[94:95], v11 offset:50176
    ds_read_b64_tr_b16 v[96:97], v12 offset:49152
    s_add_u32 m0, s78, 8192
    s_add_u32 s87, s92, 640
    buffer_load_dwordx4 v228, s[32:35], s87 offen offset:0 lds
    v_mfma_f32_16x16x32_bf16 v[52:55], v[136:139], v[156:159], v[52:55]
    ds_read_b64_tr_b16 v[98:99], v12 offset:50176
    s_add_u32 s7, s99, s101
    v_mfma_f32_16x16x32_bf16 v[56:59], v[140:143], v[152:155], v[56:59]
    ds_read_b64_tr_b16 v[100:101], v13 offset:49152
    buffer_load_dwordx4 v229, s[32:35], s87 offen offset:1024 lds
    v_mfma_f32_16x16x32_bf16 v[60:63], v[140:143], v[156:159], v[60:63]
    ds_read_b64_tr_b16 v[102:103], v13 offset:50176
    s_lshl_b32 s11, s100, 12
    v_mfma_f32_16x16x32_bf16 v[64:67], v[144:147], v[152:155], v[64:67]
    ds_read_b64_tr_b16 v[104:105], v14 offset:49152
    s_add_u32 s15, s66, 4
    v_mfma_f32_16x16x32_bf16 v[68:71], v[144:147], v[156:159], v[68:71]
    s_waitcnt lgkmcnt(7)
    ds_read_b64_tr_b16 v[106:107], v14 offset:50176
    buffer_load_dwordx4 v230, s[32:35], s87 offen offset:2048 lds
    v_mfma_f32_16x16x32_bf16 v[72:75], v[148:151], v[152:155], v[72:75]
    ds_read_b64_tr_b16 v[108:109], v15 offset:49152
    s_and_b32 s15, s15, 3
    v_mfma_f32_16x16x32_bf16 v[76:79], v[148:151], v[156:159], v[76:79]
    ds_read_b64_tr_b16 v[110:111], v15 offset:50176
    s_lshl_b32 s99, s65, 2
    v_mfma_f32_16x16x32_bf16 v[16:19], v[80:83], v[112:115], v[16:19]
    ds_read_b128 v[152:155], v233 offset:12288
    ds_read_b128 v[156:159], v233 offset:14336
    buffer_load_dwordx4 v231, s[32:35], s87 offen offset:3072 lds
    v_mfma_f32_16x16x32_bf16 v[20:23], v[80:83], v[116:119], v[20:23]
    ds_read_b64_tr_b16 v[120:121], v8 offset:57344
    s_add_u32 s99, s99, s68
    v_mfma_f32_16x16x32_bf16 v[24:27], v[84:87], v[112:115], v[24:27]
    ds_read_b64_tr_b16 v[122:123], v8 offset:58368
    ds_read_b64_tr_b16 v[124:125], v9 offset:57344
    s_add_u32 m0, s81, 32768
    s_add_u32 s87, s88, 2621440
    buffer_load_dwordx4 v224, s[44:47], s87 offen offset:0 lds
    v_mfma_f32_16x16x32_bf16 v[28:31], v[84:87], v[116:119], v[28:31]
    s_waitcnt lgkmcnt(7)
    ds_read_b64_tr_b16 v[126:127], v9 offset:58368
    s_lshl_b32 s99, s99, 21
    v_mfma_f32_16x16x32_bf16 v[32:35], v[88:91], v[112:115], v[32:35]
    ds_read_b64_tr_b16 v[128:129], v10 offset:57344
    ds_read_b64_tr_b16 v[130:131], v10 offset:58368
    s_lshl_b32 s100, s98, 14
    v_mfma_f32_16x16x32_bf16 v[36:39], v[88:91], v[116:119], v[36:39]
    ds_read_b64_tr_b16 v[132:133], v11 offset:57344
    buffer_load_dwordx4 v225, s[44:47], s87 offen offset:1024 lds
    v_mfma_f32_16x16x32_bf16 v[40:43], v[92:95], v[112:115], v[40:43]
    ds_read_b64_tr_b16 v[134:135], v11 offset:58368
    ds_read_b64_tr_b16 v[136:137], v12 offset:57344
    s_add_u32 s16, s99, s100
    v_mfma_f32_16x16x32_bf16 v[44:47], v[92:95], v[116:119], v[44:47]
    ds_read_b64_tr_b16 v[138:139], v12 offset:58368
    s_and_b32 s100, s80, 0xfffff
    v_mfma_f32_16x16x32_bf16 v[48:51], v[96:99], v[112:115], v[48:51]
    ds_read_b64_tr_b16 v[140:141], v13 offset:57344
    s_waitcnt lgkmcnt(7)
    ds_read_b64_tr_b16 v[142:143], v13 offset:58368
    buffer_load_dwordx4 v226, s[44:47], s87 offen offset:2048 lds
    v_mfma_f32_16x16x32_bf16 v[52:55], v[96:99], v[116:119], v[52:55]
    ds_read_b64_tr_b16 v[144:145], v14 offset:57344
    s_add_u32 s22, s99, s100
    v_mfma_f32_16x16x32_bf16 v[56:59], v[100:103], v[112:115], v[56:59]
    ds_read_b64_tr_b16 v[146:147], v14 offset:58368
    ds_read_b64_tr_b16 v[148:149], v15 offset:57344
    buffer_load_dwordx4 v227, s[44:47], s87 offen offset:3072 lds
    v_mfma_f32_16x16x32_bf16 v[60:63], v[100:103], v[116:119], v[60:63]
    ds_read_b64_tr_b16 v[150:151], v15 offset:58368
    s_add_u32 s23, s22, 4096
    v_mfma_f32_16x16x32_bf16 v[64:67], v[104:107], v[112:115], v[64:67]
    s_add_u32 s99, s99, 1048576
    v_mfma_f32_16x16x32_bf16 v[68:71], v[104:107], v[116:119], v[68:71]
    s_mul_i32 s100, s66, 40960
    v_mfma_f32_16x16x32_bf16 v[72:75], v[108:111], v[112:115], v[72:75]
    s_add_u32 s100, s100, s99
    v_mfma_f32_16x16x32_bf16 v[76:79], v[108:111], v[116:119], v[76:79]
    s_lshl_b32 s101, s64, 10
    s_waitcnt lgkmcnt(0)
    s_waitcnt vmcnt(24)
    s_barrier
    v_mfma_f32_16x16x32_bf16 v[16:19], v[120:123], v[152:155], v[16:19]
    ds_read_b128 v[112:115], v232 offset:0
    ds_read_b128 v[116:119], v232 offset:2048
    s_add_u32 m0, s78, 12288
    s_add_u32 s87, s92, 768
    buffer_load_dwordx4 v228, s[32:35], s87 offen offset:0 lds
    v_mfma_f32_16x16x32_bf16 v[20:23], v[120:123], v[156:159], v[20:23]
    ds_read_b64_tr_b16 v[80:81], v8 offset:0
    buffer_load_dwordx4 v229, s[32:35], s87 offen offset:1024 lds
    v_mfma_f32_16x16x32_bf16 v[24:27], v[124:127], v[152:155], v[24:27]
    ds_read_b64_tr_b16 v[82:83], v8 offset:1024
    buffer_load_dwordx4 v230, s[32:35], s87 offen offset:2048 lds
    v_mfma_f32_16x16x32_bf16 v[28:31], v[124:127], v[156:159], v[28:31]
    ds_read_b64_tr_b16 v[84:85], v9 offset:0
    s_add_u32 s19, s100, s101
    v_mfma_f32_16x16x32_bf16 v[32:35], v[128:131], v[152:155], v[32:35]
    ds_read_b64_tr_b16 v[86:87], v9 offset:1024
    s_lshl_b32 s101, s67, 2
    v_mfma_f32_16x16x32_bf16 v[36:39], v[128:131], v[156:159], v[36:39]
    ds_read_b64_tr_b16 v[88:89], v10 offset:0
    buffer_load_dwordx4 v231, s[32:35], s87 offen offset:3072 lds
    v_mfma_f32_16x16x32_bf16 v[40:43], v[132:135], v[152:155], v[40:43]
    ds_read_b64_tr_b16 v[90:91], v10 offset:1024
    s_add_u32 s101, s101, s64
    v_mfma_f32_16x16x32_bf16 v[44:47], v[132:135], v[156:159], v[44:47]
    ds_read_b64_tr_b16 v[92:93], v11 offset:0
    s_lshl_b32 s101, s101, 7
    v_mfma_f32_16x16x32_bf16 v[48:51], v[136:139], v[152:155], v[48:51]
    ds_read_b64_tr_b16 v[94:95], v11 offset:1024
    ds_read_b64_tr_b16 v[96:97], v12 offset:0
    s_add_u32 m0, s81, 49152
    s_add_u32 s87, s88, 3145728
    buffer_load_dwordx4 v224, s[44:47], s87 offen offset:0 lds
    v_mfma_f32_16x16x32_bf16 v[52:55], v[136:139], v[156:159], v[52:55]
    ds_read_b64_tr_b16 v[98:99], v12 offset:1024
    s_add_u32 s18, s100, s101
    v_mfma_f32_16x16x32_bf16 v[56:59], v[140:143], v[152:155], v[56:59]
    ds_read_b64_tr_b16 v[100:101], v13 offset:0
    buffer_load_dwordx4 v225, s[44:47], s87 offen offset:1024 lds
    v_mfma_f32_16x16x32_bf16 v[60:63], v[140:143], v[156:159], v[60:63]
    ds_read_b64_tr_b16 v[102:103], v13 offset:1024
    s_lshl_b32 s100, s83, 17
    v_mfma_f32_16x16x32_bf16 v[64:67], v[144:147], v[152:155], v[64:67]
    ds_read_b64_tr_b16 v[104:105], v14 offset:0
    s_add_u32 s100, s100, s99
    v_mfma_f32_16x16x32_bf16 v[68:71], v[144:147], v[156:159], v[68:71]
    s_waitcnt lgkmcnt(7)
    ds_read_b64_tr_b16 v[106:107], v14 offset:1024
    buffer_load_dwordx4 v226, s[44:47], s87 offen offset:2048 lds
    v_mfma_f32_16x16x32_bf16 v[72:75], v[148:151], v[152:155], v[72:75]
    ds_read_b64_tr_b16 v[108:109], v15 offset:0
    s_lshl_b32 s101, s98, 11
    v_mfma_f32_16x16x32_bf16 v[76:79], v[148:151], v[156:159], v[76:79]
    ds_read_b64_tr_b16 v[110:111], v15 offset:1024
    s_add_u32 s17, s100, s101
    v_mfma_f32_16x16x32_bf16 v[16:19], v[80:83], v[112:115], v[16:19]
    ds_read_b128 v[152:155], v233 offset:0
    ds_read_b128 v[156:159], v233 offset:2048
    buffer_load_dwordx4 v227, s[44:47], s87 offen offset:3072 lds
    v_mfma_f32_16x16x32_bf16 v[20:23], v[80:83], v[116:119], v[20:23]
    ds_read_b64_tr_b16 v[120:121], v8 offset:8192
    s_lshl_b32 s101, s66, 15
    v_mfma_f32_16x16x32_bf16 v[24:27], v[84:87], v[112:115], v[24:27]
    ds_read_b64_tr_b16 v[122:123], v8 offset:9216
    ds_read_b64_tr_b16 v[124:125], v9 offset:8192
    s_add_u32 s21, s100, s101
    v_mfma_f32_16x16x32_bf16 v[28:31], v[84:87], v[116:119], v[28:31]
    s_waitcnt lgkmcnt(7)
    ds_read_b64_tr_b16 v[126:127], v9 offset:9216
    s_lshl_b32 s101, s64, 11
    v_mfma_f32_16x16x32_bf16 v[32:35], v[88:91], v[112:115], v[32:35]
    ds_read_b64_tr_b16 v[128:129], v10 offset:8192
    ds_read_b64_tr_b16 v[130:131], v10 offset:9216
    s_add_u32 s21, s21, s101
    v_mfma_f32_16x16x32_bf16 v[36:39], v[88:91], v[116:119], v[36:39]
    ds_read_b64_tr_b16 v[132:133], v11 offset:8192
    s_lshl_b32 s100, s68, 2
    v_mfma_f32_16x16x32_bf16 v[40:43], v[92:95], v[112:115], v[40:43]
    ds_read_b64_tr_b16 v[134:135], v11 offset:9216
    ds_read_b64_tr_b16 v[136:137], v12 offset:8192
    s_add_u32 s100, s100, s66
    v_mfma_f32_16x16x32_bf16 v[44:47], v[92:95], v[116:119], v[44:47]
    ds_read_b64_tr_b16 v[138:139], v12 offset:9216
    s_lshl_b32 s100, s100, 17
    v_mfma_f32_16x16x32_bf16 v[48:51], v[96:99], v[112:115], v[48:51]
    ds_read_b64_tr_b16 v[140:141], v13 offset:8192
    s_waitcnt lgkmcnt(7)
    ds_read_b64_tr_b16 v[142:143], v13 offset:9216
    s_lshl_b32 s101, s65, 11
    v_mfma_f32_16x16x32_bf16 v[52:55], v[96:99], v[116:119], v[52:55]
    ds_read_b64_tr_b16 v[144:145], v14 offset:8192
    s_add_u32 s100, s100, s101
    v_mfma_f32_16x16x32_bf16 v[56:59], v[100:103], v[112:115], v[56:59]
    ds_read_b64_tr_b16 v[146:147], v14 offset:9216
    ds_read_b64_tr_b16 v[148:149], v15 offset:8192
    s_lshl_b32 s101, s83, 8
    v_mfma_f32_16x16x32_bf16 v[60:63], v[100:103], v[116:119], v[60:63]
    ds_read_b64_tr_b16 v[150:151], v15 offset:9216
    s_add_u32 s100, s100, s101
    v_mfma_f32_16x16x32_bf16 v[64:67], v[104:107], v[112:115], v[64:67]
    s_lshl_b32 s101, s64, 6
    v_mfma_f32_16x16x32_bf16 v[68:71], v[104:107], v[116:119], v[68:71]
    s_add_u32 s20, s100, s101
    v_mfma_f32_16x16x32_bf16 v[72:75], v[108:111], v[112:115], v[72:75]
    v_mfma_f32_16x16x32_bf16 v[76:79], v[108:111], v[116:119], v[76:79]
    s_waitcnt lgkmcnt(0)
    s_waitcnt vmcnt(24)
    s_barrier
    v_mfma_f32_16x16x32_bf16 v[16:19], v[120:123], v[152:155], v[16:19]
    ds_read_b128 v[112:115], v232 offset:4096
    ds_read_b128 v[116:119], v232 offset:6144
    s_add_u32 m0, s78, 0
    s_add_u32 s87, s93, 0
    buffer_load_dwordx4 v228, s[32:35], s87 offen offset:0 lds
    v_mfma_f32_16x16x32_bf16 v[20:23], v[120:123], v[156:159], v[20:23]
    ds_read_b64_tr_b16 v[80:81], v8 offset:16384
    buffer_load_dwordx4 v229, s[32:35], s87 offen offset:1024 lds
    v_mfma_f32_16x16x32_bf16 v[24:27], v[124:127], v[152:155], v[24:27]
    ds_read_b64_tr_b16 v[82:83], v8 offset:17408
    buffer_load_dwordx4 v230, s[32:35], s87 offen offset:2048 lds
    v_mfma_f32_16x16x32_bf16 v[28:31], v[124:127], v[156:159], v[28:31]
    ds_read_b64_tr_b16 v[84:85], v9 offset:16384
    buffer_load_dwordx4 v231, s[32:35], s87 offen offset:3072 lds
    v_mfma_f32_16x16x32_bf16 v[32:35], v[128:131], v[152:155], v[32:35]
    ds_read_b64_tr_b16 v[86:87], v9 offset:17408
    s_add_u32 m0, s81, 0
    s_add_u32 s87, s89, 0
    buffer_load_dwordx4 v224, s[44:47], s87 offen offset:0 lds
    v_mfma_f32_16x16x32_bf16 v[36:39], v[128:131], v[156:159], v[36:39]
    ds_read_b64_tr_b16 v[88:89], v10 offset:16384
    buffer_load_dwordx4 v225, s[44:47], s87 offen offset:1024 lds
    v_mfma_f32_16x16x32_bf16 v[40:43], v[132:135], v[152:155], v[40:43]
    ds_read_b64_tr_b16 v[90:91], v10 offset:17408
    buffer_load_dwordx4 v226, s[44:47], s87 offen offset:2048 lds
    v_mfma_f32_16x16x32_bf16 v[44:47], v[132:135], v[156:159], v[44:47]
    ds_read_b64_tr_b16 v[92:93], v11 offset:16384
    buffer_load_dwordx4 v227, s[44:47], s87 offen offset:3072 lds
    v_mfma_f32_16x16x32_bf16 v[48:51], v[136:139], v[152:155], v[48:51]
    ds_read_b64_tr_b16 v[94:95], v11 offset:17408
    ds_read_b64_tr_b16 v[96:97], v12 offset:16384
    v_mfma_f32_16x16x32_bf16 v[52:55], v[136:139], v[156:159], v[52:55]
    ds_read_b64_tr_b16 v[98:99], v12 offset:17408
    v_mfma_f32_16x16x32_bf16 v[56:59], v[140:143], v[152:155], v[56:59]
    ds_read_b64_tr_b16 v[100:101], v13 offset:16384
    v_mfma_f32_16x16x32_bf16 v[60:63], v[140:143], v[156:159], v[60:63]
    ds_read_b64_tr_b16 v[102:103], v13 offset:17408
    v_mfma_f32_16x16x32_bf16 v[64:67], v[144:147], v[152:155], v[64:67]
    ds_read_b64_tr_b16 v[104:105], v14 offset:16384
    v_mfma_f32_16x16x32_bf16 v[68:71], v[144:147], v[156:159], v[68:71]
    s_waitcnt lgkmcnt(7)
    ds_read_b64_tr_b16 v[106:107], v14 offset:17408
    v_mfma_f32_16x16x32_bf16 v[72:75], v[148:151], v[152:155], v[72:75]
    ds_read_b64_tr_b16 v[108:109], v15 offset:16384
    v_mfma_f32_16x16x32_bf16 v[76:79], v[148:151], v[156:159], v[76:79]
    ds_read_b64_tr_b16 v[110:111], v15 offset:17408
    v_mfma_f32_16x16x32_bf16 v[16:19], v[80:83], v[112:115], v[16:19]
    ds_read_b128 v[152:155], v233 offset:4096
    ds_read_b128 v[156:159], v233 offset:6144
    v_mfma_f32_16x16x32_bf16 v[20:23], v[80:83], v[116:119], v[20:23]
    ds_read_b64_tr_b16 v[120:121], v8 offset:24576
    v_mfma_f32_16x16x32_bf16 v[24:27], v[84:87], v[112:115], v[24:27]
    ds_read_b64_tr_b16 v[122:123], v8 offset:25600
    ds_read_b64_tr_b16 v[124:125], v9 offset:24576
    v_mfma_f32_16x16x32_bf16 v[28:31], v[84:87], v[116:119], v[28:31]
    s_waitcnt lgkmcnt(7)
    ds_read_b64_tr_b16 v[126:127], v9 offset:25600
    v_mfma_f32_16x16x32_bf16 v[32:35], v[88:91], v[112:115], v[32:35]
    ds_read_b64_tr_b16 v[128:129], v10 offset:24576
    ds_read_b64_tr_b16 v[130:131], v10 offset:25600
    v_mfma_f32_16x16x32_bf16 v[36:39], v[88:91], v[116:119], v[36:39]
    ds_read_b64_tr_b16 v[132:133], v11 offset:24576
    v_mfma_f32_16x16x32_bf16 v[40:43], v[92:95], v[112:115], v[40:43]
    ds_read_b64_tr_b16 v[134:135], v11 offset:25600
    ds_read_b64_tr_b16 v[136:137], v12 offset:24576
    v_mfma_f32_16x16x32_bf16 v[44:47], v[92:95], v[116:119], v[44:47]
    ds_read_b64_tr_b16 v[138:139], v12 offset:25600
    v_mfma_f32_16x16x32_bf16 v[48:51], v[96:99], v[112:115], v[48:51]
    ds_read_b64_tr_b16 v[140:141], v13 offset:24576
    s_waitcnt lgkmcnt(7)
    ds_read_b64_tr_b16 v[142:143], v13 offset:25600
    v_mfma_f32_16x16x32_bf16 v[52:55], v[96:99], v[116:119], v[52:55]
    ds_read_b64_tr_b16 v[144:145], v14 offset:24576
    v_mfma_f32_16x16x32_bf16 v[56:59], v[100:103], v[112:115], v[56:59]
    ds_read_b64_tr_b16 v[146:147], v14 offset:25600
    ds_read_b64_tr_b16 v[148:149], v15 offset:24576
    v_mfma_f32_16x16x32_bf16 v[60:63], v[100:103], v[116:119], v[60:63]
    ds_read_b64_tr_b16 v[150:151], v15 offset:25600
    v_mfma_f32_16x16x32_bf16 v[64:67], v[104:107], v[112:115], v[64:67]
    v_mfma_f32_16x16x32_bf16 v[68:71], v[104:107], v[116:119], v[68:71]
    v_mfma_f32_16x16x32_bf16 v[72:75], v[108:111], v[112:115], v[72:75]
    v_mfma_f32_16x16x32_bf16 v[76:79], v[108:111], v[116:119], v[76:79]
    s_waitcnt lgkmcnt(0)
    s_waitcnt vmcnt(16)
    s_barrier
    v_mfma_f32_16x16x32_bf16 v[16:19], v[120:123], v[152:155], v[16:19]
    ds_read_b128 v[112:115], v232 offset:8192
    ds_read_b128 v[116:119], v232 offset:10240
    s_add_u32 m0, s78, 4096
    s_add_u32 s87, s93, 384
    buffer_load_dwordx4 v228, s[32:35], s87 offen offset:0 lds
    v_mfma_f32_16x16x32_bf16 v[20:23], v[120:123], v[156:159], v[20:23]
    ds_read_b64_tr_b16 v[80:81], v8 offset:32768
    buffer_load_dwordx4 v229, s[32:35], s87 offen offset:1024 lds
    v_xor_b32 v253, 0, v248
    ds_read_b64 v[160:161], v253 offset:0
    v_mfma_f32_16x16x32_bf16 v[24:27], v[124:127], v[152:155], v[24:27]
    ds_read_b64_tr_b16 v[82:83], v8 offset:33792
    buffer_load_dwordx4 v230, s[32:35], s87 offen offset:2048 lds
    v_mfma_f32_16x16x32_bf16 v[28:31], v[124:127], v[156:159], v[28:31]
    ds_read_b64_tr_b16 v[84:85], v9 offset:32768
    buffer_load_dwordx4 v231, s[32:35], s87 offen offset:3072 lds
    v_xor_b32 v253, 32, v248
    ds_read_b64 v[162:163], v253 offset:0
    v_mfma_f32_16x16x32_bf16 v[32:35], v[128:131], v[152:155], v[32:35]
    ds_read_b64_tr_b16 v[86:87], v9 offset:33792
    s_add_u32 m0, s81, 16384
    s_add_u32 s87, s89, 1572864
    buffer_load_dwordx4 v224, s[44:47], s87 offen offset:0 lds
    v_xor_b32 v253, 64, v248
    ds_read_b64 v[164:165], v253 offset:0
    v_mfma_f32_16x16x32_bf16 v[36:39], v[128:131], v[156:159], v[36:39]
    ds_read_b64_tr_b16 v[88:89], v10 offset:32768
    buffer_load_dwordx4 v225, s[44:47], s87 offen offset:1024 lds
    v_mfma_f32_16x16x32_bf16 v[40:43], v[132:135], v[152:155], v[40:43]
    ds_read_b64_tr_b16 v[90:91], v10 offset:33792
    buffer_load_dwordx4 v226, s[44:47], s87 offen offset:2048 lds
    v_xor_b32 v253, 96, v248
    ds_read_b64 v[166:167], v253 offset:0
    v_mfma_f32_16x16x32_bf16 v[44:47], v[132:135], v[156:159], v[44:47]
    ds_read_b64_tr_b16 v[92:93], v11 offset:32768
    buffer_load_dwordx4 v227, s[44:47], s87 offen offset:3072 lds
    v_mfma_f32_16x16x32_bf16 v[48:51], v[136:139], v[152:155], v[48:51]
    ds_read_b64_tr_b16 v[94:95], v11 offset:33792
    ds_read_b64_tr_b16 v[96:97], v12 offset:32768
    v_xor_b32 v253, 128, v248
    s_waitcnt lgkmcnt(7)
    ds_read_b64 v[168:169], v253 offset:0
    v_mfma_f32_16x16x32_bf16 v[52:55], v[136:139], v[156:159], v[52:55]
    ds_read_b64_tr_b16 v[98:99], v12 offset:33792
    v_xor_b32 v253, 160, v248
    ds_read_b64 v[170:171], v253 offset:0
    v_mfma_f32_16x16x32_bf16 v[56:59], v[140:143], v[152:155], v[56:59]
    ds_read_b64_tr_b16 v[100:101], v13 offset:32768
    v_mfma_f32_16x16x32_bf16 v[60:63], v[140:143], v[156:159], v[60:63]
    ds_read_b64_tr_b16 v[102:103], v13 offset:33792
    v_xor_b32 v253, 192, v248
    ds_read_b64 v[172:173], v253 offset:0
    v_mfma_f32_16x16x32_bf16 v[64:67], v[144:147], v[152:155], v[64:67]
    ds_read_b64_tr_b16 v[104:105], v14 offset:32768
    v_xor_b32 v253, 224, v248
    ds_read_b64 v[174:175], v253 offset:0
    v_mfma_f32_16x16x32_bf16 v[68:71], v[144:147], v[156:159], v[68:71]
    s_waitcnt lgkmcnt(7)
    ds_read_b64_tr_b16 v[106:107], v14 offset:33792
    v_mfma_f32_16x16x32_bf16 v[72:75], v[148:151], v[152:155], v[72:75]
    ds_read_b64_tr_b16 v[108:109], v15 offset:32768
    v_xor_b32 v253, 64, v248
    ds_read_b64 v[176:177], v253 offset:1024
    v_mfma_f32_16x16x32_bf16 v[76:79], v[148:151], v[156:159], v[76:79]
    ds_read_b64_tr_b16 v[110:111], v15 offset:33792
    v_mfma_f32_16x16x32_bf16 v[16:19], v[80:83], v[112:115], v[16:19]
    ds_read_b128 v[152:155], v233 offset:8192
    ds_read_b128 v[156:159], v233 offset:10240
    v_xor_b32 v253, 96, v248
    ds_read_b64 v[178:179], v253 offset:1024
    v_mfma_f32_16x16x32_bf16 v[20:23], v[80:83], v[116:119], v[20:23]
    ds_read_b64_tr_b16 v[120:121], v8 offset:40960
    v_xor_b32 v253, 0, v248
    s_waitcnt lgkmcnt(7)
    ds_read_b64 v[180:181], v253 offset:1024
    v_mfma_f32_16x16x32_bf16 v[24:27], v[84:87], v[112:115], v[24:27]
    ds_read_b64_tr_b16 v[122:123], v8 offset:41984
    ds_read_b64_tr_b16 v[124:125], v9 offset:40960
    v_mfma_f32_16x16x32_bf16 v[28:31], v[84:87], v[116:119], v[28:31]
    ds_read_b64_tr_b16 v[126:127], v9 offset:41984
    v_xor_b32 v253, 32, v248
    ds_read_b64 v[182:183], v253 offset:1024
    v_mfma_f32_16x16x32_bf16 v[32:35], v[88:91], v[112:115], v[32:35]
    ds_read_b64_tr_b16 v[128:129], v10 offset:40960
    ds_read_b64_tr_b16 v[130:131], v10 offset:41984
    v_mfma_f32_16x16x32_bf16 v[36:39], v[88:91], v[116:119], v[36:39]
    ds_read_b64_tr_b16 v[132:133], v11 offset:40960
    v_xor_b32 v253, 192, v248
    s_waitcnt lgkmcnt(7)
    ds_read_b64 v[184:185], v253 offset:1024
    v_mfma_f32_16x16x32_bf16 v[40:43], v[92:95], v[112:115], v[40:43]
    ds_read_b64_tr_b16 v[134:135], v11 offset:41984
    ds_read_b64_tr_b16 v[136:137], v12 offset:40960
    v_xor_b32 v253, 224, v248
    ds_read_b64 v[186:187], v253 offset:1024
    v_mfma_f32_16x16x32_bf16 v[44:47], v[92:95], v[116:119], v[44:47]
    ds_read_b64_tr_b16 v[138:139], v12 offset:41984
    v_mfma_f32_16x16x32_bf16 v[48:51], v[96:99], v[112:115], v[48:51]
    ds_read_b64_tr_b16 v[140:141], v13 offset:40960
    ds_read_b64_tr_b16 v[142:143], v13 offset:41984
    v_xor_b32 v253, 128, v248
    ds_read_b64 v[188:189], v253 offset:1024
    v_mfma_f32_16x16x32_bf16 v[52:55], v[96:99], v[116:119], v[52:55]
    s_waitcnt lgkmcnt(7)
    ds_read_b64_tr_b16 v[144:145], v14 offset:40960
    v_xor_b32 v253, 160, v248
    ds_read_b64 v[190:191], v253 offset:1024
    v_mfma_f32_16x16x32_bf16 v[56:59], v[100:103], v[112:115], v[56:59]
    ds_read_b64_tr_b16 v[146:147], v14 offset:41984
    ds_read_b64_tr_b16 v[148:149], v15 offset:40960
    v_mfma_f32_16x16x32_bf16 v[60:63], v[100:103], v[116:119], v[60:63]
    ds_read_b64_tr_b16 v[150:151], v15 offset:41984
    v_mfma_f32_16x16x32_bf16 v[64:67], v[104:107], v[112:115], v[64:67]
    v_mfma_f32_16x16x32_bf16 v[68:71], v[104:107], v[116:119], v[68:71]
    v_mfma_f32_16x16x32_bf16 v[72:75], v[108:111], v[112:115], v[72:75]
    v_mfma_f32_16x16x32_bf16 v[76:79], v[108:111], v[116:119], v[76:79]
    s_waitcnt lgkmcnt(0)
    s_waitcnt vmcnt(16)
    s_barrier
    v_mfma_f32_16x16x32_bf16 v[16:19], v[120:123], v[152:155], v[16:19]
    ds_read_b128 v[112:115], v232 offset:12288
    ds_read_b128 v[116:119], v232 offset:14336
    s_add_u32 m0, s82, 131072
    s_add_u32 s87, s80, 0
    buffer_load_dwordx4 v3, s[40:43], s87 offen offset:0 nt lds
    v_mfma_f32_16x16x32_bf16 v[20:23], v[120:123], v[156:159], v[20:23]
    ds_read_b64_tr_b16 v[80:81], v8 offset:49152
    buffer_load_dwordx4 v3, s[40:43], s87 offen offset:1024 nt lds
    v_mfma_f32_16x16x32_bf16 v[24:27], v[124:127], v[152:155], v[24:27]
    ds_read_b64_tr_b16 v[82:83], v8 offset:50176
    v_xor_b32 v240, 32, v3
    buffer_load_dwordx4 v240, s[40:43], s87 offen offset:2048 nt lds
    v_mfma_f32_16x16x32_bf16 v[28:31], v[124:127], v[156:159], v[28:31]
    ds_read_b64_tr_b16 v[84:85], v9 offset:49152
    buffer_load_dwordx4 v240, s[40:43], s87 offen offset:3072 nt lds
    v_mfma_f32_16x16x32_bf16 v[32:35], v[128:131], v[152:155], v[32:35]
    ds_read_b64_tr_b16 v[86:87], v9 offset:50176
    s_add_u32 m0, s82, 135168
    s_add_u32 s87, s80, 4096
    buffer_load_dwordx4 v3, s[40:43], s87 offen offset:0 nt lds
    v_mfma_f32_16x16x32_bf16 v[36:39], v[128:131], v[156:159], v[36:39]
    ds_read_b64_tr_b16 v[88:89], v10 offset:49152
    buffer_load_dwordx4 v3, s[40:43], s87 offen offset:1024 nt lds
    v_mfma_f32_16x16x32_bf16 v[40:43], v[132:135], v[152:155], v[40:43]
    ds_read_b64_tr_b16 v[90:91], v10 offset:50176
    v_xor_b32 v240, 32, v3
    buffer_load_dwordx4 v240, s[40:43], s87 offen offset:2048 nt lds
    v_mfma_f32_16x16x32_bf16 v[44:47], v[132:135], v[156:159], v[44:47]
    ds_read_b64_tr_b16 v[92:93], v11 offset:49152
    buffer_load_dwordx4 v240, s[40:43], s87 offen offset:3072 nt lds
    v_mfma_f32_16x16x32_bf16 v[48:51], v[136:139], v[152:155], v[48:51]
    ds_read_b64_tr_b16 v[94:95], v11 offset:50176
    ds_read_b64_tr_b16 v[96:97], v12 offset:49152
    s_add_u32 m0, s78, 8192
    s_add_u32 s87, s93, 128
    buffer_load_dwordx4 v228, s[32:35], s87 offen offset:0 lds
    v_mfma_f32_16x16x32_bf16 v[52:55], v[136:139], v[156:159], v[52:55]
    ds_read_b64_tr_b16 v[98:99], v12 offset:50176
    buffer_load_dwordx4 v229, s[32:35], s87 offen offset:1024 lds
    v_mfma_f32_16x16x32_bf16 v[56:59], v[140:143], v[152:155], v[56:59]
    ds_read_b64_tr_b16 v[100:101], v13 offset:49152
    v_mfma_f32_16x16x32_bf16 v[60:63], v[140:143], v[156:159], v[60:63]
    ds_read_b64_tr_b16 v[102:103], v13 offset:50176
    v_mfma_f32_16x16x32_bf16 v[64:67], v[144:147], v[152:155], v[64:67]
    ds_read_b64_tr_b16 v[104:105], v14 offset:49152
    v_mfma_f32_16x16x32_bf16 v[68:71], v[144:147], v[156:159], v[68:71]
    s_waitcnt lgkmcnt(7)
    ds_read_b64_tr_b16 v[106:107], v14 offset:50176
    v_mfma_f32_16x16x32_bf16 v[72:75], v[148:151], v[152:155], v[72:75]
    ds_read_b64_tr_b16 v[108:109], v15 offset:49152
    v_mfma_f32_16x16x32_bf16 v[76:79], v[148:151], v[156:159], v[76:79]
    ds_read_b64_tr_b16 v[110:111], v15 offset:50176
    v_mfma_f32_16x16x32_bf16 v[16:19], v[80:83], v[112:115], v[16:19]
    ds_read_b128 v[152:155], v233 offset:12288
    ds_read_b128 v[156:159], v233 offset:14336
    v_mfma_f32_16x16x32_bf16 v[20:23], v[80:83], v[116:119], v[20:23]
    ds_read_b64_tr_b16 v[120:121], v8 offset:57344
    v_mfma_f32_16x16x32_bf16 v[24:27], v[84:87], v[112:115], v[24:27]
    ds_read_b64_tr_b16 v[122:123], v8 offset:58368
    ds_read_b64_tr_b16 v[124:125], v9 offset:57344
    v_mfma_f32_16x16x32_bf16 v[28:31], v[84:87], v[116:119], v[28:31]
    s_waitcnt lgkmcnt(7)
    ds_read_b64_tr_b16 v[126:127], v9 offset:58368
    v_mfma_f32_16x16x32_bf16 v[32:35], v[88:91], v[112:115], v[32:35]
    ds_read_b64_tr_b16 v[128:129], v10 offset:57344
    ds_read_b64_tr_b16 v[130:131], v10 offset:58368
    buffer_load_dwordx4 v230, s[32:35], s87 offen offset:2048 lds
    v_mfma_f32_16x16x32_bf16 v[36:39], v[88:91], v[116:119], v[36:39]
    ds_read_b64_tr_b16 v[132:133], v11 offset:57344
    v_mfma_f32_16x16x32_bf16 v[40:43], v[92:95], v[112:115], v[40:43]
    ds_read_b64_tr_b16 v[134:135], v11 offset:58368
    ds_read_b64_tr_b16 v[136:137], v12 offset:57344
    v_mfma_f32_16x16x32_bf16 v[44:47], v[92:95], v[116:119], v[44:47]
    ds_read_b64_tr_b16 v[138:139], v12 offset:58368
    buffer_load_dwordx4 v231, s[32:35], s87 offen offset:3072 lds
    v_mfma_f32_16x16x32_bf16 v[48:51], v[96:99], v[112:115], v[48:51]
    ds_read_b64_tr_b16 v[140:141], v13 offset:57344
    s_waitcnt lgkmcnt(7)
    ds_read_b64_tr_b16 v[142:143], v13 offset:58368
    v_mfma_f32_16x16x32_bf16 v[52:55], v[96:99], v[116:119], v[52:55]
    ds_read_b64_tr_b16 v[144:145], v14 offset:57344
    v_mfma_f32_16x16x32_bf16 v[56:59], v[100:103], v[112:115], v[56:59]
    ds_read_b64_tr_b16 v[146:147], v14 offset:58368
    ds_read_b64_tr_b16 v[148:149], v15 offset:57344
    s_add_u32 m0, s81, 32768
    s_add_u32 s87, s89, 524288
    buffer_load_dwordx4 v224, s[44:47], s87 offen offset:0 lds
    v_mfma_f32_16x16x32_bf16 v[60:63], v[100:103], v[116:119], v[60:63]
    ds_read_b64_tr_b16 v[150:151], v15 offset:58368
    v_mfma_f32_16x16x32_bf16 v[64:67], v[104:107], v[112:115], v[64:67]
    buffer_load_dwordx4 v225, s[44:47], s87 offen offset:1024 lds
    v_mfma_f32_16x16x32_bf16 v[68:71], v[104:107], v[116:119], v[68:71]
    v_mfma_f32_16x16x32_bf16 v[72:75], v[108:111], v[112:115], v[72:75]
    v_mfma_f32_16x16x32_bf16 v[76:79], v[108:111], v[116:119], v[76:79]
    buffer_load_dwordx4 v226, s[44:47], s87 offen offset:2048 lds
    s_waitcnt lgkmcnt(0)
    s_waitcnt vmcnt(23)
    s_barrier
    v_mfma_f32_16x16x32_bf16 v[16:19], v[120:123], v[152:155], v[16:19]
    ds_read_b128 v[112:115], v232 offset:0
    ds_read_b128 v[116:119], v232 offset:2048
    v_mfma_f32_16x16x32_bf16 v[20:23], v[120:123], v[156:159], v[20:23]
    ds_read_b64_tr_b16 v[80:81], v8 offset:0
    v_mfma_f32_16x16x32_bf16 v[24:27], v[124:127], v[152:155], v[24:27]
    ds_read_b64_tr_b16 v[82:83], v8 offset:1024
    buffer_load_dwordx4 v227, s[44:47], s87 offen offset:3072 lds
    v_mfma_f32_16x16x32_bf16 v[28:31], v[124:127], v[156:159], v[28:31]
    ds_read_b64_tr_b16 v[84:85], v9 offset:0
    v_mfma_f32_16x16x32_bf16 v[32:35], v[128:131], v[152:155], v[32:35]
    ds_read_b64_tr_b16 v[86:87], v9 offset:1024
    s_add_u32 m0, s78, 12288
    s_add_u32 s87, s93, 256
    buffer_load_dwordx4 v228, s[32:35], s87 offen offset:0 lds
    v_mfma_f32_16x16x32_bf16 v[36:39], v[128:131], v[156:159], v[36:39]
    ds_read_b64_tr_b16 v[88:89], v10 offset:0
    v_mfma_f32_16x16x32_bf16 v[40:43], v[132:135], v[152:155], v[40:43]
    ds_read_b64_tr_b16 v[90:91], v10 offset:1024
    v_mfma_f32_16x16x32_bf16 v[44:47], v[132:135], v[156:159], v[44:47]
    ds_read_b64_tr_b16 v[92:93], v11 offset:0
    buffer_load_dwordx4 v229, s[32:35], s87 offen offset:1024 lds
    v_mfma_f32_16x16x32_bf16 v[48:51], v[136:139], v[152:155], v[48:51]
    ds_read_b64_tr_b16 v[94:95], v11 offset:1024
    ds_read_b64_tr_b16 v[96:97], v12 offset:0
    v_mfma_f32_16x16x32_bf16 v[52:55], v[136:139], v[156:159], v[52:55]
    ds_read_b64_tr_b16 v[98:99], v12 offset:1024
    v_mfma_f32_16x16x32_bf16 v[56:59], v[140:143], v[152:155], v[56:59]
    ds_read_b64_tr_b16 v[100:101], v13 offset:0
    buffer_load_dwordx4 v230, s[32:35], s87 offen offset:2048 lds
    v_mfma_f32_16x16x32_bf16 v[60:63], v[140:143], v[156:159], v[60:63]
    ds_read_b64_tr_b16 v[102:103], v13 offset:1024
    v_mfma_f32_16x16x32_bf16 v[64:67], v[144:147], v[152:155], v[64:67]
    ds_read_b64_tr_b16 v[104:105], v14 offset:0
    v_mfma_f32_16x16x32_bf16 v[68:71], v[144:147], v[156:159], v[68:71]
    s_waitcnt lgkmcnt(7)
    ds_read_b64_tr_b16 v[106:107], v14 offset:1024
    buffer_load_dwordx4 v231, s[32:35], s87 offen offset:3072 lds
    v_mfma_f32_16x16x32_bf16 v[72:75], v[148:151], v[152:155], v[72:75]
    ds_read_b64_tr_b16 v[108:109], v15 offset:0
    v_mfma_f32_16x16x32_bf16 v[76:79], v[148:151], v[156:159], v[76:79]
    ds_read_b64_tr_b16 v[110:111], v15 offset:1024
    s_add_u32 m0, s81, 49152
    s_add_u32 s87, s89, 1048576
    buffer_load_dwordx4 v224, s[44:47], s87 offen offset:0 lds
    v_mfma_f32_16x16x32_bf16 v[16:19], v[80:83], v[112:115], v[16:19]
    ds_read_b128 v[152:155], v233 offset:0
    ds_read_b128 v[156:159], v233 offset:2048
    v_mfma_f32_16x16x32_bf16 v[20:23], v[80:83], v[116:119], v[20:23]
    ds_read_b64_tr_b16 v[120:121], v8 offset:8192
    v_mfma_f32_16x16x32_bf16 v[24:27], v[84:87], v[112:115], v[24:27]
    ds_read_b64_tr_b16 v[122:123], v8 offset:9216
    ds_read_b64_tr_b16 v[124:125], v9 offset:8192
    buffer_load_dwordx4 v225, s[44:47], s87 offen offset:1024 lds
    v_mfma_f32_16x16x32_bf16 v[28:31], v[84:87], v[116:119], v[28:31]
    s_waitcnt lgkmcnt(7)
    ds_read_b64_tr_b16 v[126:127], v9 offset:9216
    v_mfma_f32_16x16x32_bf16 v[32:35], v[88:91], v[112:115], v[32:35]
    ds_read_b64_tr_b16 v[128:129], v10 offset:8192
    ds_read_b64_tr_b16 v[130:131], v10 offset:9216
    v_mfma_f32_16x16x32_bf16 v[36:39], v[88:91], v[116:119], v[36:39]
    ds_read_b64_tr_b16 v[132:133], v11 offset:8192
    buffer_load_dwordx4 v226, s[44:47], s87 offen offset:2048 lds
    v_mfma_f32_16x16x32_bf16 v[40:43], v[92:95], v[112:115], v[40:43]
    ds_read_b64_tr_b16 v[134:135], v11 offset:9216
    ds_read_b64_tr_b16 v[136:137], v12 offset:8192
    v_mfma_f32_16x16x32_bf16 v[44:47], v[92:95], v[116:119], v[44:47]
    ds_read_b64_tr_b16 v[138:139], v12 offset:9216
    buffer_load_dwordx4 v227, s[44:47], s87 offen offset:3072 lds
    v_mfma_f32_16x16x32_bf16 v[48:51], v[96:99], v[112:115], v[48:51]
    ds_read_b64_tr_b16 v[140:141], v13 offset:8192
    s_waitcnt lgkmcnt(7)
    ds_read_b64_tr_b16 v[142:143], v13 offset:9216
    v_mfma_f32_16x16x32_bf16 v[52:55], v[96:99], v[116:119], v[52:55]
    ds_read_b64_tr_b16 v[144:145], v14 offset:8192
    v_mfma_f32_16x16x32_bf16 v[56:59], v[100:103], v[112:115], v[56:59]
    ds_read_b64_tr_b16 v[146:147], v14 offset:9216
    ds_read_b64_tr_b16 v[148:149], v15 offset:8192
    v_mfma_f32_16x16x32_bf16 v[60:63], v[100:103], v[116:119], v[60:63]
    ds_read_b64_tr_b16 v[150:151], v15 offset:9216
    v_mfma_f32_16x16x32_bf16 v[64:67], v[104:107], v[112:115], v[64:67]
    v_mfma_f32_16x16x32_bf16 v[68:71], v[104:107], v[116:119], v[68:71]
    v_mfma_f32_16x16x32_bf16 v[72:75], v[108:111], v[112:115], v[72:75]
    v_mfma_f32_16x16x32_bf16 v[76:79], v[108:111], v[116:119], v[76:79]
    s_waitcnt lgkmcnt(0)
    s_waitcnt vmcnt(24)
    s_barrier
    v_mfma_f32_16x16x32_bf16 v[16:19], v[120:123], v[152:155], v[16:19]
    ds_read_b128 v[112:115], v232 offset:4096
    ds_read_b128 v[116:119], v232 offset:6144
    s_add_u32 m0, s78, 0
    s_add_u32 s87, s93, 512
    buffer_load_dwordx4 v228, s[32:35], s87 offen offset:0 lds
    v_mfma_f32_16x16x32_bf16 v[20:23], v[120:123], v[156:159], v[20:23]
    ds_read_b64_tr_b16 v[80:81], v8 offset:16384
    buffer_load_dwordx4 v229, s[32:35], s87 offen offset:1024 lds
    v_mfma_f32_16x16x32_bf16 v[24:27], v[124:127], v[152:155], v[24:27]
    ds_read_b64_tr_b16 v[82:83], v8 offset:17408
    buffer_load_dwordx4 v230, s[32:35], s87 offen offset:2048 lds
    v_mfma_f32_16x16x32_bf16 v[28:31], v[124:127], v[156:159], v[28:31]
    ds_read_b64_tr_b16 v[84:85], v9 offset:16384
    buffer_load_dwordx4 v231, s[32:35], s87 offen offset:3072 lds
    v_mfma_f32_16x16x32_bf16 v[32:35], v[128:131], v[152:155], v[32:35]
    ds_read_b64_tr_b16 v[86:87], v9 offset:17408
    v_mfma_f32_16x16x32_bf16 v[36:39], v[128:131], v[156:159], v[36:39]
    ds_read_b64_tr_b16 v[88:89], v10 offset:16384
    s_add_u32 m0, s81, 0
    s_add_u32 s87, s89, 2097152
    buffer_load_dwordx4 v224, s[44:47], s87 offen offset:0 lds
    v_mfma_f32_16x16x32_bf16 v[40:43], v[132:135], v[152:155], v[40:43]
    ds_read_b64_tr_b16 v[90:91], v10 offset:17408
    v_mfma_f32_16x16x32_bf16 v[44:47], v[132:135], v[156:159], v[44:47]
    ds_read_b64_tr_b16 v[92:93], v11 offset:16384
    buffer_load_dwordx4 v225, s[44:47], s87 offen offset:1024 lds
    v_mfma_f32_16x16x32_bf16 v[48:51], v[136:139], v[152:155], v[48:51]
    ds_read_b64_tr_b16 v[94:95], v11 offset:17408
    ds_read_b64_tr_b16 v[96:97], v12 offset:16384
    v_mfma_f32_16x16x32_bf16 v[52:55], v[136:139], v[156:159], v[52:55]
    ds_read_b64_tr_b16 v[98:99], v12 offset:17408
    v_mfma_f32_16x16x32_bf16 v[56:59], v[140:143], v[152:155], v[56:59]
    ds_read_b64_tr_b16 v[100:101], v13 offset:16384
    buffer_load_dwordx4 v226, s[44:47], s87 offen offset:2048 lds
    v_mfma_f32_16x16x32_bf16 v[60:63], v[140:143], v[156:159], v[60:63]
    ds_read_b64_tr_b16 v[102:103], v13 offset:17408
    v_mfma_f32_16x16x32_bf16 v[64:67], v[144:147], v[152:155], v[64:67]
    ds_read_b64_tr_b16 v[104:105], v14 offset:16384
    v_mfma_f32_16x16x32_bf16 v[68:71], v[144:147], v[156:159], v[68:71]
    s_waitcnt lgkmcnt(7)
    ds_read_b64_tr_b16 v[106:107], v14 offset:17408
    buffer_load_dwordx4 v227, s[44:47], s87 offen offset:3072 lds
    v_mfma_f32_16x16x32_bf16 v[72:75], v[148:151], v[152:155], v[72:75]
    ds_read_b64_tr_b16 v[108:109], v15 offset:16384
    v_mfma_f32_16x16x32_bf16 v[76:79], v[148:151], v[156:159], v[76:79]
    ds_read_b64_tr_b16 v[110:111], v15 offset:17408
    v_mfma_f32_16x16x32_bf16 v[16:19], v[80:83], v[112:115], v[16:19]
    ds_read_b128 v[152:155], v233 offset:4096
    ds_read_b128 v[156:159], v233 offset:6144
    v_mfma_f32_16x16x32_bf16 v[20:23], v[80:83], v[116:119], v[20:23]
    ds_read_b64_tr_b16 v[120:121], v8 offset:24576
    v_mfma_f32_16x16x32_bf16 v[24:27], v[84:87], v[112:115], v[24:27]
    ds_read_b64_tr_b16 v[122:123], v8 offset:25600
    ds_read_b64_tr_b16 v[124:125], v9 offset:24576
    v_mfma_f32_16x16x32_bf16 v[28:31], v[84:87], v[116:119], v[28:31]
    s_waitcnt lgkmcnt(7)
    ds_read_b64_tr_b16 v[126:127], v9 offset:25600
    v_mfma_f32_16x16x32_bf16 v[32:35], v[88:91], v[112:115], v[32:35]
    ds_read_b64_tr_b16 v[128:129], v10 offset:24576
    ds_read_b64_tr_b16 v[130:131], v10 offset:25600
    v_mfma_f32_16x16x32_bf16 v[36:39], v[88:91], v[116:119], v[36:39]
    ds_read_b64_tr_b16 v[132:133], v11 offset:24576
    v_mfma_f32_16x16x32_bf16 v[40:43], v[92:95], v[112:115], v[40:43]
    ds_read_b64_tr_b16 v[134:135], v11 offset:25600
    ds_read_b64_tr_b16 v[136:137], v12 offset:24576
    v_mfma_f32_16x16x32_bf16 v[44:47], v[92:95], v[116:119], v[44:47]
    ds_read_b64_tr_b16 v[138:139], v12 offset:25600
    v_mfma_f32_16x16x32_bf16 v[48:51], v[96:99], v[112:115], v[48:51]
    ds_read_b64_tr_b16 v[140:141], v13 offset:24576
    s_waitcnt lgkmcnt(7)
    ds_read_b64_tr_b16 v[142:143], v13 offset:25600
    v_mfma_f32_16x16x32_bf16 v[52:55], v[96:99], v[116:119], v[52:55]
    ds_read_b64_tr_b16 v[144:145], v14 offset:24576
    v_mfma_f32_16x16x32_bf16 v[56:59], v[100:103], v[112:115], v[56:59]
    ds_read_b64_tr_b16 v[146:147], v14 offset:25600
    ds_read_b64_tr_b16 v[148:149], v15 offset:24576
    v_mfma_f32_16x16x32_bf16 v[60:63], v[100:103], v[116:119], v[60:63]
    ds_read_b64_tr_b16 v[150:151], v15 offset:25600
    v_mfma_f32_16x16x32_bf16 v[64:67], v[104:107], v[112:115], v[64:67]
    v_mfma_f32_16x16x32_bf16 v[68:71], v[104:107], v[116:119], v[68:71]
    v_mfma_f32_16x16x32_bf16 v[72:75], v[108:111], v[112:115], v[72:75]
    v_mfma_f32_16x16x32_bf16 v[76:79], v[108:111], v[116:119], v[76:79]
    s_waitcnt lgkmcnt(0)
    s_waitcnt vmcnt(16)
    s_barrier
    v_mfma_f32_16x16x32_bf16 v[16:19], v[120:123], v[152:155], v[16:19]
    ds_read_b128 v[112:115], v232 offset:8192
    ds_read_b128 v[116:119], v232 offset:10240
    s_add_u32 m0, s78, 4096
    s_add_u32 s87, s93, 896
    buffer_load_dwordx4 v228, s[32:35], s87 offen offset:0 lds
    v_mfma_f32_16x16x32_bf16 v[20:23], v[120:123], v[156:159], v[20:23]
    ds_read_b64_tr_b16 v[80:81], v8 offset:32768
    buffer_load_dwordx4 v229, s[32:35], s87 offen offset:1024 lds
    v_mfma_f32_16x16x32_bf16 v[24:27], v[124:127], v[152:155], v[24:27]
    ds_read_b64_tr_b16 v[82:83], v8 offset:33792
    buffer_load_dwordx4 v230, s[32:35], s87 offen offset:2048 lds
    v_mfma_f32_16x16x32_bf16 v[28:31], v[124:127], v[156:159], v[28:31]
    ds_read_b64_tr_b16 v[84:85], v9 offset:32768
    buffer_load_dwordx4 v231, s[32:35], s87 offen offset:3072 lds
    s_add_u32 s71, s82, 131072
    v_add_u32 v253, s71, v8
    ds_read_b64_tr_b16 v[192:193], v253 offset:0
    ds_read_b64_tr_b16 v[194:195], v253 offset:1024
    v_mfma_f32_16x16x32_bf16 v[32:35], v[128:131], v[152:155], v[32:35]
    ds_read_b64_tr_b16 v[86:87], v9 offset:33792
    s_add_u32 m0, s81, 16384
    s_add_u32 s87, s89, 3670016
    buffer_load_dwordx4 v224, s[44:47], s87 offen offset:0 lds
    v_mfma_f32_16x16x32_bf16 v[36:39], v[128:131], v[156:159], v[36:39]
    ds_read_b64_tr_b16 v[88:89], v10 offset:32768
    buffer_load_dwordx4 v225, s[44:47], s87 offen offset:1024 lds
    v_mfma_f32_16x16x32_bf16 v[40:43], v[132:135], v[152:155], v[40:43]
    ds_read_b64_tr_b16 v[90:91], v10 offset:33792
    buffer_load_dwordx4 v226, s[44:47], s87 offen offset:2048 lds
    v_add_u32 v253, s71, v9
    ds_read_b64_tr_b16 v[196:197], v253 offset:0
    ds_read_b64_tr_b16 v[198:199], v253 offset:1024
    v_mfma_f32_16x16x32_bf16 v[44:47], v[132:135], v[156:159], v[44:47]
    ds_read_b64_tr_b16 v[92:93], v11 offset:32768
    buffer_load_dwordx4 v227, s[44:47], s87 offen offset:3072 lds
    v_mfma_f32_16x16x32_bf16 v[48:51], v[136:139], v[152:155], v[48:51]
    ds_read_b64_tr_b16 v[94:95], v11 offset:33792
    ds_read_b64_tr_b16 v[96:97], v12 offset:32768
    v_mfma_f32_16x16x32_bf16 v[52:55], v[136:139], v[156:159], v[52:55]
    s_waitcnt lgkmcnt(7)
    ds_read_b64_tr_b16 v[98:99], v12 offset:33792
    v_add_u32 v253, s71, v10
    ds_read_b64_tr_b16 v[200:201], v253 offset:0
    ds_read_b64_tr_b16 v[202:203], v253 offset:1024
    v_mfma_f32_16x16x32_bf16 v[56:59], v[140:143], v[152:155], v[56:59]
    ds_read_b64_tr_b16 v[100:101], v13 offset:32768
    v_mfma_f32_16x16x32_bf16 v[60:63], v[140:143], v[156:159], v[60:63]
    ds_read_b64_tr_b16 v[102:103], v13 offset:33792
    v_mfma_f32_16x16x32_bf16 v[64:67], v[144:147], v[152:155], v[64:67]
    ds_read_b64_tr_b16 v[104:105], v14 offset:32768
    v_add_u32 v253, s71, v11
    ds_read_b64_tr_b16 v[204:205], v253 offset:0
    ds_read_b64_tr_b16 v[206:207], v253 offset:1024
    v_mfma_f32_16x16x32_bf16 v[68:71], v[144:147], v[156:159], v[68:71]
    s_waitcnt lgkmcnt(7)
    ds_read_b64_tr_b16 v[106:107], v14 offset:33792
    v_mfma_f32_16x16x32_bf16 v[72:75], v[148:151], v[152:155], v[72:75]
    ds_read_b64_tr_b16 v[108:109], v15 offset:32768
    v_mfma_f32_16x16x32_bf16 v[76:79], v[148:151], v[156:159], v[76:79]
    ds_read_b64_tr_b16 v[110:111], v15 offset:33792
    v_mfma_f32_16x16x32_bf16 v[16:19], v[80:83], v[112:115], v[16:19]
    ds_read_b128 v[152:155], v233 offset:8192
    ds_read_b128 v[156:159], v233 offset:10240
    v_add_u32 v253, s71, v12
    ds_read_b64_tr_b16 v[208:209], v253 offset:0
    ds_read_b64_tr_b16 v[210:211], v253 offset:1024
    v_mfma_f32_16x16x32_bf16 v[20:23], v[80:83], v[116:119], v[20:23]
    ds_read_b64_tr_b16 v[120:121], v8 offset:40960
    v_mfma_f32_16x16x32_bf16 v[24:27], v[84:87], v[112:115], v[24:27]
    s_waitcnt lgkmcnt(7)
    ds_read_b64_tr_b16 v[122:123], v8 offset:41984
    ds_read_b64_tr_b16 v[124:125], v9 offset:40960
    v_mfma_f32_16x16x32_bf16 v[28:31], v[84:87], v[116:119], v[28:31]
    ds_read_b64_tr_b16 v[126:127], v9 offset:41984
    v_add_u32 v253, s71, v13
    ds_read_b64_tr_b16 v[212:213], v253 offset:0
    ds_read_b64_tr_b16 v[214:215], v253 offset:1024
    v_mfma_f32_16x16x32_bf16 v[32:35], v[88:91], v[112:115], v[32:35]
    ds_read_b64_tr_b16 v[128:129], v10 offset:40960
    ds_read_b64_tr_b16 v[130:131], v10 offset:41984
    v_mfma_f32_16x16x32_bf16 v[36:39], v[88:91], v[116:119], v[36:39]
    ds_read_b64_tr_b16 v[132:133], v11 offset:40960
    v_mfma_f32_16x16x32_bf16 v[40:43], v[92:95], v[112:115], v[40:43]
    s_waitcnt lgkmcnt(7)
    ds_read_b64_tr_b16 v[134:135], v11 offset:41984
    ds_read_b64_tr_b16 v[136:137], v12 offset:40960
    v_add_u32 v253, s71, v14
    ds_read_b64_tr_b16 v[216:217], v253 offset:0
    ds_read_b64_tr_b16 v[218:219], v253 offset:1024
    v_mfma_f32_16x16x32_bf16 v[44:47], v[92:95], v[116:119], v[44:47]
    ds_read_b64_tr_b16 v[138:139], v12 offset:41984
    v_mfma_f32_16x16x32_bf16 v[48:51], v[96:99], v[112:115], v[48:51]
    ds_read_b64_tr_b16 v[140:141], v13 offset:40960
    ds_read_b64_tr_b16 v[142:143], v13 offset:41984
    v_mfma_f32_16x16x32_bf16 v[52:55], v[96:99], v[116:119], v[52:55]
    ds_read_b64_tr_b16 v[144:145], v14 offset:40960
    v_add_u32 v253, s71, v15
    s_waitcnt lgkmcnt(7)
    ds_read_b64_tr_b16 v[220:221], v253 offset:0
    ds_read_b64_tr_b16 v[222:223], v253 offset:1024
    v_mfma_f32_16x16x32_bf16 v[56:59], v[100:103], v[112:115], v[56:59]
    ds_read_b64_tr_b16 v[146:147], v14 offset:41984
    ds_read_b64_tr_b16 v[148:149], v15 offset:40960
    v_mfma_f32_16x16x32_bf16 v[60:63], v[100:103], v[116:119], v[60:63]
    ds_read_b64_tr_b16 v[150:151], v15 offset:41984
    v_mfma_f32_16x16x32_bf16 v[64:67], v[104:107], v[112:115], v[64:67]
    v_mfma_f32_16x16x32_bf16 v[68:71], v[104:107], v[116:119], v[68:71]
    v_mfma_f32_16x16x32_bf16 v[72:75], v[108:111], v[112:115], v[72:75]
    v_mfma_f32_16x16x32_bf16 v[76:79], v[108:111], v[116:119], v[76:79]
    s_waitcnt lgkmcnt(0)
    s_waitcnt vmcnt(16)
    s_barrier
    v_mfma_f32_16x16x32_bf16 v[16:19], v[120:123], v[152:155], v[16:19]
    ds_read_b128 v[112:115], v232 offset:12288
    ds_read_b128 v[116:119], v232 offset:14336
    s_add_u32 m0, s82, 131072
    s_add_u32 s87, s4, 0
    buffer_load_dwordx4 v4, s[48:51], s87 offen offset:0 lds
    v_mfma_f32_16x16x32_bf16 v[20:23], v[120:123], v[156:159], v[20:23]
    ds_read_b64_tr_b16 v[80:81], v8 offset:49152
    buffer_load_dwordx4 v5, s[48:51], s87 offen offset:1024 lds
    v_mfma_f32_16x16x32_bf16 v[24:27], v[124:127], v[152:155], v[24:27]
    ds_read_b64_tr_b16 v[82:83], v8 offset:50176
    buffer_load_dwordx4 v6, s[48:51], s87 offen offset:2048 lds
    v_mfma_f32_16x16x32_bf16 v[28:31], v[124:127], v[156:159], v[28:31]
    ds_read_b64_tr_b16 v[84:85], v9 offset:49152
    buffer_load_dwordx4 v7, s[48:51], s87 offen offset:3072 lds
    v_mfma_f32_16x16x32_bf16 v[32:35], v[128:131], v[152:155], v[32:35]
    ds_read_b64_tr_b16 v[86:87], v9 offset:50176
    s_add_u32 m0, s82, 135168
    s_add_u32 s87, s4, 16384
    buffer_load_dwordx4 v4, s[48:51], s87 offen offset:0 lds
    v_mfma_f32_16x16x32_bf16 v[36:39], v[128:131], v[156:159], v[36:39]
    ds_read_b64_tr_b16 v[88:89], v10 offset:49152
    buffer_load_dwordx4 v5, s[48:51], s87 offen offset:1024 lds
    v_mfma_f32_16x16x32_bf16 v[40:43], v[132:135], v[152:155], v[40:43]
    ds_read_b64_tr_b16 v[90:91], v10 offset:50176
    buffer_load_dwordx4 v6, s[48:51], s87 offen offset:2048 lds
    v_mfma_f32_16x16x32_bf16 v[44:47], v[132:135], v[156:159], v[44:47]
    ds_read_b64_tr_b16 v[92:93], v11 offset:49152
    buffer_load_dwordx4 v7, s[48:51], s87 offen offset:3072 lds
    v_mfma_f32_16x16x32_bf16 v[48:51], v[136:139], v[152:155], v[48:51]
    ds_read_b64_tr_b16 v[94:95], v11 offset:50176
    ds_read_b64_tr_b16 v[96:97], v12 offset:49152
    buffer_load_dword v252, v241, s[60:63], 0 offen sc1
    v_mfma_f32_16x16x32_bf16 v[52:55], v[136:139], v[156:159], v[52:55]
    ds_read_b64_tr_b16 v[98:99], v12 offset:50176
    buffer_load_dword v242, v241, s[52:55], s18 offen
    v_mfma_f32_16x16x32_bf16 v[56:59], v[140:143], v[152:155], v[56:59]
    ds_read_b64_tr_b16 v[100:101], v13 offset:49152
    v_mfma_f32_16x16x32_bf16 v[60:63], v[140:143], v[156:159], v[60:63]
    ds_read_b64_tr_b16 v[102:103], v13 offset:50176
    v_mfma_f32_16x16x32_bf16 v[64:67], v[144:147], v[152:155], v[64:67]
    ds_read_b64_tr_b16 v[104:105], v14 offset:49152
    v_mfma_f32_16x16x32_bf16 v[68:71], v[144:147], v[156:159], v[68:71]
    s_waitcnt lgkmcnt(7)
    ds_read_b64_tr_b16 v[106:107], v14 offset:50176
    v_mfma_f32_16x16x32_bf16 v[72:75], v[148:151], v[152:155], v[72:75]
    ds_read_b64_tr_b16 v[108:109], v15 offset:49152
    v_mfma_f32_16x16x32_bf16 v[76:79], v[148:151], v[156:159], v[76:79]
    ds_read_b64_tr_b16 v[110:111], v15 offset:50176
    v_mfma_f32_16x16x32_bf16 v[16:19], v[80:83], v[112:115], v[16:19]
    ds_read_b128 v[152:155], v233 offset:12288
    ds_read_b128 v[156:159], v233 offset:14336
    v_mfma_f32_16x16x32_bf16 v[20:23], v[80:83], v[116:119], v[20:23]
    ds_read_b64_tr_b16 v[120:121], v8 offset:57344
    v_mfma_f32_16x16x32_bf16 v[24:27], v[84:87], v[112:115], v[24:27]
    ds_read_b64_tr_b16 v[122:123], v8 offset:58368
    ds_read_b64_tr_b16 v[124:125], v9 offset:57344
    v_mfma_f32_16x16x32_bf16 v[28:31], v[84:87], v[116:119], v[28:31]
    s_waitcnt lgkmcnt(7)
    ds_read_b64_tr_b16 v[126:127], v9 offset:58368
    v_mfma_f32_16x16x32_bf16 v[32:35], v[88:91], v[112:115], v[32:35]
    ds_read_b64_tr_b16 v[128:129], v10 offset:57344
    ds_read_b64_tr_b16 v[130:131], v10 offset:58368
    s_add_u32 m0, s78, 8192
    s_add_u32 s87, s93, 640
    buffer_load_dwordx4 v228, s[32:35], s87 offen offset:0 lds
    v_mfma_f32_16x16x32_bf16 v[36:39], v[88:91], v[116:119], v[36:39]
    ds_read_b64_tr_b16 v[132:133], v11 offset:57344
    v_mfma_f32_16x16x32_bf16 v[40:43], v[92:95], v[112:115], v[40:43]
    ds_read_b64_tr_b16 v[134:135], v11 offset:58368
    ds_read_b64_tr_b16 v[136:137], v12 offset:57344
    v_mfma_f32_16x16x32_bf16 v[44:47], v[92:95], v[116:119], v[44:47]
    ds_read_b64_tr_b16 v[138:139], v12 offset:58368
    buffer_load_dwordx4 v229, s[32:35], s87 offen offset:1024 lds
    v_mfma_f32_16x16x32_bf16 v[48:51], v[96:99], v[112:115], v[48:51]
    ds_read_b64_tr_b16 v[140:141], v13 offset:57344
    s_waitcnt lgkmcnt(7)
    ds_read_b64_tr_b16 v[142:143], v13 offset:58368
    v_mfma_f32_16x16x32_bf16 v[52:55], v[96:99], v[116:119], v[52:55]
    ds_read_b64_tr_b16 v[144:145], v14 offset:57344
    v_mfma_f32_16x16x32_bf16 v[56:59], v[100:103], v[112:115], v[56:59]
    ds_read_b64_tr_b16 v[146:147], v14 offset:58368
    ds_read_b64_tr_b16 v[148:149], v15 offset:57344
    buffer_load_dwordx4 v230, s[32:35], s87 offen offset:2048 lds
    v_mfma_f32_16x16x32_bf16 v[60:63], v[100:103], v[116:119], v[60:63]
    ds_read_b64_tr_b16 v[150:151], v15 offset:58368
    v_mfma_f32_16x16x32_bf16 v[64:67], v[104:107], v[112:115], v[64:67]
    v_mfma_f32_16x16x32_bf16 v[68:71], v[104:107], v[116:119], v[68:71]
    buffer_load_dwordx4 v231, s[32:35], s87 offen offset:3072 lds
    v_mfma_f32_16x16x32_bf16 v[72:75], v[108:111], v[112:115], v[72:75]
    v_mfma_f32_16x16x32_bf16 v[76:79], v[108:111], v[116:119], v[76:79]
    s_add_u32 m0, s81, 32768
    s_add_u32 s87, s89, 2621440
    buffer_load_dwordx4 v224, s[44:47], s87 offen offset:0 lds
    s_waitcnt lgkmcnt(0)
    s_waitcnt vmcnt(23)
    s_barrier
    v_mfma_f32_16x16x32_bf16 v[16:19], v[120:123], v[152:155], v[16:19]
    ds_read_b128 v[112:115], v232 offset:0
    ds_read_b128 v[116:119], v232 offset:2048
    v_mfma_f32_16x16x32_bf16 v[20:23], v[120:123], v[156:159], v[20:23]
    ds_read_b64_tr_b16 v[80:81], v8 offset:0
    v_mfma_f32_16x16x32_bf16 v[24:27], v[124:127], v[152:155], v[24:27]
    ds_read_b64_tr_b16 v[82:83], v8 offset:1024
    buffer_load_dwordx4 v225, s[44:47], s87 offen offset:1024 lds
    v_mfma_f32_16x16x32_bf16 v[28:31], v[124:127], v[156:159], v[28:31]
    ds_read_b64_tr_b16 v[84:85], v9 offset:0
    v_mfma_f32_16x16x32_bf16 v[32:35], v[128:131], v[152:155], v[32:35]
    ds_read_b64_tr_b16 v[86:87], v9 offset:1024
    v_mfma_f32_16x16x32_bf16 v[36:39], v[128:131], v[156:159], v[36:39]
    ds_read_b64_tr_b16 v[88:89], v10 offset:0
    buffer_load_dwordx4 v226, s[44:47], s87 offen offset:2048 lds
    v_mfma_f32_16x16x32_bf16 v[40:43], v[132:135], v[152:155], v[40:43]
    ds_read_b64_tr_b16 v[90:91], v10 offset:1024
    v_mfma_f32_16x16x32_bf16 v[44:47], v[132:135], v[156:159], v[44:47]
    ds_read_b64_tr_b16 v[92:93], v11 offset:0
    buffer_load_dwordx4 v227, s[44:47], s87 offen offset:3072 lds
    v_mfma_f32_16x16x32_bf16 v[48:51], v[136:139], v[152:155], v[48:51]
    ds_read_b64_tr_b16 v[94:95], v11 offset:1024
    ds_read_b64_tr_b16 v[96:97], v12 offset:0
    s_add_u32 m0, s78, 12288
    s_add_u32 s87, s93, 768
    buffer_load_dwordx4 v228, s[32:35], s87 offen offset:0 lds
    v_mfma_f32_16x16x32_bf16 v[52:55], v[136:139], v[156:159], v[52:55]
    ds_read_b64_tr_b16 v[98:99], v12 offset:1024
    buffer_load_dwordx4 v229, s[32:35], s87 offen offset:1024 lds
    v_mfma_f32_16x16x32_bf16 v[56:59], v[140:143], v[152:155], v[56:59]
    ds_read_b64_tr_b16 v[100:101], v13 offset:0
    v_mfma_f32_16x16x32_bf16 v[60:63], v[140:143], v[156:159], v[60:63]
    ds_read_b64_tr_b16 v[102:103], v13 offset:1024
    buffer_load_dwordx4 v230, s[32:35], s87 offen offset:2048 lds
    v_mfma_f32_16x16x32_bf16 v[64:67], v[144:147], v[152:155], v[64:67]
    ds_read_b64_tr_b16 v[104:105], v14 offset:0
    v_mfma_f32_16x16x32_bf16 v[68:71], v[144:147], v[156:159], v[68:71]
    s_waitcnt lgkmcnt(7)
    ds_read_b64_tr_b16 v[106:107], v14 offset:1024
    v_mfma_f32_16x16x32_bf16 v[72:75], v[148:151], v[152:155], v[72:75]
    ds_read_b64_tr_b16 v[108:109], v15 offset:0
    buffer_load_dwordx4 v231, s[32:35], s87 offen offset:3072 lds
    v_mfma_f32_16x16x32_bf16 v[76:79], v[148:151], v[156:159], v[76:79]
    ds_read_b64_tr_b16 v[110:111], v15 offset:1024
    v_mfma_f32_16x16x32_bf16 v[16:19], v[80:83], v[112:115], v[16:19]
    ds_read_b128 v[152:155], v233 offset:0
    ds_read_b128 v[156:159], v233 offset:2048
    s_add_u32 m0, s81, 49152
    s_add_u32 s87, s89, 3145728
    buffer_load_dwordx4 v224, s[44:47], s87 offen offset:0 lds
    v_mfma_f32_16x16x32_bf16 v[20:23], v[80:83], v[116:119], v[20:23]
    ds_read_b64_tr_b16 v[120:121], v8 offset:8192
    v_mfma_f32_16x16x32_bf16 v[24:27], v[84:87], v[112:115], v[24:27]
    ds_read_b64_tr_b16 v[122:123], v8 offset:9216
    ds_read_b64_tr_b16 v[124:125], v9 offset:8192
    v_mfma_f32_16x16x32_bf16 v[28:31], v[84:87], v[116:119], v[28:31]
    s_waitcnt lgkmcnt(7)
    ds_read_b64_tr_b16 v[126:127], v9 offset:9216
    buffer_load_dwordx4 v225, s[44:47], s87 offen offset:1024 lds
    v_mfma_f32_16x16x32_bf16 v[32:35], v[88:91], v[112:115], v[32:35]
    ds_read_b64_tr_b16 v[128:129], v10 offset:8192
    ds_read_b64_tr_b16 v[130:131], v10 offset:9216
    v_mfma_f32_16x16x32_bf16 v[36:39], v[88:91], v[116:119], v[36:39]
    ds_read_b64_tr_b16 v[132:133], v11 offset:8192
    v_mfma_f32_16x16x32_bf16 v[40:43], v[92:95], v[112:115], v[40:43]
    ds_read_b64_tr_b16 v[134:135], v11 offset:9216
    ds_read_b64_tr_b16 v[136:137], v12 offset:8192
    buffer_load_dwordx4 v226, s[44:47], s87 offen offset:2048 lds
    v_mfma_f32_16x16x32_bf16 v[44:47], v[92:95], v[116:119], v[44:47]
    ds_read_b64_tr_b16 v[138:139], v12 offset:9216
    v_mfma_f32_16x16x32_bf16 v[48:51], v[96:99], v[112:115], v[48:51]
    ds_read_b64_tr_b16 v[140:141], v13 offset:8192
    s_waitcnt lgkmcnt(7)
    ds_read_b64_tr_b16 v[142:143], v13 offset:9216
    buffer_load_dwordx4 v227, s[44:47], s87 offen offset:3072 lds
    v_mfma_f32_16x16x32_bf16 v[52:55], v[96:99], v[116:119], v[52:55]
    ds_read_b64_tr_b16 v[144:145], v14 offset:8192
    v_mfma_f32_16x16x32_bf16 v[56:59], v[100:103], v[112:115], v[56:59]
    ds_read_b64_tr_b16 v[146:147], v14 offset:9216
    ds_read_b64_tr_b16 v[148:149], v15 offset:8192
    v_mfma_f32_16x16x32_bf16 v[60:63], v[100:103], v[116:119], v[60:63]
    ds_read_b64_tr_b16 v[150:151], v15 offset:9216
    v_mfma_f32_16x16x32_bf16 v[64:67], v[104:107], v[112:115], v[64:67]
    v_mfma_f32_16x16x32_bf16 v[68:71], v[104:107], v[116:119], v[68:71]
    v_mfma_f32_16x16x32_bf16 v[72:75], v[108:111], v[112:115], v[72:75]
    v_mfma_f32_16x16x32_bf16 v[76:79], v[108:111], v[116:119], v[76:79]
    s_waitcnt lgkmcnt(0)
    s_waitcnt vmcnt(26)
    s_barrier
    v_mfma_f32_16x16x32_bf16 v[16:19], v[120:123], v[152:155], v[16:19]
    ds_read_b128 v[112:115], v232 offset:4096
    ds_read_b128 v[116:119], v232 offset:6144
    s_add_u32 m0, s81, 0
    s_add_u32 s87, s4, 65536
    buffer_load_dwordx4 v4, s[48:51], s87 offen offset:0 lds
    v_mfma_f32_16x16x32_bf16 v[20:23], v[120:123], v[156:159], v[20:23]
    ds_read_b64_tr_b16 v[80:81], v8 offset:16384
    buffer_load_dwordx4 v5, s[48:51], s87 offen offset:1024 lds
    v_mfma_f32_16x16x32_bf16 v[24:27], v[124:127], v[152:155], v[24:27]
    ds_read_b64_tr_b16 v[82:83], v8 offset:17408
    buffer_load_dwordx4 v6, s[48:51], s87 offen offset:2048 lds
    v_mfma_f32_16x16x32_bf16 v[28:31], v[124:127], v[156:159], v[28:31]
    ds_read_b64_tr_b16 v[84:85], v9 offset:16384
    buffer_load_dwordx4 v7, s[48:51], s87 offen offset:3072 lds
    v_mfma_f32_16x16x32_bf16 v[32:35], v[128:131], v[152:155], v[32:35]
    ds_read_b64_tr_b16 v[86:87], v9 offset:17408
    v_mfma_f32_16x16x32_bf16 v[36:39], v[128:131], v[156:159], v[36:39]
    ds_read_b64_tr_b16 v[88:89], v10 offset:16384
    v_mfma_f32_16x16x32_bf16 v[40:43], v[132:135], v[152:155], v[40:43]
    ds_read_b64_tr_b16 v[90:91], v10 offset:17408
    s_add_u32 m0, s78, 0
    s_add_u32 s87, s4, 81920
    buffer_load_dwordx4 v4, s[48:51], s87 offen offset:0 lds
    v_mfma_f32_16x16x32_bf16 v[44:47], v[132:135], v[156:159], v[44:47]
    ds_read_b64_tr_b16 v[92:93], v11 offset:16384
    v_mfma_f32_16x16x32_bf16 v[48:51], v[136:139], v[152:155], v[48:51]
    ds_read_b64_tr_b16 v[94:95], v11 offset:17408
    ds_read_b64_tr_b16 v[96:97], v12 offset:16384
    buffer_load_dwordx4 v5, s[48:51], s87 offen offset:1024 lds
    v_mfma_f32_16x16x32_bf16 v[52:55], v[136:139], v[156:159], v[52:55]
    ds_read_b64_tr_b16 v[98:99], v12 offset:17408
    v_mfma_f32_16x16x32_bf16 v[56:59], v[140:143], v[152:155], v[56:59]
    ds_read_b64_tr_b16 v[100:101], v13 offset:16384
    v_mfma_f32_16x16x32_bf16 v[60:63], v[140:143], v[156:159], v[60:63]
    ds_read_b64_tr_b16 v[102:103], v13 offset:17408
    buffer_load_dwordx4 v6, s[48:51], s87 offen offset:2048 lds
    v_mfma_f32_16x16x32_bf16 v[64:67], v[144:147], v[152:155], v[64:67]
    ds_read_b64_tr_b16 v[104:105], v14 offset:16384
    v_mfma_f32_16x16x32_bf16 v[68:71], v[144:147], v[156:159], v[68:71]
    s_waitcnt lgkmcnt(7)
    ds_read_b64_tr_b16 v[106:107], v14 offset:17408
    v_mfma_f32_16x16x32_bf16 v[72:75], v[148:151], v[152:155], v[72:75]
    ds_read_b64_tr_b16 v[108:109], v15 offset:16384
    buffer_load_dwordx4 v7, s[48:51], s87 offen offset:3072 lds
    v_mfma_f32_16x16x32_bf16 v[76:79], v[148:151], v[156:159], v[76:79]
    ds_read_b64_tr_b16 v[110:111], v15 offset:17408
    v_mfma_f32_16x16x32_bf16 v[16:19], v[80:83], v[112:115], v[16:19]
    ds_read_b128 v[152:155], v233 offset:4096
    ds_read_b128 v[156:159], v233 offset:6144
    v_mfma_f32_16x16x32_bf16 v[20:23], v[80:83], v[116:119], v[20:23]
    ds_read_b64_tr_b16 v[120:121], v8 offset:24576
    v_mfma_f32_16x16x32_bf16 v[24:27], v[84:87], v[112:115], v[24:27]
    ds_read_b64_tr_b16 v[122:123], v8 offset:25600
    ds_read_b64_tr_b16 v[124:125], v9 offset:24576
    v_mfma_f32_16x16x32_bf16 v[28:31], v[84:87], v[116:119], v[28:31]
    s_waitcnt lgkmcnt(7)
    ds_read_b64_tr_b16 v[126:127], v9 offset:25600
    v_mfma_f32_16x16x32_bf16 v[32:35], v[88:91], v[112:115], v[32:35]
    ds_read_b64_tr_b16 v[128:129], v10 offset:24576
    ds_read_b64_tr_b16 v[130:131], v10 offset:25600
    v_mfma_f32_16x16x32_bf16 v[36:39], v[88:91], v[116:119], v[36:39]
    ds_read_b64_tr_b16 v[132:133], v11 offset:24576
    v_mfma_f32_16x16x32_bf16 v[40:43], v[92:95], v[112:115], v[40:43]
    ds_read_b64_tr_b16 v[134:135], v11 offset:25600
    ds_read_b64_tr_b16 v[136:137], v12 offset:24576
    v_mfma_f32_16x16x32_bf16 v[44:47], v[92:95], v[116:119], v[44:47]
    ds_read_b64_tr_b16 v[138:139], v12 offset:25600
    v_mfma_f32_16x16x32_bf16 v[48:51], v[96:99], v[112:115], v[48:51]
    ds_read_b64_tr_b16 v[140:141], v13 offset:24576
    s_waitcnt lgkmcnt(7)
    ds_read_b64_tr_b16 v[142:143], v13 offset:25600
    v_mfma_f32_16x16x32_bf16 v[52:55], v[96:99], v[116:119], v[52:55]
    ds_read_b64_tr_b16 v[144:145], v14 offset:24576
    v_mfma_f32_16x16x32_bf16 v[56:59], v[100:103], v[112:115], v[56:59]
    ds_read_b64_tr_b16 v[146:147], v14 offset:25600
    ds_read_b64_tr_b16 v[148:149], v15 offset:24576
    v_mfma_f32_16x16x32_bf16 v[60:63], v[100:103], v[116:119], v[60:63]
    ds_read_b64_tr_b16 v[150:151], v15 offset:25600
    v_mfma_f32_16x16x32_bf16 v[64:67], v[104:107], v[112:115], v[64:67]
    v_mfma_f32_16x16x32_bf16 v[68:71], v[104:107], v[116:119], v[68:71]
    v_mfma_f32_16x16x32_bf16 v[72:75], v[108:111], v[112:115], v[72:75]
    v_mfma_f32_16x16x32_bf16 v[76:79], v[108:111], v[116:119], v[76:79]
    s_waitcnt lgkmcnt(0)
    s_waitcnt vmcnt(16)
    s_barrier
    v_mfma_f32_16x16x32_bf16 v[16:19], v[120:123], v[152:155], v[16:19]
    ds_read_b128 v[112:115], v232 offset:8192
    ds_read_b128 v[116:119], v232 offset:10240
    v_mfma_f32_16x16x32_bf16 v[20:23], v[120:123], v[156:159], v[20:23]
    ds_read_b64_tr_b16 v[80:81], v8 offset:32768
    v_mfma_f32_16x16x32_bf16 v[24:27], v[124:127], v[152:155], v[24:27]
    ds_read_b64_tr_b16 v[82:83], v8 offset:33792
    v_mfma_f32_16x16x32_bf16 v[28:31], v[124:127], v[156:159], v[28:31]
    ds_read_b64_tr_b16 v[84:85], v9 offset:32768
    s_add_u32 s71, s82, 131072
    v_add_u32 v253, s71, v244
    ds_read_b64_tr_b16 a[0:1], v253 offset:0
    ds_read_b64_tr_b16 a[2:3], v253 offset:1024
    v_mfma_f32_16x16x32_bf16 v[32:35], v[128:131], v[152:155], v[32:35]
    ds_read_b64_tr_b16 v[86:87], v9 offset:33792
    v_mfma_f32_16x16x32_bf16 v[36:39], v[128:131], v[156:159], v[36:39]
    ds_read_b64_tr_b16 v[88:89], v10 offset:32768
    v_mfma_f32_16x16x32_bf16 v[40:43], v[132:135], v[152:155], v[40:43]
    ds_read_b64_tr_b16 v[90:91], v10 offset:33792
    v_add_u32 v253, s71, v245
    ds_read_b64_tr_b16 a[4:5], v253 offset:0
    ds_read_b64_tr_b16 a[6:7], v253 offset:1024
    v_mfma_f32_16x16x32_bf16 v[44:47], v[132:135], v[156:159], v[44:47]
    ds_read_b64_tr_b16 v[92:93], v11 offset:32768
    v_mfma_f32_16x16x32_bf16 v[48:51], v[136:139], v[152:155], v[48:51]
    ds_read_b64_tr_b16 v[94:95], v11 offset:33792
    ds_read_b64_tr_b16 v[96:97], v12 offset:32768
    v_mfma_f32_16x16x32_bf16 v[52:55], v[136:139], v[156:159], v[52:55]
    s_waitcnt lgkmcnt(7)
    ds_read_b64_tr_b16 v[98:99], v12 offset:33792
    v_add_u32 v253, s71, v246
    ds_read_b64_tr_b16 a[8:9], v253 offset:0
    ds_read_b64_tr_b16 a[10:11], v253 offset:1024
    v_mfma_f32_16x16x32_bf16 v[56:59], v[140:143], v[152:155], v[56:59]
    ds_read_b64_tr_b16 v[100:101], v13 offset:32768
    v_mfma_f32_16x16x32_bf16 v[60:63], v[140:143], v[156:159], v[60:63]
    ds_read_b64_tr_b16 v[102:103], v13 offset:33792
    v_mfma_f32_16x16x32_bf16 v[64:67], v[144:147], v[152:155], v[64:67]
    ds_read_b64_tr_b16 v[104:105], v14 offset:32768
    v_add_u32 v253, s71, v247
    ds_read_b64_tr_b16 a[12:13], v253 offset:0
    ds_read_b64_tr_b16 a[14:15], v253 offset:1024
    v_mfma_f32_16x16x32_bf16 v[68:71], v[144:147], v[156:159], v[68:71]
    s_waitcnt lgkmcnt(7)
    ds_read_b64_tr_b16 v[106:107], v14 offset:33792
    v_mfma_f32_16x16x32_bf16 v[72:75], v[148:151], v[152:155], v[72:75]
    ds_read_b64_tr_b16 v[108:109], v15 offset:32768
    v_mfma_f32_16x16x32_bf16 v[76:79], v[148:151], v[156:159], v[76:79]
    ds_read_b64_tr_b16 v[110:111], v15 offset:33792
    v_mfma_f32_16x16x32_bf16 v[16:19], v[80:83], v[112:115], v[16:19]
    ds_read_b128 v[152:155], v233 offset:8192
    ds_read_b128 v[156:159], v233 offset:10240
    s_add_u32 s71, s82, 135168
    v_add_u32 v253, s71, v244
    ds_read_b64_tr_b16 a[16:17], v253 offset:0
    ds_read_b64_tr_b16 a[18:19], v253 offset:1024
    v_mfma_f32_16x16x32_bf16 v[20:23], v[80:83], v[116:119], v[20:23]
    ds_read_b64_tr_b16 v[120:121], v8 offset:40960
    v_mfma_f32_16x16x32_bf16 v[24:27], v[84:87], v[112:115], v[24:27]
    s_waitcnt lgkmcnt(7)
    ds_read_b64_tr_b16 v[122:123], v8 offset:41984
    ds_read_b64_tr_b16 v[124:125], v9 offset:40960
    v_mfma_f32_16x16x32_bf16 v[28:31], v[84:87], v[116:119], v[28:31]
    ds_read_b64_tr_b16 v[126:127], v9 offset:41984
    v_add_u32 v253, s71, v245
    ds_read_b64_tr_b16 a[20:21], v253 offset:0
    ds_read_b64_tr_b16 a[22:23], v253 offset:1024
    v_mfma_f32_16x16x32_bf16 v[32:35], v[88:91], v[112:115], v[32:35]
    ds_read_b64_tr_b16 v[128:129], v10 offset:40960
    ds_read_b64_tr_b16 v[130:131], v10 offset:41984
    v_mfma_f32_16x16x32_bf16 v[36:39], v[88:91], v[116:119], v[36:39]
    ds_read_b64_tr_b16 v[132:133], v11 offset:40960
    v_mfma_f32_16x16x32_bf16 v[40:43], v[92:95], v[112:115], v[40:43]
    s_waitcnt lgkmcnt(7)
    ds_read_b64_tr_b16 v[134:135], v11 offset:41984
    ds_read_b64_tr_b16 v[136:137], v12 offset:40960
    v_add_u32 v253, s71, v246
    ds_read_b64_tr_b16 a[24:25], v253 offset:0
    ds_read_b64_tr_b16 a[26:27], v253 offset:1024
    v_mfma_f32_16x16x32_bf16 v[44:47], v[92:95], v[116:119], v[44:47]
    ds_read_b64_tr_b16 v[138:139], v12 offset:41984
    v_mfma_f32_16x16x32_bf16 v[48:51], v[96:99], v[112:115], v[48:51]
    ds_read_b64_tr_b16 v[140:141], v13 offset:40960
    ds_read_b64_tr_b16 v[142:143], v13 offset:41984
    v_mfma_f32_16x16x32_bf16 v[52:55], v[96:99], v[116:119], v[52:55]
    ds_read_b64_tr_b16 v[144:145], v14 offset:40960
    v_add_u32 v253, s71, v247
    s_waitcnt lgkmcnt(7)
    ds_read_b64_tr_b16 a[28:29], v253 offset:0
    ds_read_b64_tr_b16 a[30:31], v253 offset:1024
    v_mfma_f32_16x16x32_bf16 v[56:59], v[100:103], v[112:115], v[56:59]
    ds_read_b64_tr_b16 v[146:147], v14 offset:41984
    ds_read_b64_tr_b16 v[148:149], v15 offset:40960
    v_mfma_f32_16x16x32_bf16 v[60:63], v[100:103], v[116:119], v[60:63]
    ds_read_b64_tr_b16 v[150:151], v15 offset:41984
    v_mfma_f32_16x16x32_bf16 v[64:67], v[104:107], v[112:115], v[64:67]
    v_mfma_f32_16x16x32_bf16 v[68:71], v[104:107], v[116:119], v[68:71]
    v_mfma_f32_16x16x32_bf16 v[72:75], v[108:111], v[112:115], v[72:75]
    v_mfma_f32_16x16x32_bf16 v[76:79], v[108:111], v[116:119], v[76:79]
    s_waitcnt lgkmcnt(0)
    s_waitcnt vmcnt(8)
    s_barrier
    v_mfma_f32_16x16x32_bf16 v[16:19], v[120:123], v[152:155], v[16:19]
    ds_read_b128 v[112:115], v232 offset:12288
    ds_read_b128 v[116:119], v232 offset:14336
    v_mfma_f32_16x16x32_bf16 v[20:23], v[120:123], v[156:159], v[20:23]
    ds_read_b64_tr_b16 v[80:81], v8 offset:49152
    v_mfma_f32_16x16x32_bf16 v[24:27], v[124:127], v[152:155], v[24:27]
    ds_read_b64_tr_b16 v[82:83], v8 offset:50176
    v_mfma_f32_16x16x32_bf16 v[28:31], v[124:127], v[156:159], v[28:31]
    ds_read_b64_tr_b16 v[84:85], v9 offset:49152
    v_mfma_f32_16x16x32_bf16 v[32:35], v[128:131], v[152:155], v[32:35]
    ds_read_b64_tr_b16 v[86:87], v9 offset:50176
    v_mfma_f32_16x16x32_bf16 v[36:39], v[128:131], v[156:159], v[36:39]
    ds_read_b64_tr_b16 v[88:89], v10 offset:49152
    v_mfma_f32_16x16x32_bf16 v[40:43], v[132:135], v[152:155], v[40:43]
    ds_read_b64_tr_b16 v[90:91], v10 offset:50176
    v_mfma_f32_16x16x32_bf16 v[44:47], v[132:135], v[156:159], v[44:47]
    ds_read_b64_tr_b16 v[92:93], v11 offset:49152
    v_mfma_f32_16x16x32_bf16 v[48:51], v[136:139], v[152:155], v[48:51]
    ds_read_b64_tr_b16 v[94:95], v11 offset:50176
    ds_read_b64_tr_b16 v[96:97], v12 offset:49152
    v_mfma_f32_16x16x32_bf16 v[52:55], v[136:139], v[156:159], v[52:55]
    ds_read_b64_tr_b16 v[98:99], v12 offset:50176
    v_mfma_f32_16x16x32_bf16 v[56:59], v[140:143], v[152:155], v[56:59]
    ds_read_b64_tr_b16 v[100:101], v13 offset:49152
    v_mfma_f32_16x16x32_bf16 v[60:63], v[140:143], v[156:159], v[60:63]
    ds_read_b64_tr_b16 v[102:103], v13 offset:50176
    v_mfma_f32_16x16x32_bf16 v[64:67], v[144:147], v[152:155], v[64:67]
    ds_read_b64_tr_b16 v[104:105], v14 offset:49152
    v_mfma_f32_16x16x32_bf16 v[68:71], v[144:147], v[156:159], v[68:71]
    s_waitcnt lgkmcnt(7)
    ds_read_b64_tr_b16 v[106:107], v14 offset:50176
    v_mfma_f32_16x16x32_bf16 v[72:75], v[148:151], v[152:155], v[72:75]
    ds_read_b64_tr_b16 v[108:109], v15 offset:49152
    v_mfma_f32_16x16x32_bf16 v[76:79], v[148:151], v[156:159], v[76:79]
    ds_read_b64_tr_b16 v[110:111], v15 offset:50176
    v_mfma_f32_16x16x32_bf16 v[16:19], v[80:83], v[112:115], v[16:19]
    ds_read_b128 v[152:155], v233 offset:12288
    ds_read_b128 v[156:159], v233 offset:14336
    v_mfma_f32_16x16x32_bf16 v[20:23], v[80:83], v[116:119], v[20:23]
    ds_read_b64_tr_b16 v[120:121], v8 offset:57344
    v_mfma_f32_16x16x32_bf16 v[24:27], v[84:87], v[112:115], v[24:27]
    ds_read_b64_tr_b16 v[122:123], v8 offset:58368
    ds_read_b64_tr_b16 v[124:125], v9 offset:57344
    v_mfma_f32_16x16x32_bf16 v[28:31], v[84:87], v[116:119], v[28:31]
    s_waitcnt lgkmcnt(7)
    ds_read_b64_tr_b16 v[126:127], v9 offset:58368
    v_mfma_f32_16x16x32_bf16 v[32:35], v[88:91], v[112:115], v[32:35]
    ds_read_b64_tr_b16 v[128:129], v10 offset:57344
    ds_read_b64_tr_b16 v[130:131], v10 offset:58368
    v_mfma_f32_16x16x32_bf16 v[36:39], v[88:91], v[116:119], v[36:39]
    ds_read_b64_tr_b16 v[132:133], v11 offset:57344
    v_mfma_f32_16x16x32_bf16 v[40:43], v[92:95], v[112:115], v[40:43]
    ds_read_b64_tr_b16 v[134:135], v11 offset:58368
    ds_read_b64_tr_b16 v[136:137], v12 offset:57344
    v_mfma_f32_16x16x32_bf16 v[44:47], v[92:95], v[116:119], v[44:47]
    ds_read_b64_tr_b16 v[138:139], v12 offset:58368
    v_mfma_f32_16x16x32_bf16 v[48:51], v[96:99], v[112:115], v[48:51]
    ds_read_b64_tr_b16 v[140:141], v13 offset:57344
    s_waitcnt lgkmcnt(7)
    ds_read_b64_tr_b16 v[142:143], v13 offset:58368
    v_mfma_f32_16x16x32_bf16 v[52:55], v[96:99], v[116:119], v[52:55]
    ds_read_b64_tr_b16 v[144:145], v14 offset:57344
    v_mfma_f32_16x16x32_bf16 v[56:59], v[100:103], v[112:115], v[56:59]
    ds_read_b64_tr_b16 v[146:147], v14 offset:58368
    ds_read_b64_tr_b16 v[148:149], v15 offset:57344
    v_mfma_f32_16x16x32_bf16 v[60:63], v[100:103], v[116:119], v[60:63]
    ds_read_b64_tr_b16 v[150:151], v15 offset:58368
    v_mfma_f32_16x16x32_bf16 v[64:67], v[104:107], v[112:115], v[64:67]
    v_mfma_f32_16x16x32_bf16 v[68:71], v[104:107], v[116:119], v[68:71]
    v_mfma_f32_16x16x32_bf16 v[72:75], v[108:111], v[112:115], v[72:75]
    v_mfma_f32_16x16x32_bf16 v[76:79], v[108:111], v[116:119], v[76:79]
L_common:
    v_mfma_f32_16x16x32_bf16 v[16:19], v[120:123], v[152:155], v[16:19]
    v_readfirstlane_b32 s84, v252
    v_mfma_f32_16x16x32_bf16 v[24:27], v[124:127], v[152:155], v[24:27]
    s_mov_b32 s72, 0x3fb8aa3b
    s_waitcnt lgkmcnt(10)
    v_mfma_f32_16x16x32_bf16 v[32:35], v[128:131], v[152:155], v[32:35]
    s_mov_b32 s73, 0x3db504f3
    s_waitcnt lgkmcnt(8)
    v_mfma_f32_16x16x32_bf16 v[40:43], v[132:135], v[152:155], v[40:43]
    s_waitcnt lgkmcnt(6)
    v_mfma_f32_16x16x32_bf16 v[48:51], v[136:139], v[152:155], v[48:51]
    s_waitcnt lgkmcnt(4)
    v_mfma_f32_16x16x32_bf16 v[56:59], v[140:143], v[152:155], v[56:59]
    s_waitcnt lgkmcnt(2)
    v_mfma_f32_16x16x32_bf16 v[64:67], v[144:147], v[152:155], v[64:67]
    s_waitcnt lgkmcnt(0)
    v_mfma_f32_16x16x32_bf16 v[72:75], v[148:151], v[152:155], v[72:75]
    v_mfma_f32_16x16x32_bf16 v[20:23], v[120:123], v[156:159], v[20:23]
    v_cvt_pk_bf16_f32 v80, v16, v17
    v_cvt_pk_bf16_f32 v81, v18, v19
    v_mfma_f32_16x16x32_bf16 v[28:31], v[124:127], v[156:159], v[28:31]
    v_cvt_pk_bf16_f32 v82, v24, v25
    v_cvt_pk_bf16_f32 v83, v26, v27
    v_mfma_f32_16x16x32_bf16 v[36:39], v[128:131], v[156:159], v[36:39]
    v_cvt_pk_bf16_f32 v88, v32, v33
    v_cvt_pk_bf16_f32 v89, v34, v35
    v_mfma_f32_16x16x32_bf16 v[44:47], v[132:135], v[156:159], v[44:47]
    v_cvt_pk_bf16_f32 v90, v40, v41
    v_cvt_pk_bf16_f32 v91, v42, v43
    v_mfma_f32_16x16x32_bf16 v[52:55], v[136:139], v[156:159], v[52:55]
    v_cvt_pk_bf16_f32 v96, v48, v49
    v_cvt_pk_bf16_f32 v97, v50, v51
    v_mfma_f32_16x16x32_bf16 v[60:63], v[140:143], v[156:159], v[60:63]
    v_cvt_pk_bf16_f32 v98, v56, v57
    v_cvt_pk_bf16_f32 v99, v58, v59
    v_mfma_f32_16x16x32_bf16 v[68:71], v[144:147], v[156:159], v[68:71]
    v_cvt_pk_bf16_f32 v104, v64, v65
    v_cvt_pk_bf16_f32 v105, v66, v67
    v_mfma_f32_16x16x32_bf16 v[76:79], v[148:151], v[156:159], v[76:79]
    v_cvt_pk_bf16_f32 v106, v72, v73
    v_cvt_pk_bf16_f32 v107, v74, v75
    v_mfma_f32_16x16x32_bf16 v[112:115], v[160:163], v[80:83], 0
    v_cvt_pk_bf16_f32 v84, v20, v21
    v_cvt_pk_bf16_f32 v85, v22, v23
    v_mfma_f32_16x16x32_bf16 v[116:119], v[176:179], v[80:83], 0
    v_cvt_pk_bf16_f32 v86, v28, v29
    v_cvt_pk_bf16_f32 v87, v30, v31
    v_mfma_f32_16x16x32_bf16 v[112:115], v[164:167], v[88:91], v[112:115]
    v_cvt_pk_bf16_f32 v92, v36, v37
    v_cvt_pk_bf16_f32 v93, v38, v39
    v_mfma_f32_16x16x32_bf16 v[116:119], v[180:183], v[88:91], v[116:119]
    v_cvt_pk_bf16_f32 v94, v44, v45
    v_cvt_pk_bf16_f32 v95, v46, v47
    v_mfma_f32_16x16x32_bf16 v[112:115], v[168:171], v[96:99], v[112:115]
    v_cvt_pk_bf16_f32 v100, v52, v53
    v_cvt_pk_bf16_f32 v101, v54, v55
    v_mfma_f32_16x16x32_bf16 v[116:119], v[184:187], v[96:99], v[116:119]
    v_cvt_pk_bf16_f32 v102, v60, v61
    v_cvt_pk_bf16_f32 v103, v62, v63
    v_mfma_f32_16x16x32_bf16 v[112:115], v[172:175], v[104:107], v[112:115]
    v_cvt_pk_bf16_f32 v108, v68, v69
    v_cvt_pk_bf16_f32 v109, v70, v71
    v_mfma_f32_16x16x32_bf16 v[116:119], v[188:191], v[104:107], v[116:119]
    v_cvt_pk_bf16_f32 v110, v76, v77
    v_cvt_pk_bf16_f32 v111, v78, v79
    v_mfma_f32_16x16x32_bf16 v[120:123], v[160:163], v[84:87], 0
    s_nop 0
    s_nop 0
    v_mfma_f32_16x16x32_bf16 v[124:127], v[176:179], v[84:87], 0
    v_cvt_pk_bf16_f32 v113, v112, v113
    v_cvt_pk_bf16_f32 v115, v114, v115
    v_mfma_f32_16x16x32_bf16 v[120:123], v[164:167], v[92:95], v[120:123]
    v_cvt_pk_bf16_f32 v117, v116, v117
    v_cvt_pk_bf16_f32 v119, v118, v119
    v_mfma_f32_16x16x32_bf16 v[124:127], v[180:183], v[92:95], v[124:127]
    v_lshlrev_b32 v112, 16, v113
    v_and_b32 v113, 0xffff0000, v113
    v_mfma_f32_16x16x32_bf16 v[120:123], v[168:171], v[100:103], v[120:123]
    v_lshlrev_b32 v114, 16, v115
    v_and_b32 v115, 0xffff0000, v115
    v_mfma_f32_16x16x32_bf16 v[124:127], v[184:187], v[100:103], v[124:127]
    v_lshlrev_b32 v116, 16, v117
    v_and_b32 v117, 0xffff0000, v117
    v_mfma_f32_16x16x32_bf16 v[120:123], v[172:175], v[108:111], v[120:123]
    v_lshlrev_b32 v118, 16, v119
    v_and_b32 v119, 0xffff0000, v119
    v_mfma_f32_16x16x32_bf16 v[124:127], v[188:191], v[108:111], v[124:127]
    v_mul_f32 v112, s73, v112
    v_mul_f32 v113, s73, v113
    v_mul_f32 v114, s73, v114
    v_mul_f32 v115, s73, v115
    v_mul_f32 v116, s73, v116
    v_mul_f32 v117, s73, v117
    v_mul_f32 v118, s73, v118
    v_mul_f32 v119, s73, v119
    v_cvt_pk_bf16_f32 v113, v112, v113
    v_cvt_pk_bf16_f32 v115, v114, v115
    v_cvt_pk_bf16_f32 v117, v116, v117
    v_cvt_pk_bf16_f32 v119, v118, v119
    v_lshlrev_b32 v112, 16, v113
    v_and_b32 v113, 0xffff0000, v113
    v_lshlrev_b32 v114, 16, v115
    v_and_b32 v115, 0xffff0000, v115
    v_lshlrev_b32 v116, 16, v117
    v_and_b32 v117, 0xffff0000, v117
    v_lshlrev_b32 v118, 16, v119
    v_and_b32 v119, 0xffff0000, v119
    v_max3_f32 v240, v112, v113, v114
    v_max3_f32 v241, v115, v116, v117
    v_max3_f32 v240, v240, v118, v119
    v_max_f32 v240, v240, v241
    v_mov_b32 v241, v240
    v_cvt_pk_bf16_f32 v121, v120, v121
    v_cvt_pk_bf16_f32 v123, v122, v123
    v_permlane32_swap_b32 v240, v241
    v_cvt_pk_bf16_f32 v125, v124, v125
    v_max_f32 v240, v240, v241
    v_mov_b32 v241, v240
    v_cvt_pk_bf16_f32 v127, v126, v127
    v_lshlrev_b32 v120, 16, v121
    v_permlane16_swap_b32 v240, v241
    v_and_b32 v121, 0xffff0000, v121
    v_max_f32 v240, v240, v241
    v_mul_f32 v240, s72, v240
    v_fma_f32 v112, v112, s72, -v240
    v_fma_f32 v113, v113, s72, -v240
    v_fma_f32 v114, v114, s72, -v240
    v_fma_f32 v115, v115, s72, -v240
    v_fma_f32 v116, v116, s72, -v240
    v_fma_f32 v117, v117, s72, -v240
    v_fma_f32 v118, v118, s72, -v240
    v_fma_f32 v119, v119, s72, -v240
    v_exp_f32 v112, v112
    v_exp_f32 v113, v113
    v_exp_f32 v114, v114
    v_exp_f32 v115, v115
    v_exp_f32 v116, v116
    v_exp_f32 v117, v117
    v_exp_f32 v118, v118
    v_exp_f32 v119, v119
    v_add_f32 v240, v112, v113
    v_add_f32 v241, v114, v115
    v_add_f32 v240, v240, v116
    v_add_f32 v241, v241, v117
    v_add_f32 v240, v240, v118
    v_add_f32 v241, v241, v119
    v_add_f32 v240, v240, v241
    v_mov_b32 v241, v240
    v_lshlrev_b32 v122, 16, v123
    v_and_b32 v123, 0xffff0000, v123
    v_permlane32_swap_b32 v240, v241
    v_lshlrev_b32 v124, 16, v125
    v_add_f32 v240, v240, v241
    v_mov_b32 v241, v240
    v_and_b32 v125, 0xffff0000, v125
    v_lshlrev_b32 v126, 16, v127
    v_permlane16_swap_b32 v240, v241
    v_and_b32 v127, 0xffff0000, v127
    v_add_f32 v240, v240, v241
    v_rcp_f32 v240, v240
    v_mul_f32 v120, s73, v120
    v_mul_f32 v112, v112, v240
    v_mul_f32 v113, v113, v240
    v_mul_f32 v114, v114, v240
    v_mul_f32 v115, v115, v240
    v_mul_f32 v116, v116, v240
    v_mul_f32 v117, v117, v240
    v_mul_f32 v118, v118, v240
    v_mul_f32 v119, v119, v240
    v_cvt_pk_bf16_f32 v128, v112, v113
    v_cvt_pk_bf16_f32 v129, v114, v115
    v_cvt_pk_bf16_f32 v130, v116, v117
    v_cvt_pk_bf16_f32 v131, v118, v119
    v_mul_f32 v121, s73, v121
    v_mul_f32 v122, s73, v122
    v_mfma_f32_16x16x32_bf16 v[16:19], v[192:195], v[128:131], 0
    v_mul_f32 v123, s73, v123
    v_mul_f32 v124, s73, v124
    v_mfma_f32_16x16x32_bf16 v[24:27], v[196:199], v[128:131], 0
    v_mul_f32 v125, s73, v125
    v_mul_f32 v126, s73, v126
    v_mfma_f32_16x16x32_bf16 v[32:35], v[200:203], v[128:131], 0
    v_mul_f32 v127, s73, v127
    v_cvt_pk_bf16_f32 v121, v120, v121
    v_mfma_f32_16x16x32_bf16 v[40:43], v[204:207], v[128:131], 0
    v_cvt_pk_bf16_f32 v123, v122, v123
    v_cvt_pk_bf16_f32 v125, v124, v125
    v_mfma_f32_16x16x32_bf16 v[48:51], v[208:211], v[128:131], 0
    v_cvt_pk_bf16_f32 v127, v126, v127
    v_lshlrev_b32 v120, 16, v121
    v_mfma_f32_16x16x32_bf16 v[56:59], v[212:215], v[128:131], 0
    v_and_b32 v121, 0xffff0000, v121
    v_lshlrev_b32 v122, 16, v123
    v_mfma_f32_16x16x32_bf16 v[64:67], v[216:219], v[128:131], 0
    v_and_b32 v123, 0xffff0000, v123
    v_lshlrev_b32 v124, 16, v125
    v_mfma_f32_16x16x32_bf16 v[72:75], v[220:223], v[128:131], 0
    v_cvt_pk_bf16_f32 v80, v16, v17
    v_cvt_pk_bf16_f32 v81, v18, v19
    v_cvt_pk_bf16_f32 v82, v24, v25
    v_cvt_pk_bf16_f32 v83, v26, v27
    buffer_store_dwordx4 v[80:83], v249, s[52:55], s22 offen offset:0 sc1
    v_cvt_pk_bf16_f32 v88, v32, v33
    v_cvt_pk_bf16_f32 v89, v34, v35
    v_cvt_pk_bf16_f32 v90, v40, v41
    v_cvt_pk_bf16_f32 v91, v42, v43
    v_and_b32 v125, 0xffff0000, v125
    v_lshlrev_b32 v126, 16, v127
    v_and_b32 v127, 0xffff0000, v127
    v_max3_f32 v242, v120, v121, v122
    v_max3_f32 v243, v123, v124, v125
    v_max3_f32 v242, v242, v126, v127
    v_max_f32 v242, v242, v243
    v_mov_b32 v243, v242
    s_nop 0
    s_nop 0
    v_permlane32_swap_b32 v242, v243
    buffer_store_dwordx4 v[88:91], v249, s[52:55], s22 offen offset:2048 sc1
    v_cvt_pk_bf16_f32 v96, v48, v49
    v_cvt_pk_bf16_f32 v97, v50, v51
    v_cvt_pk_bf16_f32 v98, v56, v57
    v_cvt_pk_bf16_f32 v99, v58, v59
    v_max_f32 v242, v242, v243
    v_mov_b32 v243, v242
    s_nop 0
    s_nop 0
    v_permlane16_swap_b32 v242, v243
    s_nop 0
    v_max_f32 v242, v242, v243
    v_mul_f32 v242, s72, v242
    v_fma_f32 v120, v120, s72, -v242
    v_fma_f32 v121, v121, s72, -v242
    v_fma_f32 v122, v122, s72, -v242
    buffer_store_dwordx4 v[96:99], v249, s[52:55], s23 offen offset:0 sc1
    v_cvt_pk_bf16_f32 v104, v64, v65
    v_cvt_pk_bf16_f32 v105, v66, v67
    v_cvt_pk_bf16_f32 v106, v72, v73
    v_cvt_pk_bf16_f32 v107, v74, v75
    v_fma_f32 v123, v123, s72, -v242
    v_fma_f32 v124, v124, s72, -v242
    v_fma_f32 v125, v125, s72, -v242
    v_fma_f32 v126, v126, s72, -v242
    v_fma_f32 v127, v127, s72, -v242
    v_exp_f32 v120, v120
    v_exp_f32 v121, v121
    v_exp_f32 v122, v122
    buffer_store_dwordx4 v[104:107], v249, s[52:55], s23 offen offset:2048 sc1
    v_exp_f32 v123, v123
    v_exp_f32 v124, v124
    v_exp_f32 v125, v125
    v_exp_f32 v126, v126
    v_exp_f32 v127, v127
    v_add_f32 v242, v120, v121
    v_add_f32 v243, v122, v123
    v_add_f32 v242, v242, v124
    v_add_f32 v243, v243, v125
    v_add_f32 v242, v242, v126
    v_add_f32 v243, v243, v127
    v_add_f32 v242, v242, v243
    v_mov_b32 v243, v242
    s_nop 0
    s_nop 0
    v_permlane32_swap_b32 v242, v243
    s_nop 0
    v_add_f32 v242, v242, v243
    v_mov_b32 v243, v242
    s_nop 0
    s_nop 0
    v_permlane16_swap_b32 v242, v243
    s_nop 0
    v_add_f32 v242, v242, v243
    v_rcp_f32 v242, v242
    s_nop 0
    v_mul_f32 v120, v120, v242
    v_mul_f32 v121, v121, v242
    v_mul_f32 v122, v122, v242
    v_mul_f32 v123, v123, v242
    v_mul_f32 v124, v124, v242
    v_mul_f32 v125, v125, v242
    v_mul_f32 v126, v126, v242
    v_mul_f32 v127, v127, v242
    v_cvt_pk_bf16_f32 v132, v120, v121
    v_cvt_pk_bf16_f32 v133, v122, v123
    v_cvt_pk_bf16_f32 v134, v124, v125
    v_cvt_pk_bf16_f32 v135, v126, v127
    s_nop 0
    s_nop 0
    v_mfma_f32_16x16x32_bf16 v[20:23], v[192:195], v[132:135], 0
    v_mfma_f32_16x16x32_bf16 v[28:31], v[196:199], v[132:135], 0
    v_mfma_f32_16x16x32_bf16 v[36:39], v[200:203], v[132:135], 0
    v_mfma_f32_16x16x32_bf16 v[44:47], v[204:207], v[132:135], 0
    v_mfma_f32_16x16x32_bf16 v[52:55], v[208:211], v[132:135], 0
    v_mfma_f32_16x16x32_bf16 v[60:63], v[212:215], v[132:135], 0
    v_mfma_f32_16x16x32_bf16 v[68:71], v[216:219], v[132:135], 0
    v_mfma_f32_16x16x32_bf16 v[76:79], v[220:223], v[132:135], 0
    s_nop 0
    v_cvt_pk_bf16_f32 v84, v20, v21
    v_cvt_pk_bf16_f32 v85, v22, v23
    v_cvt_pk_bf16_f32 v86, v28, v29
    v_cvt_pk_bf16_f32 v87, v30, v31
    buffer_store_dwordx4 v[84:87], v249, s[52:55], s22 offen offset:1024 sc1
    v_cvt_pk_bf16_f32 v92, v36, v37
    v_cvt_pk_bf16_f32 v93, v38, v39
    v_cvt_pk_bf16_f32 v94, v44, v45
    v_cvt_pk_bf16_f32 v95, v46, v47
    buffer_store_dwordx4 v[92:95], v249, s[52:55], s22 offen offset:3072 sc1
    v_cvt_pk_bf16_f32 v100, v52, v53
    v_cvt_pk_bf16_f32 v101, v54, v55
    v_cvt_pk_bf16_f32 v102, v60, v61
    v_cvt_pk_bf16_f32 v103, v62, v63
    buffer_store_dwordx4 v[100:103], v249, s[52:55], s23 offen offset:1024 sc1
    v_cvt_pk_bf16_f32 v108, v68, v69
    v_cvt_pk_bf16_f32 v109, v70, v71
    v_cvt_pk_bf16_f32 v110, v76, v77
    v_cvt_pk_bf16_f32 v111, v78, v79
    buffer_store_dwordx4 v[108:111], v249, s[52:55], s23 offen offset:3072 sc1
    s_barrier
    s_cmp_lg_u32 s84, 0
    s_cbranch_scc1 L_havenonce
    s_mov_b32 s85, 0
    v_mov_b32 v240, 0
L_nonce_spin:
    buffer_load_dword v252, v240, s[60:63], 0 offen sc1
    s_waitcnt vmcnt(0)
    v_readfirstlane_b32 s84, v252
    s_add_u32 s85, s85, 1
    s_cmp_gt_u32 s85, 100000
    s_cbranch_scc1 L_havenonce
    s_cmp_eq_u32 s84, 0
    s_cbranch_scc1 L_nonce_spin
L_havenonce:
    v_mov_b32 v2, v249
    s_add_u32 s70, s64, 1
    s_and_b32 s70, s70, 3
    s_mul_i32 s70, s70, 12288
    s_add_u32 s70, s70, 0
    v_add_u32 v8, s70, v249
    s_add_u32 s70, s64, 2
    s_and_b32 s70, s70, 3
    s_mul_i32 s70, s70, 12288
    s_add_u32 s70, s70, 4096
    v_add_u32 v9, s70, v249
    s_add_u32 s70, s64, 3
    s_and_b32 s70, s70, 3
    s_mul_i32 s70, s70, 12288
    s_add_u32 s70, s70, 8192
    v_add_u32 v10, s70, v249
    s_mul_i32 s70, s64, 12288
    v_add_u32 v3, s70, v249
    v_lshrrev_b32 v12, 5, v0
    v_lshlrev_b32 v12, 25, v12
    v_lshl_add_u32 v12, v0, 2, v12
    v_mov_b32 v13, s84
    v_and_b32 v15, 7, v0
    v_lshlrev_b32 v15, 7, v15
    v_and_b32 v11, 31, v0
    v_lshlrev_b32 v11, 12, v11
    v_lshrrev_b32 v240, 5, v0
    v_lshl_add_u32 v11, v240, 4, v11
    v_and_b32 v241, 15, v0
    v_lshlrev_b32 v241, 4, v241
    v_lshl_add_u32 v241, v240, 8, v241
    v_bfe_u32 v240, v0, 4, 1
    v_lshl_add_u32 v241, v240, 10, v241
    s_waitcnt vmcnt(12)
    s_add_u32 s71, s81, 0
    v_add_u32 v253, s71, v244
    ds_read_b64_tr_b16 a[32:33], v253 offset:0
    ds_read_b64_tr_b16 a[34:35], v253 offset:1024
    v_add_u32 v253, s71, v245
    ds_read_b64_tr_b16 a[36:37], v253 offset:0
    ds_read_b64_tr_b16 a[38:39], v253 offset:1024
    v_add_u32 v253, s71, v246
    ds_read_b64_tr_b16 a[40:41], v253 offset:0
    ds_read_b64_tr_b16 a[42:43], v253 offset:1024
    v_add_u32 v253, s71, v247
    ds_read_b64_tr_b16 a[44:45], v253 offset:0
    ds_read_b64_tr_b16 a[46:47], v253 offset:1024
    s_waitcnt vmcnt(8)
    s_add_u32 s71, s78, 0
    v_add_u32 v253, s71, v244
    ds_read_b64_tr_b16 a[48:49], v253 offset:0
    ds_read_b64_tr_b16 a[50:51], v253 offset:1024
    v_add_u32 v253, s71, v245
    ds_read_b64_tr_b16 a[52:53], v253 offset:0
    ds_read_b64_tr_b16 a[54:55], v253 offset:1024
    v_add_u32 v253, s71, v246
    ds_read_b64_tr_b16 a[56:57], v253 offset:0
    ds_read_b64_tr_b16 a[58:59], v253 offset:1024
    v_add_u32 v253, s71, v247
    ds_read_b64_tr_b16 a[60:61], v253 offset:0
    s_waitcnt lgkmcnt(12)
    ds_read_b64_tr_b16 a[62:63], v253 offset:1024
    s_waitcnt lgkmcnt(0)
    s_waitcnt vmcnt(0)
    buffer_store_dword v13, v12, s[52:55], s18 offen sc1
    s_add_u32 m0, s81, 16384
    s_add_u32 s87, s5, 0
    buffer_load_dwordx4 v4, s[48:51], s87 offen offset:0 lds
    buffer_load_dwordx4 v5, s[48:51], s87 offen offset:1024 lds
    buffer_load_dwordx4 v6, s[48:51], s87 offen offset:2048 lds
    buffer_load_dwordx4 v7, s[48:51], s87 offen offset:3072 lds
    s_add_u32 m0, s78, 4096
    s_add_u32 s87, s6, 0
    buffer_load_dwordx4 v4, s[48:51], s87 offen offset:0 lds
    buffer_load_dwordx4 v5, s[48:51], s87 offen offset:1024 lds
    buffer_load_dwordx4 v6, s[48:51], s87 offen offset:2048 lds
    buffer_load_dwordx4 v7, s[48:51], s87 offen offset:3072 lds
    s_add_u32 m0, s81, 32768
    s_add_u32 s87, s7, 0
    buffer_load_dwordx4 v4, s[48:51], s87 offen offset:0 lds
    buffer_load_dwordx4 v5, s[48:51], s87 offen offset:1024 lds
    buffer_load_dwordx4 v6, s[48:51], s87 offen offset:2048 lds
    buffer_load_dwordx4 v7, s[48:51], s87 offen offset:3072 lds
    s_waitcnt vmcnt(8)
    s_add_u32 s71, s81, 16384
    v_add_u32 v253, s71, v244
    ds_read_b64_tr_b16 a[64:65], v253 offset:0
    ds_read_b64_tr_b16 a[66:67], v253 offset:1024
    v_add_u32 v253, s71, v245
    ds_read_b64_tr_b16 a[68:69], v253 offset:0
    ds_read_b64_tr_b16 a[70:71], v253 offset:1024
    v_add_u32 v253, s71, v246
    ds_read_b64_tr_b16 a[72:73], v253 offset:0
    ds_read_b64_tr_b16 a[74:75], v253 offset:1024
    v_add_u32 v253, s71, v247
    ds_read_b64_tr_b16 a[76:77], v253 offset:0
    ds_read_b64_tr_b16 a[78:79], v253 offset:1024
    s_add_u32 m0, s78, 8192
    s_add_u32 s87, s5, 16384
    buffer_load_dwordx4 v4, s[48:51], s87 offen offset:0 lds
    buffer_load_dwordx4 v5, s[48:51], s87 offen offset:1024 lds
    buffer_load_dwordx4 v6, s[48:51], s87 offen offset:2048 lds
    buffer_load_dwordx4 v7, s[48:51], s87 offen offset:3072 lds
    s_waitcnt vmcnt(8)
    s_add_u32 s71, s78, 4096
    v_add_u32 v253, s71, v244
    ds_read_b64_tr_b16 a[128:129], v253 offset:0
    ds_read_b64_tr_b16 a[130:131], v253 offset:1024
    v_add_u32 v253, s71, v245
    ds_read_b64_tr_b16 a[132:133], v253 offset:0
    ds_read_b64_tr_b16 a[134:135], v253 offset:1024
    v_add_u32 v253, s71, v246
    ds_read_b64_tr_b16 a[136:137], v253 offset:0
    ds_read_b64_tr_b16 a[138:139], v253 offset:1024
    v_add_u32 v253, s71, v247
    ds_read_b64_tr_b16 a[140:141], v253 offset:0
    s_waitcnt lgkmcnt(12)
    ds_read_b64_tr_b16 a[142:143], v253 offset:1024
    s_add_u32 m0, s82, 131072
    s_add_u32 s87, s6, 16384
    buffer_load_dwordx4 v4, s[48:51], s87 offen offset:0 lds
    buffer_load_dwordx4 v5, s[48:51], s87 offen offset:1024 lds
    buffer_load_dwordx4 v6, s[48:51], s87 offen offset:2048 lds
    buffer_load_dwordx4 v7, s[48:51], s87 offen offset:3072 lds
    s_waitcnt vmcnt(8)
    s_add_u32 s71, s81, 32768
    v_add_u32 v253, s71, v244
    ds_read_b64_tr_b16 a[192:193], v253 offset:0
    ds_read_b64_tr_b16 a[194:195], v253 offset:1024
    v_add_u32 v253, s71, v245
    s_waitcnt lgkmcnt(12)
    ds_read_b64_tr_b16 a[196:197], v253 offset:0
    ds_read_b64_tr_b16 a[198:199], v253 offset:1024
    v_add_u32 v253, s71, v246
    ds_read_b64_tr_b16 a[200:201], v253 offset:0
    s_waitcnt lgkmcnt(12)
    ds_read_b64_tr_b16 a[202:203], v253 offset:1024
    v_add_u32 v253, s71, v247
    ds_read_b64_tr_b16 a[204:205], v253 offset:0
    ds_read_b64_tr_b16 a[206:207], v253 offset:1024
    s_add_u32 m0, s82, 135168
    s_add_u32 s87, s7, 16384
    buffer_load_dwordx4 v4, s[48:51], s87 offen offset:0 lds
    buffer_load_dwordx4 v5, s[48:51], s87 offen offset:1024 lds
    buffer_load_dwordx4 v6, s[48:51], s87 offen offset:2048 lds
    buffer_load_dwordx4 v7, s[48:51], s87 offen offset:3072 lds
    s_waitcnt vmcnt(8)
    s_add_u32 s71, s78, 8192
    v_add_u32 v253, s71, v244
    s_waitcnt lgkmcnt(12)
    ds_read_b64_tr_b16 a[80:81], v253 offset:0
    ds_read_b64_tr_b16 a[82:83], v253 offset:1024
    v_add_u32 v253, s71, v245
    ds_read_b64_tr_b16 a[84:85], v253 offset:0
    s_waitcnt lgkmcnt(12)
    ds_read_b64_tr_b16 a[86:87], v253 offset:1024
    v_add_u32 v253, s71, v246
    ds_read_b64_tr_b16 a[88:89], v253 offset:0
    ds_read_b64_tr_b16 a[90:91], v253 offset:1024
    v_add_u32 v253, s71, v247
    s_waitcnt lgkmcnt(12)
    ds_read_b64_tr_b16 a[92:93], v253 offset:0
    ds_read_b64_tr_b16 a[94:95], v253 offset:1024
    s_add_u32 m0, s78, 12288
    s_add_u32 s87, s5, 65536
    buffer_load_dwordx4 v4, s[48:51], s87 offen offset:0 lds
    buffer_load_dwordx4 v5, s[48:51], s87 offen offset:1024 lds
    buffer_load_dwordx4 v6, s[48:51], s87 offen offset:2048 lds
    buffer_load_dwordx4 v7, s[48:51], s87 offen offset:3072 lds
    s_waitcnt vmcnt(8)
    s_add_u32 s71, s82, 131072
    v_add_u32 v253, s71, v244
    ds_read_b64_tr_b16 a[144:145], v253 offset:0
    s_waitcnt lgkmcnt(12)
    ds_read_b64_tr_b16 a[146:147], v253 offset:1024
    v_add_u32 v253, s71, v245
    ds_read_b64_tr_b16 a[148:149], v253 offset:0
    ds_read_b64_tr_b16 a[150:151], v253 offset:1024
    v_add_u32 v253, s71, v246
    s_waitcnt lgkmcnt(12)
    ds_read_b64_tr_b16 a[152:153], v253 offset:0
    ds_read_b64_tr_b16 a[154:155], v253 offset:1024
    v_add_u32 v253, s71, v247
    ds_read_b64_tr_b16 a[156:157], v253 offset:0
    s_waitcnt lgkmcnt(12)
    ds_read_b64_tr_b16 a[158:159], v253 offset:1024
    s_add_u32 m0, s81, 49152
    s_add_u32 s87, s6, 65536
    buffer_load_dwordx4 v4, s[48:51], s87 offen offset:0 lds
    buffer_load_dwordx4 v5, s[48:51], s87 offen offset:1024 lds
    buffer_load_dwordx4 v6, s[48:51], s87 offen offset:2048 lds
    buffer_load_dwordx4 v7, s[48:51], s87 offen offset:3072 lds
    s_waitcnt vmcnt(8)
    s_add_u32 s71, s82, 135168
    v_add_u32 v253, s71, v244
    ds_read_b64_tr_b16 a[208:209], v253 offset:0
    ds_read_b64_tr_b16 a[210:211], v253 offset:1024
    v_add_u32 v253, s71, v245
    s_waitcnt lgkmcnt(12)
    ds_read_b64_tr_b16 a[212:213], v253 offset:0
    ds_read_b64_tr_b16 a[214:215], v253 offset:1024
    v_add_u32 v253, s71, v246
    ds_read_b64_tr_b16 a[216:217], v253 offset:0
    s_waitcnt lgkmcnt(12)
    ds_read_b64_tr_b16 a[218:219], v253 offset:1024
    v_add_u32 v253, s71, v247
    ds_read_b64_tr_b16 a[220:221], v253 offset:0
    ds_read_b64_tr_b16 a[222:223], v253 offset:1024
    s_add_u32 m0, s81, 0
    s_add_u32 s87, s7, 65536
    buffer_load_dwordx4 v4, s[48:51], s87 offen offset:0 lds
    buffer_load_dwordx4 v5, s[48:51], s87 offen offset:1024 lds
    buffer_load_dwordx4 v6, s[48:51], s87 offen offset:2048 lds
    buffer_load_dwordx4 v7, s[48:51], s87 offen offset:3072 lds
    s_waitcnt vmcnt(8)
    s_add_u32 s71, s78, 12288
    v_add_u32 v253, s71, v244
    s_waitcnt lgkmcnt(12)
    ds_read_b64_tr_b16 a[96:97], v253 offset:0
    ds_read_b64_tr_b16 a[98:99], v253 offset:1024
    v_add_u32 v253, s71, v245
    ds_read_b64_tr_b16 a[100:101], v253 offset:0
    s_waitcnt lgkmcnt(12)
    ds_read_b64_tr_b16 a[102:103], v253 offset:1024
    v_add_u32 v253, s71, v246
    ds_read_b64_tr_b16 a[104:105], v253 offset:0
    ds_read_b64_tr_b16 a[106:107], v253 offset:1024
    v_add_u32 v253, s71, v247
    s_waitcnt lgkmcnt(12)
    ds_read_b64_tr_b16 a[108:109], v253 offset:0
    ds_read_b64_tr_b16 a[110:111], v253 offset:1024
    s_waitcnt lgkmcnt(0)
    s_add_u32 m0, s78, 0
    s_add_u32 s87, s5, 81920
    buffer_load_dwordx4 v4, s[48:51], s87 offen offset:0 lds
    buffer_load_dwordx4 v5, s[48:51], s87 offen offset:1024 lds
    buffer_load_dwordx4 v6, s[48:51], s87 offen offset:2048 lds
    buffer_load_dwordx4 v7, s[48:51], s87 offen offset:3072 lds
    buffer_load_dword v14, v15, s[52:55], s19 offen sc1
    s_waitcnt vmcnt(9)
    s_add_u32 s71, s81, 49152
    v_add_u32 v253, s71, v244
    ds_read_b64_tr_b16 a[160:161], v253 offset:0
    ds_read_b64_tr_b16 a[162:163], v253 offset:1024
    v_add_u32 v253, s71, v245
    ds_read_b64_tr_b16 a[164:165], v253 offset:0
    ds_read_b64_tr_b16 a[166:167], v253 offset:1024
    v_add_u32 v253, s71, v246
    ds_read_b64_tr_b16 a[168:169], v253 offset:0
    ds_read_b64_tr_b16 a[170:171], v253 offset:1024
    v_add_u32 v253, s71, v247
    ds_read_b64_tr_b16 a[172:173], v253 offset:0
    ds_read_b64_tr_b16 a[174:175], v253 offset:1024
    s_add_u32 m0, s81, 16384
    s_add_u32 s87, s6, 81920
    buffer_load_dwordx4 v4, s[48:51], s87 offen offset:0 lds
    buffer_load_dwordx4 v5, s[48:51], s87 offen offset:1024 lds
    buffer_load_dwordx4 v6, s[48:51], s87 offen offset:2048 lds
    buffer_load_dwordx4 v7, s[48:51], s87 offen offset:3072 lds
    s_waitcnt vmcnt(9)
    s_add_u32 s71, s81, 0
    v_add_u32 v253, s71, v244
    ds_read_b64_tr_b16 a[224:225], v253 offset:0
    ds_read_b64_tr_b16 a[226:227], v253 offset:1024
    v_add_u32 v253, s71, v245
    ds_read_b64_tr_b16 a[228:229], v253 offset:0
    ds_read_b64_tr_b16 a[230:231], v253 offset:1024
    v_add_u32 v253, s71, v246
    ds_read_b64_tr_b16 a[232:233], v253 offset:0
    ds_read_b64_tr_b16 a[234:235], v253 offset:1024
    v_add_u32 v253, s71, v247
    ds_read_b64_tr_b16 a[236:237], v253 offset:0
    s_waitcnt lgkmcnt(12)
    ds_read_b64_tr_b16 a[238:239], v253 offset:1024
    s_add_u32 m0, s78, 4096
    s_add_u32 s87, s7, 81920
    buffer_load_dwordx4 v4, s[48:51], s87 offen offset:0 lds
    buffer_load_dwordx4 v5, s[48:51], s87 offen offset:1024 lds
    buffer_load_dwordx4 v6, s[48:51], s87 offen offset:2048 lds
    buffer_load_dwordx4 v7, s[48:51], s87 offen offset:3072 lds
    s_lshl_b32 s72, s12, 18
    s_add_u32 s72, s72, s16
    s_add_u32 s88, s72, s8
    s_add_u32 s89, s72, s9
    s_add_u32 s90, s72, s10
    s_add_u32 s91, s72, s11
    s_mov_b32 s85, 0
    s_waitcnt vmcnt(8)
L_pollo:
    v_cmp_ne_u32 vcc, s84, v14
    s_add_u32 s85, s85, 1
    s_cmp_gt_u32 s85, 100000
    s_cbranch_scc1 L_pollo_done
    s_nop 1
    s_cbranch_vccz L_pollo_done
    buffer_load_dword v14, v15, s[52:55], s19 offen sc1
    s_waitcnt vmcnt(0)
    s_branch L_pollo
L_pollo_done:
    v_mov_b32 v15, v241
    buffer_load_dwordx4 v[128:131], v15, s[52:55], s88 offen offset:0 sc1
    buffer_load_dwordx4 v[132:135], v15, s[52:55], s88 offen offset:512 sc1
    buffer_load_dwordx4 v[136:139], v15, s[52:55], s88 offen offset:2048 sc1
    buffer_load_dwordx4 v[140:143], v15, s[52:55], s88 offen offset:2560 sc1
    buffer_load_dwordx4 v[144:147], v15, s[52:55], s89 offen offset:0 sc1
    buffer_load_dwordx4 v[160:163], v15, s[52:55], s90 offen offset:0 sc1
    buffer_load_dwordx4 v[176:179], v15, s[52:55], s91 offen offset:0 sc1
    buffer_load_dwordx4 v[148:151], v15, s[52:55], s89 offen offset:512 sc1
    s_add_u32 s71, s78, 0
    v_add_u32 v253, s71, v244
    ds_read_b64_tr_b16 a[112:113], v253 offset:0
    ds_read_b64_tr_b16 a[114:115], v253 offset:1024
    v_add_u32 v253, s71, v245
    s_waitcnt lgkmcnt(12)
    ds_read_b64_tr_b16 a[116:117], v253 offset:0
    ds_read_b64_tr_b16 a[118:119], v253 offset:1024
    v_add_u32 v253, s71, v246
    ds_read_b64_tr_b16 a[120:121], v253 offset:0
    s_waitcnt lgkmcnt(12)
    ds_read_b64_tr_b16 a[122:123], v253 offset:1024
    v_add_u32 v253, s71, v247
    ds_read_b64_tr_b16 a[124:125], v253 offset:0
    ds_read_b64_tr_b16 a[126:127], v253 offset:1024
    s_waitcnt vmcnt(12)
    s_add_u32 s71, s81, 16384
    v_add_u32 v253, s71, v244
    s_waitcnt lgkmcnt(12)
    ds_read_b64_tr_b16 a[176:177], v253 offset:0
    ds_read_b64_tr_b16 a[178:179], v253 offset:1024
    v_add_u32 v253, s71, v245
    ds_read_b64_tr_b16 a[180:181], v253 offset:0
    s_waitcnt lgkmcnt(12)
    ds_read_b64_tr_b16 a[182:183], v253 offset:1024
    v_add_u32 v253, s71, v246
    ds_read_b64_tr_b16 a[184:185], v253 offset:0
    ds_read_b64_tr_b16 a[186:187], v253 offset:1024
    v_add_u32 v253, s71, v247
    s_waitcnt lgkmcnt(12)
    ds_read_b64_tr_b16 a[188:189], v253 offset:0
    ds_read_b64_tr_b16 a[190:191], v253 offset:1024
    s_waitcnt vmcnt(8)
    s_add_u32 s71, s78, 4096
    v_add_u32 v253, s71, v244
    ds_read_b64_tr_b16 a[240:241], v253 offset:0
    s_waitcnt lgkmcnt(12)
    ds_read_b64_tr_b16 a[242:243], v253 offset:1024
    v_add_u32 v253, s71, v245
    ds_read_b64_tr_b16 a[244:245], v253 offset:0
    ds_read_b64_tr_b16 a[246:247], v253 offset:1024
    v_add_u32 v253, s71, v246
    s_waitcnt lgkmcnt(12)
    ds_read_b64_tr_b16 a[248:249], v253 offset:0
    ds_read_b64_tr_b16 a[250:251], v253 offset:1024
    v_add_u32 v253, s71, v247
    ds_read_b64_tr_b16 a[252:253], v253 offset:0
    s_waitcnt lgkmcnt(12)
    ds_read_b64_tr_b16 a[254:255], v253 offset:1024
    s_mov_b32 s94, 0x0c0c0c0c
    s_mov_b32 s86, 0
    s_add_u32 s95, s82, 131072
    v_add_u32 v14, s95, v2
    s_mov_b32 s96, 0x00010001
    s_mov_b32 s97, 0x07060302
    s_waitcnt vmcnt(7)
    v_mfma_f32_32x32x16_bf16 v[32:47], a[4:7], v[128:131], 0
    buffer_load_dwordx4 v[164:167], v15, s[52:55], s90 offen offset:512 sc1
    v_mfma_f32_32x32x16_bf16 v[48:63], a[8:11], v[128:131], 0
    s_waitcnt vmcnt(7)
    v_mfma_f32_32x32x16_bf16 v[32:47], a[20:23], v[132:135], v[32:47]
    buffer_load_dwordx4 v[180:183], v15, s[52:55], s91 offen offset:512 sc1
    v_mfma_f32_32x32x16_bf16 v[48:63], a[24:27], v[132:135], v[48:63]
    s_waitcnt vmcnt(7)
    v_mfma_f32_32x32x16_bf16 v[32:47], a[36:39], v[136:139], v[32:47]
    buffer_load_dwordx4 v[152:155], v15, s[52:55], s89 offen offset:2048 sc1
    v_mfma_f32_32x32x16_bf16 v[48:63], a[40:43], v[136:139], v[48:63]
    s_waitcnt vmcnt(7)
    v_mfma_f32_32x32x16_bf16 v[32:47], a[52:55], v[140:143], v[32:47]
    buffer_load_dwordx4 v[168:171], v15, s[52:55], s90 offen offset:2048 sc1
    v_mfma_f32_32x32x16_bf16 v[48:63], a[56:59], v[140:143], v[48:63]
    s_waitcnt vmcnt(7)
    v_mfma_f32_32x32x16_bf16 v[32:47], a[68:71], v[144:147], v[32:47]
    buffer_load_dwordx4 v[184:187], v15, s[52:55], s91 offen offset:2048 sc1
    v_mfma_f32_32x32x16_bf16 v[48:63], a[72:75], v[144:147], v[48:63]
    s_waitcnt vmcnt(7)
    v_mfma_f32_32x32x16_bf16 v[32:47], a[132:135], v[160:163], v[32:47]
    buffer_load_dwordx4 v[156:159], v15, s[52:55], s89 offen offset:2560 sc1
    v_mfma_f32_32x32x16_bf16 v[48:63], a[136:139], v[160:163], v[48:63]
    s_waitcnt vmcnt(7)
    v_mfma_f32_32x32x16_bf16 v[32:47], a[196:199], v[176:179], v[32:47]
    buffer_load_dwordx4 v[172:175], v15, s[52:55], s90 offen offset:2560 sc1
    v_mfma_f32_32x32x16_bf16 v[48:63], a[200:203], v[176:179], v[48:63]
    s_waitcnt vmcnt(7)
    v_mfma_f32_32x32x16_bf16 v[32:47], a[84:87], v[148:151], v[32:47]
    buffer_load_dwordx4 v[188:191], v15, s[52:55], s91 offen offset:2560 sc1
    v_mfma_f32_32x32x16_bf16 v[48:63], a[88:91], v[148:151], v[48:63]
    s_waitcnt vmcnt(7)
    v_mfma_f32_32x32x16_bf16 v[32:47], a[148:151], v[164:167], v[32:47]
    s_lshl_b32 s72, s13, 18
    s_add_u32 s72, s72, s16
    s_add_u32 s88, s72, s8
    s_add_u32 s89, s72, s9
    s_add_u32 s90, s72, s10
    s_add_u32 s91, s72, s11
    v_mfma_f32_32x32x16_bf16 v[48:63], a[152:155], v[164:167], v[48:63]
    buffer_load_dwordx4 v[192:195], v15, s[52:55], s88 offen offset:0 sc1
    s_waitcnt vmcnt(7)
    v_mfma_f32_32x32x16_bf16 v[32:47], a[212:215], v[180:183], v[32:47]
    v_mfma_f32_32x32x16_bf16 v[48:63], a[216:219], v[180:183], v[48:63]
    buffer_load_dwordx4 v[196:199], v15, s[52:55], s88 offen offset:512 sc1
    s_waitcnt vmcnt(7)
    v_mfma_f32_32x32x16_bf16 v[32:47], a[100:103], v[152:155], v[32:47]
    v_mfma_f32_32x32x16_bf16 v[48:63], a[104:107], v[152:155], v[48:63]
    buffer_load_dwordx4 v[200:203], v15, s[52:55], s88 offen offset:2048 sc1
    s_waitcnt vmcnt(7)
    v_mfma_f32_32x32x16_bf16 v[32:47], a[164:167], v[168:171], v[32:47]
    v_mfma_f32_32x32x16_bf16 v[48:63], a[168:171], v[168:171], v[48:63]
    buffer_load_dwordx4 v[204:207], v15, s[52:55], s88 offen offset:2560 sc1
    s_waitcnt vmcnt(7)
    v_mfma_f32_32x32x16_bf16 v[32:47], a[228:231], v[184:187], v[32:47]
    v_mfma_f32_32x32x16_bf16 v[48:63], a[232:235], v[184:187], v[48:63]
    buffer_load_dwordx4 v[208:211], v15, s[52:55], s89 offen offset:0 sc1
    s_waitcnt vmcnt(7)
    v_mfma_f32_32x32x16_bf16 v[32:47], a[116:119], v[156:159], v[32:47]
    v_mfma_f32_32x32x16_bf16 v[48:63], a[120:123], v[156:159], v[48:63]
    buffer_load_dwordx4 v[212:215], v15, s[52:55], s89 offen offset:512 sc1
    s_waitcnt vmcnt(7)
    s_waitcnt lgkmcnt(8)
    v_mfma_f32_32x32x16_bf16 v[32:47], a[180:183], v[172:175], v[32:47]
    v_mfma_f32_32x32x16_bf16 v[48:63], a[184:187], v[172:175], v[48:63]
    buffer_load_dwordx4 v[216:219], v15, s[52:55], s89 offen offset:2048 sc1
    s_waitcnt vmcnt(7)
    s_waitcnt lgkmcnt(0)
    v_mfma_f32_32x32x16_bf16 v[32:47], a[244:247], v[188:191], v[32:47]
    v_mfma_f32_32x32x16_bf16 v[48:63], a[248:251], v[188:191], v[48:63]
    buffer_load_dwordx4 v[220:223], v15, s[52:55], s89 offen offset:2560 sc1
    v_mfma_f32_32x32x16_bf16 v[64:79], a[12:15], v[128:131], 0
    s_barrier
    v_mfma_f32_32x32x16_bf16 v[64:79], a[28:31], v[132:135], v[64:79]
    buffer_load_dwordx4 v[224:227], v15, s[52:55], s90 offen offset:0 sc1
    v_and_b32 v4, 3, v0
    v_lshlrev_b32 v4, 2, v4
    v_lshrrev_b32 v4, v4, v13
    s_nop 0
    v_mfma_f32_32x32x16_bf16 v[64:79], a[44:47], v[136:139], v[64:79]
    v_lshrrev_b32 v5, 1, v4
    v_lshrrev_b32 v6, 2, v4
    v_lshrrev_b32 v7, 3, v4
    v_mfma_f32_32x32x16_bf16 v[64:79], a[60:63], v[140:143], v[64:79]
    buffer_load_dwordx4 v[228:231], v15, s[52:55], s90 offen offset:512 sc1
    v_mfma_f32_32x32x16_bf16 v[64:79], a[76:79], v[144:147], v[64:79]
    ds_write_b128 v8, v[32:35] offset:0
    v_mfma_f32_32x32x16_bf16 v[64:79], a[140:143], v[160:163], v[64:79]
    buffer_load_dwordx4 v[232:235], v15, s[52:55], s90 offen offset:2048 sc1
    ds_write_b128 v8, v[36:39] offset:1024
    v_mfma_f32_32x32x16_bf16 v[64:79], a[204:207], v[176:179], v[64:79]
    v_mfma_f32_32x32x16_bf16 v[64:79], a[92:95], v[148:151], v[64:79]
    buffer_load_dwordx4 v[236:239], v15, s[52:55], s90 offen offset:2560 sc1
    ds_write_b128 v8, v[40:43] offset:2048
    v_mfma_f32_32x32x16_bf16 v[64:79], a[156:159], v[164:167], v[64:79]
    ds_write_b128 v8, v[44:47] offset:3072
    v_mfma_f32_32x32x16_bf16 v[64:79], a[220:223], v[180:183], v[64:79]
    buffer_load_dwordx4 v[240:243], v15, s[52:55], s91 offen offset:0 sc1
    v_mfma_f32_32x32x16_bf16 v[64:79], a[108:111], v[152:155], v[64:79]
    ds_write_b128 v9, v[48:51] offset:0
    v_mfma_f32_32x32x16_bf16 v[64:79], a[172:175], v[168:171], v[64:79]
    buffer_load_dwordx4 v[244:247], v15, s[52:55], s91 offen offset:512 sc1
    ds_write_b128 v9, v[52:55] offset:1024
    v_mfma_f32_32x32x16_bf16 v[64:79], a[236:239], v[184:187], v[64:79]
    v_mfma_f32_32x32x16_bf16 v[64:79], a[124:127], v[156:159], v[64:79]
    buffer_load_dwordx4 v[248:251], v15, s[52:55], s91 offen offset:2048 sc1
    ds_write_b128 v9, v[56:59] offset:2048
    v_mfma_f32_32x32x16_bf16 v[64:79], a[188:191], v[172:175], v[64:79]
    ds_write_b128 v9, v[60:63] offset:3072
    v_mfma_f32_32x32x16_bf16 v[64:79], a[252:255], v[188:191], v[64:79]
    buffer_load_dwordx4 v[252:255], v15, s[52:55], s91 offen offset:2560 sc1
    v_mfma_f32_32x32x16_bf16 v[16:31], a[0:3], v[128:131], 0
    s_nop 3
    v_mfma_f32_32x32x16_bf16 v[16:31], a[16:19], v[132:135], v[16:31]
    s_nop 4
    v_mfma_f32_32x32x16_bf16 v[16:31], a[32:35], v[136:139], v[16:31]
    ds_write_b128 v10, v[64:67] offset:0
    v_mfma_f32_32x32x16_bf16 v[16:31], a[48:51], v[140:143], v[16:31]
    v_mfma_f32_32x32x16_bf16 v[16:31], a[64:67], v[144:147], v[16:31]
    ds_write_b128 v10, v[68:71] offset:1024
    v_mfma_f32_32x32x16_bf16 v[16:31], a[128:131], v[160:163], v[16:31]
    v_mfma_f32_32x32x16_bf16 v[16:31], a[192:195], v[176:179], v[16:31]
    ds_write_b128 v10, v[72:75] offset:2048
    v_mfma_f32_32x32x16_bf16 v[16:31], a[80:83], v[148:151], v[16:31]
    v_mfma_f32_32x32x16_bf16 v[16:31], a[144:147], v[164:167], v[16:31]
    ds_write_b128 v10, v[76:79] offset:3072
    v_mfma_f32_32x32x16_bf16 v[16:31], a[208:211], v[180:183], v[16:31]
    v_mfma_f32_32x32x16_bf16 v[16:31], a[96:99], v[152:155], v[16:31]
    s_waitcnt lgkmcnt(0)
    s_barrier
    ds_read_b128 v[80:83], v3 offset:0
    ds_read_b128 v[96:99], v3 offset:4096
    v_mfma_f32_32x32x16_bf16 v[16:31], a[160:163], v[168:171], v[16:31]
    ds_read_b128 v[112:115], v3 offset:8192
    ds_read_b128 v[84:87], v3 offset:1024
    v_mfma_f32_32x32x16_bf16 v[16:31], a[224:227], v[184:187], v[16:31]
    ds_read_b128 v[100:103], v3 offset:5120
    ds_read_b128 v[116:119], v3 offset:9216
    v_mfma_f32_32x32x16_bf16 v[16:31], a[112:115], v[156:159], v[16:31]
    ds_read_b128 v[88:91], v3 offset:2048
    ds_read_b128 v[104:107], v3 offset:6144
    v_mfma_f32_32x32x16_bf16 v[16:31], a[176:179], v[172:175], v[16:31]
    ds_read_b128 v[120:123], v3 offset:10240
    ds_read_b128 v[92:95], v3 offset:3072
    v_mfma_f32_32x32x16_bf16 v[16:31], a[240:243], v[188:191], v[16:31]
    ds_read_b128 v[108:111], v3 offset:7168
    ds_read_b128 v[124:127], v3 offset:11264
    s_waitcnt vmcnt(15)
    v_mfma_f32_32x32x16_bf16 v[32:47], a[4:7], v[192:195], 0
    v_mfma_f32_32x32x16_bf16 v[48:63], a[8:11], v[192:195], 0
    s_lshl_b32 s72, s14, 18
    s_add_u32 s72, s72, s16
    s_add_u32 s88, s72, s8
    s_add_u32 s89, s72, s9
    s_add_u32 s90, s72, s10
    s_add_u32 s91, s72, s11
    s_waitcnt lgkmcnt(10)
    v_add_f32 v80, v80, v96
    v_add_f32 v81, v81, v97
    v_add_f32 v82, v82, v98
    v_add_f32 v83, v83, v99
    s_waitcnt vmcnt(14)
    v_mfma_f32_32x32x16_bf16 v[32:47], a[20:23], v[196:199], v[32:47]
    buffer_load_dwordx4 v[128:131], v15, s[52:55], s88 offen offset:0 sc1
    v_mfma_f32_32x32x16_bf16 v[48:63], a[24:27], v[196:199], v[48:63]
    s_waitcnt lgkmcnt(9)
    v_add_f32 v80, v80, v112
    v_add_f32 v81, v81, v113
    v_add_f32 v82, v82, v114
    v_add_f32 v83, v83, v115
    s_waitcnt vmcnt(14)
    v_mfma_f32_32x32x16_bf16 v[32:47], a[36:39], v[200:203], v[32:47]
    buffer_load_dwordx4 v[132:135], v15, s[52:55], s88 offen offset:512 sc1
    v_mfma_f32_32x32x16_bf16 v[48:63], a[40:43], v[200:203], v[48:63]
    s_waitcnt lgkmcnt(7)
    v_add_f32 v84, v84, v100
    v_add_f32 v85, v85, v101
    v_add_f32 v86, v86, v102
    v_add_f32 v87, v87, v103
    s_waitcnt vmcnt(14)
    v_mfma_f32_32x32x16_bf16 v[32:47], a[52:55], v[204:207], v[32:47]
    buffer_load_dwordx4 v[136:139], v15, s[52:55], s88 offen offset:2048 sc1
    v_mfma_f32_32x32x16_bf16 v[48:63], a[56:59], v[204:207], v[48:63]
    s_waitcnt lgkmcnt(6)
    v_add_f32 v84, v84, v116
    v_add_f32 v85, v85, v117
    v_add_f32 v86, v86, v118
    v_add_f32 v87, v87, v119
    s_waitcnt vmcnt(14)
    v_mfma_f32_32x32x16_bf16 v[32:47], a[68:71], v[208:211], v[32:47]
    buffer_load_dwordx4 v[140:143], v15, s[52:55], s88 offen offset:2560 sc1
    v_mfma_f32_32x32x16_bf16 v[48:63], a[72:75], v[208:211], v[48:63]
    s_waitcnt lgkmcnt(4)
    v_add_f32 v88, v88, v104
    v_add_f32 v89, v89, v105
    v_add_f32 v90, v90, v106
    v_add_f32 v91, v91, v107
    s_waitcnt vmcnt(14)
    v_mfma_f32_32x32x16_bf16 v[32:47], a[84:87], v[212:215], v[32:47]
    buffer_load_dwordx4 v[144:147], v15, s[52:55], s89 offen offset:0 sc1
    v_mfma_f32_32x32x16_bf16 v[48:63], a[88:91], v[212:215], v[48:63]
    s_waitcnt lgkmcnt(3)
    v_add_f32 v88, v88, v120
    v_add_f32 v89, v89, v121
    v_add_f32 v90, v90, v122
    v_add_f32 v91, v91, v123
    s_waitcnt vmcnt(14)
    v_mfma_f32_32x32x16_bf16 v[32:47], a[100:103], v[216:219], v[32:47]
    buffer_load_dwordx4 v[148:151], v15, s[52:55], s89 offen offset:512 sc1
    v_mfma_f32_32x32x16_bf16 v[48:63], a[104:107], v[216:219], v[48:63]
    s_waitcnt lgkmcnt(1)
    v_add_f32 v92, v92, v108
    v_add_f32 v93, v93, v109
    v_add_f32 v94, v94, v110
    v_add_f32 v95, v95, v111
    s_waitcnt vmcnt(14)
    v_mfma_f32_32x32x16_bf16 v[32:47], a[116:119], v[220:223], v[32:47]
    buffer_load_dwordx4 v[152:155], v15, s[52:55], s89 offen offset:2048 sc1
    v_mfma_f32_32x32x16_bf16 v[48:63], a[120:123], v[220:223], v[48:63]
    s_waitcnt lgkmcnt(0)
    v_add_f32 v92, v92, v124
    v_add_f32 v93, v93, v125
    v_add_f32 v94, v94, v126
    v_add_f32 v95, v95, v127
    s_waitcnt vmcnt(14)
    v_mfma_f32_32x32x16_bf16 v[32:47], a[132:135], v[224:227], v[32:47]
    buffer_load_dwordx4 v[156:159], v15, s[52:55], s89 offen offset:2560 sc1
    v_mfma_f32_32x32x16_bf16 v[48:63], a[136:139], v[224:227], v[48:63]
    v_add_f32 v80, v80, v16
    v_add_f32 v81, v81, v17
    v_add_f32 v82, v82, v18
    v_add_f32 v83, v83, v19
    s_waitcnt vmcnt(14)
    v_mfma_f32_32x32x16_bf16 v[32:47], a[148:151], v[228:231], v[32:47]
    buffer_load_dwordx4 v[160:163], v15, s[52:55], s90 offen offset:0 sc1
    v_mfma_f32_32x32x16_bf16 v[48:63], a[152:155], v[228:231], v[48:63]
    v_add_f32 v84, v84, v20
    v_add_f32 v85, v85, v21
    v_add_f32 v86, v86, v22
    v_add_f32 v87, v87, v23
    s_waitcnt vmcnt(14)
    v_mfma_f32_32x32x16_bf16 v[32:47], a[164:167], v[232:235], v[32:47]
    buffer_load_dwordx4 v[164:167], v15, s[52:55], s90 offen offset:512 sc1
    v_mfma_f32_32x32x16_bf16 v[48:63], a[168:171], v[232:235], v[48:63]
    v_add_f32 v88, v88, v24
    v_add_f32 v89, v89, v25
    v_add_f32 v90, v90, v26
    v_add_f32 v91, v91, v27
    s_waitcnt vmcnt(14)
    v_mfma_f32_32x32x16_bf16 v[32:47], a[180:183], v[236:239], v[32:47]
    buffer_load_dwordx4 v[168:171], v15, s[52:55], s90 offen offset:2048 sc1
    v_mfma_f32_32x32x16_bf16 v[48:63], a[184:187], v[236:239], v[48:63]
    v_add_f32 v92, v92, v28
    v_add_f32 v93, v93, v29
    v_add_f32 v94, v94, v30
    v_add_f32 v95, v95, v31
    s_waitcnt vmcnt(14)
    v_mfma_f32_32x32x16_bf16 v[32:47], a[196:199], v[240:243], v[32:47]
    buffer_load_dwordx4 v[172:175], v15, s[52:55], s90 offen offset:2560 sc1
    v_mfma_f32_32x32x16_bf16 v[48:63], a[200:203], v[240:243], v[48:63]
    v_perm_b32 v96, v81, v80, s97
    v_perm_b32 v97, v83, v82, s97
    v_perm_b32 v98, v85, v84, s97
    v_perm_b32 v99, v87, v86, s97
    s_waitcnt vmcnt(14)
    v_mfma_f32_32x32x16_bf16 v[32:47], a[212:215], v[244:247], v[32:47]
    buffer_load_dwordx4 v[176:179], v15, s[52:55], s91 offen offset:0 sc1
    v_mfma_f32_32x32x16_bf16 v[48:63], a[216:219], v[244:247], v[48:63]
    v_bfi_b32 v96, s96, v4, v96
    v_bfi_b32 v97, s96, v5, v97
    v_bfi_b32 v98, s96, v6, v98
    v_bfi_b32 v99, s96, v7, v99
    s_waitcnt vmcnt(14)
    v_mfma_f32_32x32x16_bf16 v[32:47], a[228:231], v[248:251], v[32:47]
    buffer_load_dwordx4 v[180:183], v15, s[52:55], s91 offen offset:512 sc1
    v_mfma_f32_32x32x16_bf16 v[48:63], a[232:235], v[248:251], v[48:63]
    v_perm_b32 v100, v89, v88, s97
    v_perm_b32 v101, v91, v90, s97
    v_perm_b32 v102, v93, v92, s97
    v_perm_b32 v103, v95, v94, s97
    s_waitcnt vmcnt(14)
    v_mfma_f32_32x32x16_bf16 v[32:47], a[244:247], v[252:255], v[32:47]
    buffer_load_dwordx4 v[184:187], v15, s[52:55], s91 offen offset:2048 sc1
    v_mfma_f32_32x32x16_bf16 v[48:63], a[248:251], v[252:255], v[48:63]
    v_bfi_b32 v100, s96, v4, v100
    v_bfi_b32 v101, s96, v5, v101
    v_bfi_b32 v102, s96, v6, v102
    v_bfi_b32 v103, s96, v7, v103
    v_mfma_f32_32x32x16_bf16 v[64:79], a[12:15], v[192:195], 0
    buffer_load_dwordx4 v[188:191], v15, s[52:55], s91 offen offset:2560 sc1
    v_mfma_f32_32x32x16_bf16 v[64:79], a[28:31], v[196:199], v[64:79]
    s_lshl_b32 s72, s15, 18
    s_add_u32 s72, s72, s16
    s_add_u32 s88, s72, s8
    s_add_u32 s89, s72, s9
    s_add_u32 s90, s72, s10
    s_add_u32 s91, s72, s11
    v_mfma_f32_32x32x16_bf16 v[64:79], a[44:47], v[200:203], v[64:79]
    s_lshl_b32 s73, s12, 15
    s_add_u32 s73, s73, s17
    buffer_store_dwordx4 v[96:99], v2, s[52:55], s73 offen offset:0 sc1
    v_mfma_f32_32x32x16_bf16 v[64:79], a[60:63], v[204:207], v[64:79]
    buffer_store_dwordx4 v[100:103], v2, s[52:55], s73 offen offset:1024 sc1
    v_mfma_f32_32x32x16_bf16 v[64:79], a[76:79], v[208:211], v[64:79]
    ds_write_b128 v8, v[32:35] offset:49152
    v_mfma_f32_32x32x16_bf16 v[64:79], a[92:95], v[212:215], v[64:79]
    ds_write_b128 v8, v[36:39] offset:50176
    v_mfma_f32_32x32x16_bf16 v[64:79], a[108:111], v[216:219], v[64:79]
    v_mfma_f32_32x32x16_bf16 v[64:79], a[124:127], v[220:223], v[64:79]
    ds_write_b128 v8, v[40:43] offset:51200
    v_mfma_f32_32x32x16_bf16 v[64:79], a[140:143], v[224:227], v[64:79]
    ds_write_b128 v8, v[44:47] offset:52224
    v_mfma_f32_32x32x16_bf16 v[64:79], a[156:159], v[228:231], v[64:79]
    v_mfma_f32_32x32x16_bf16 v[64:79], a[172:175], v[232:235], v[64:79]
    ds_write_b128 v9, v[48:51] offset:49152
    v_mfma_f32_32x32x16_bf16 v[64:79], a[188:191], v[236:239], v[64:79]
    ds_write_b128 v9, v[52:55] offset:50176
    v_mfma_f32_32x32x16_bf16 v[64:79], a[204:207], v[240:243], v[64:79]
    v_mfma_f32_32x32x16_bf16 v[64:79], a[220:223], v[244:247], v[64:79]
    ds_write_b128 v9, v[56:59] offset:51200
    v_mfma_f32_32x32x16_bf16 v[64:79], a[236:239], v[248:251], v[64:79]
    ds_write_b128 v9, v[60:63] offset:52224
    v_mfma_f32_32x32x16_bf16 v[64:79], a[252:255], v[252:255], v[64:79]
    v_mfma_f32_32x32x16_bf16 v[16:31], a[0:3], v[192:195], 0
    s_nop 3
    v_mfma_f32_32x32x16_bf16 v[16:31], a[16:19], v[196:199], v[16:31]
    s_nop 4
    v_mfma_f32_32x32x16_bf16 v[16:31], a[32:35], v[200:203], v[16:31]
    ds_write_b128 v10, v[64:67] offset:49152
    v_mfma_f32_32x32x16_bf16 v[16:31], a[48:51], v[204:207], v[16:31]
    v_mfma_f32_32x32x16_bf16 v[16:31], a[64:67], v[208:211], v[16:31]
    ds_write_b128 v10, v[68:71] offset:50176
    v_mfma_f32_32x32x16_bf16 v[16:31], a[80:83], v[212:215], v[16:31]
    v_mfma_f32_32x32x16_bf16 v[16:31], a[96:99], v[216:219], v[16:31]
    ds_write_b128 v10, v[72:75] offset:51200
    v_mfma_f32_32x32x16_bf16 v[16:31], a[112:115], v[220:223], v[16:31]
    v_mfma_f32_32x32x16_bf16 v[16:31], a[128:131], v[224:227], v[16:31]
    ds_write_b128 v10, v[76:79] offset:52224
    v_mfma_f32_32x32x16_bf16 v[16:31], a[144:147], v[228:231], v[16:31]
    v_mfma_f32_32x32x16_bf16 v[16:31], a[160:163], v[232:235], v[16:31]
    s_waitcnt lgkmcnt(0)
    s_barrier
    ds_read_b128 v[80:83], v3 offset:49152
    ds_read_b128 v[96:99], v3 offset:53248
    v_mfma_f32_32x32x16_bf16 v[16:31], a[176:179], v[236:239], v[16:31]
    ds_read_b128 v[112:115], v3 offset:57344
    ds_read_b128 v[84:87], v3 offset:50176
    v_mfma_f32_32x32x16_bf16 v[16:31], a[192:195], v[240:243], v[16:31]
    ds_read_b128 v[100:103], v3 offset:54272
    ds_read_b128 v[116:119], v3 offset:58368
    v_mfma_f32_32x32x16_bf16 v[16:31], a[208:211], v[244:247], v[16:31]
    ds_read_b128 v[88:91], v3 offset:51200
    ds_read_b128 v[104:107], v3 offset:55296
    v_mfma_f32_32x32x16_bf16 v[16:31], a[224:227], v[248:251], v[16:31]
    ds_read_b128 v[120:123], v3 offset:59392
    ds_read_b128 v[92:95], v3 offset:52224
    v_mfma_f32_32x32x16_bf16 v[16:31], a[240:243], v[252:255], v[16:31]
    ds_read_b128 v[108:111], v3 offset:56320
    ds_read_b128 v[124:127], v3 offset:60416
    s_waitcnt vmcnt(2)
    v_mfma_f32_32x32x16_bf16 v[32:47], a[4:7], v[128:131], 0
    buffer_load_dwordx4 v[192:195], v15, s[52:55], s88 offen offset:0 sc1
    v_mfma_f32_32x32x16_bf16 v[32:47], a[20:23], v[132:135], v[32:47]
    s_waitcnt lgkmcnt(10)
    v_add_f32 v80, v80, v96
    v_add_f32 v81, v81, v97
    v_add_f32 v82, v82, v98
    v_add_f32 v83, v83, v99
    v_mfma_f32_32x32x16_bf16 v[32:47], a[36:39], v[136:139], v[32:47]
    buffer_load_dwordx4 v[196:199], v15, s[52:55], s88 offen offset:512 sc1
    v_mfma_f32_32x32x16_bf16 v[32:47], a[52:55], v[140:143], v[32:47]
    s_waitcnt lgkmcnt(9)
    v_add_f32 v80, v80, v112
    v_add_f32 v81, v81, v113
    v_add_f32 v82, v82, v114
    v_add_f32 v83, v83, v115
    v_mfma_f32_32x32x16_bf16 v[32:47], a[68:71], v[144:147], v[32:47]
    buffer_load_dwordx4 v[200:203], v15, s[52:55], s88 offen offset:2048 sc1
    v_mfma_f32_32x32x16_bf16 v[32:47], a[84:87], v[148:151], v[32:47]
    s_waitcnt lgkmcnt(7)
    v_add_f32 v84, v84, v100
    v_add_f32 v85, v85, v101
    v_add_f32 v86, v86, v102
    v_add_f32 v87, v87, v103
    v_mfma_f32_32x32x16_bf16 v[32:47], a[100:103], v[152:155], v[32:47]
    buffer_load_dwordx4 v[204:207], v15, s[52:55], s88 offen offset:2560 sc1
    v_mfma_f32_32x32x16_bf16 v[32:47], a[116:119], v[156:159], v[32:47]
    s_waitcnt lgkmcnt(6)
    v_add_f32 v84, v84, v116
    v_add_f32 v85, v85, v117
    v_add_f32 v86, v86, v118
    v_add_f32 v87, v87, v119
    v_mfma_f32_32x32x16_bf16 v[32:47], a[132:135], v[160:163], v[32:47]
    buffer_load_dwordx4 v[208:211], v15, s[52:55], s89 offen offset:0 sc1
    v_mfma_f32_32x32x16_bf16 v[32:47], a[148:151], v[164:167], v[32:47]
    s_waitcnt lgkmcnt(4)
    v_add_f32 v88, v88, v104
    v_add_f32 v89, v89, v105
    v_add_f32 v90, v90, v106
    v_add_f32 v91, v91, v107
    v_mfma_f32_32x32x16_bf16 v[32:47], a[164:167], v[168:171], v[32:47]
    buffer_load_dwordx4 v[212:215], v15, s[52:55], s89 offen offset:512 sc1
    v_mfma_f32_32x32x16_bf16 v[32:47], a[180:183], v[172:175], v[32:47]
    s_waitcnt lgkmcnt(3)
    v_add_f32 v88, v88, v120
    v_add_f32 v89, v89, v121
    v_add_f32 v90, v90, v122
    v_add_f32 v91, v91, v123
    v_mfma_f32_32x32x16_bf16 v[32:47], a[196:199], v[176:179], v[32:47]
    buffer_load_dwordx4 v[216:219], v15, s[52:55], s89 offen offset:2048 sc1
    v_mfma_f32_32x32x16_bf16 v[32:47], a[212:215], v[180:183], v[32:47]
    s_waitcnt lgkmcnt(1)
    v_add_f32 v92, v92, v108
    v_add_f32 v93, v93, v109
    v_add_f32 v94, v94, v110
    v_add_f32 v95, v95, v111
    v_mfma_f32_32x32x16_bf16 v[32:47], a[228:231], v[184:187], v[32:47]
    buffer_load_dwordx4 v[220:223], v15, s[52:55], s89 offen offset:2560 sc1
    v_mfma_f32_32x32x16_bf16 v[32:47], a[244:247], v[188:191], v[32:47]
    s_waitcnt lgkmcnt(0)
    v_add_f32 v92, v92, v124
    v_add_f32 v93, v93, v125
    v_add_f32 v94, v94, v126
    v_add_f32 v95, v95, v127
    v_mfma_f32_32x32x16_bf16 v[48:63], a[8:11], v[128:131], 0
    buffer_load_dwordx4 v[224:227], v15, s[52:55], s90 offen offset:0 sc1
    v_mfma_f32_32x32x16_bf16 v[48:63], a[24:27], v[132:135], v[48:63]
    v_add_f32 v80, v80, v16
    v_add_f32 v81, v81, v17
    v_add_f32 v82, v82, v18
    v_add_f32 v83, v83, v19
    v_mfma_f32_32x32x16_bf16 v[48:63], a[40:43], v[136:139], v[48:63]
    buffer_load_dwordx4 v[228:231], v15, s[52:55], s90 offen offset:512 sc1
    v_mfma_f32_32x32x16_bf16 v[48:63], a[56:59], v[140:143], v[48:63]
    v_add_f32 v84, v84, v20
    v_add_f32 v85, v85, v21
    v_add_f32 v86, v86, v22
    v_add_f32 v87, v87, v23
    v_mfma_f32_32x32x16_bf16 v[48:63], a[72:75], v[144:147], v[48:63]
    buffer_load_dwordx4 v[232:235], v15, s[52:55], s90 offen offset:2048 sc1
    v_mfma_f32_32x32x16_bf16 v[48:63], a[88:91], v[148:151], v[48:63]
    v_add_f32 v88, v88, v24
    v_add_f32 v89, v89, v25
    v_add_f32 v90, v90, v26
    v_add_f32 v91, v91, v27
    v_mfma_f32_32x32x16_bf16 v[48:63], a[104:107], v[152:155], v[48:63]
    buffer_load_dwordx4 v[236:239], v15, s[52:55], s90 offen offset:2560 sc1
    v_mfma_f32_32x32x16_bf16 v[48:63], a[120:123], v[156:159], v[48:63]
    v_add_f32 v92, v92, v28
    v_add_f32 v93, v93, v29
    v_add_f32 v94, v94, v30
    v_add_f32 v95, v95, v31
    v_mfma_f32_32x32x16_bf16 v[48:63], a[136:139], v[160:163], v[48:63]
    buffer_load_dwordx4 v[240:243], v15, s[52:55], s91 offen offset:0 sc1
    v_mfma_f32_32x32x16_bf16 v[48:63], a[152:155], v[164:167], v[48:63]
    v_perm_b32 v96, v81, v80, s97
    v_perm_b32 v97, v83, v82, s97
    v_perm_b32 v98, v85, v84, s97
    v_perm_b32 v99, v87, v86, s97
    v_mfma_f32_32x32x16_bf16 v[48:63], a[168:171], v[168:171], v[48:63]
    buffer_load_dwordx4 v[244:247], v15, s[52:55], s91 offen offset:512 sc1
    v_mfma_f32_32x32x16_bf16 v[48:63], a[184:187], v[172:175], v[48:63]
    v_bfi_b32 v96, s96, v4, v96
    v_bfi_b32 v97, s96, v5, v97
    v_bfi_b32 v98, s96, v6, v98
    v_bfi_b32 v99, s96, v7, v99
    v_mfma_f32_32x32x16_bf16 v[48:63], a[200:203], v[176:179], v[48:63]
    buffer_load_dwordx4 v[248:251], v15, s[52:55], s91 offen offset:2048 sc1
    v_mfma_f32_32x32x16_bf16 v[48:63], a[216:219], v[180:183], v[48:63]
    v_perm_b32 v100, v89, v88, s97
    v_perm_b32 v101, v91, v90, s97
    v_perm_b32 v102, v93, v92, s97
    v_perm_b32 v103, v95, v94, s97
    v_mfma_f32_32x32x16_bf16 v[48:63], a[232:235], v[184:187], v[48:63]
    buffer_load_dwordx4 v[252:255], v15, s[52:55], s91 offen offset:2560 sc1
    v_mfma_f32_32x32x16_bf16 v[48:63], a[248:251], v[188:191], v[48:63]
    v_bfi_b32 v100, s96, v4, v100
    v_bfi_b32 v101, s96, v5, v101
    v_bfi_b32 v102, s96, v6, v102
    v_bfi_b32 v103, s96, v7, v103
    v_mfma_f32_32x32x16_bf16 v[64:79], a[12:15], v[128:131], 0
    ds_write_b128 v8, v[32:35] offset:0
    v_mfma_f32_32x32x16_bf16 v[64:79], a[28:31], v[132:135], v[64:79]
    s_lshl_b32 s73, s13, 15
    s_add_u32 s73, s73, s17
    buffer_store_dwordx4 v[96:99], v2, s[52:55], s73 offen offset:0 sc1
    v_mfma_f32_32x32x16_bf16 v[64:79], a[44:47], v[136:139], v[64:79]
    ds_write_b128 v8, v[36:39] offset:1024
    v_mfma_f32_32x32x16_bf16 v[64:79], a[60:63], v[140:143], v[64:79]
    buffer_store_dwordx4 v[100:103], v2, s[52:55], s73 offen offset:1024 sc1
    v_mfma_f32_32x32x16_bf16 v[64:79], a[76:79], v[144:147], v[64:79]
    ds_write_b128 v8, v[40:43] offset:2048
    v_mfma_f32_32x32x16_bf16 v[64:79], a[92:95], v[148:151], v[64:79]
    v_mfma_f32_32x32x16_bf16 v[64:79], a[108:111], v[152:155], v[64:79]
    ds_write_b128 v8, v[44:47] offset:3072
    v_mfma_f32_32x32x16_bf16 v[64:79], a[124:127], v[156:159], v[64:79]
    v_mfma_f32_32x32x16_bf16 v[64:79], a[140:143], v[160:163], v[64:79]
    v_mfma_f32_32x32x16_bf16 v[64:79], a[156:159], v[164:167], v[64:79]
    ds_write_b128 v9, v[48:51] offset:0
    v_mfma_f32_32x32x16_bf16 v[64:79], a[172:175], v[168:171], v[64:79]
    v_mfma_f32_32x32x16_bf16 v[64:79], a[188:191], v[172:175], v[64:79]
    ds_write_b128 v9, v[52:55] offset:1024
    v_mfma_f32_32x32x16_bf16 v[64:79], a[204:207], v[176:179], v[64:79]
    s_lshl_b32 s74, s14, 13
    s_mov_b32 m0, s95
    s_add_u32 s74, s74, s21
    buffer_load_dwordx4 v2, s[52:55], s74 offen offset:0 sc1 lds
    v_mfma_f32_32x32x16_bf16 v[64:79], a[220:223], v[180:183], v[64:79]
    ds_write_b128 v9, v[56:59] offset:2048
    v_mfma_f32_32x32x16_bf16 v[64:79], a[236:239], v[184:187], v[64:79]
    buffer_load_dwordx4 v2, s[52:55], s74 offen offset:1024 sc1 lds
    v_mfma_f32_32x32x16_bf16 v[64:79], a[252:255], v[188:191], v[64:79]
    ds_write_b128 v9, v[60:63] offset:3072
    v_mfma_f32_32x32x16_bf16 v[16:31], a[0:3], v[128:131], 0
    s_nop 3
    v_mfma_f32_32x32x16_bf16 v[16:31], a[16:19], v[132:135], v[16:31]
    s_nop 3
    v_mfma_f32_32x32x16_bf16 v[16:31], a[32:35], v[136:139], v[16:31]
    ds_write_b128 v10, v[64:67] offset:0
    v_mfma_f32_32x32x16_bf16 v[16:31], a[48:51], v[140:143], v[16:31]
    ds_write_b128 v10, v[68:71] offset:1024
    v_mfma_f32_32x32x16_bf16 v[16:31], a[64:67], v[144:147], v[16:31]
    ds_write_b128 v10, v[72:75] offset:2048
    v_mfma_f32_32x32x16_bf16 v[16:31], a[80:83], v[148:151], v[16:31]
    ds_write_b128 v10, v[76:79] offset:3072
    v_mfma_f32_32x32x16_bf16 v[16:31], a[96:99], v[152:155], v[16:31]
    v_mfma_f32_32x32x16_bf16 v[16:31], a[112:115], v[156:159], v[16:31]
    s_waitcnt lgkmcnt(0)
    s_barrier
    ds_read_b128 v[80:83], v3 offset:0
    ds_read_b128 v[96:99], v3 offset:4096
    v_mfma_f32_32x32x16_bf16 v[16:31], a[128:131], v[160:163], v[16:31]
    ds_read_b128 v[112:115], v3 offset:8192
    ds_read_b128 v[84:87], v3 offset:1024
    v_mfma_f32_32x32x16_bf16 v[16:31], a[144:147], v[164:167], v[16:31]
    ds_read_b128 v[100:103], v3 offset:5120
    ds_read_b128 v[116:119], v3 offset:9216
    v_mfma_f32_32x32x16_bf16 v[16:31], a[160:163], v[168:171], v[16:31]
    ds_read_b128 v[88:91], v3 offset:2048
    ds_read_b128 v[104:107], v3 offset:6144
    v_mfma_f32_32x32x16_bf16 v[16:31], a[176:179], v[172:175], v[16:31]
    ds_read_b128 v[120:123], v3 offset:10240
    ds_read_b128 v[92:95], v3 offset:3072
    v_mfma_f32_32x32x16_bf16 v[16:31], a[192:195], v[176:179], v[16:31]
    ds_read_b128 v[108:111], v3 offset:7168
    ds_read_b128 v[124:127], v3 offset:11264
    v_mfma_f32_32x32x16_bf16 v[16:31], a[208:211], v[180:183], v[16:31]
    s_waitcnt lgkmcnt(10)
    v_add_f32 v80, v80, v96
    v_add_f32 v81, v81, v97
    v_add_f32 v82, v82, v98
    v_add_f32 v83, v83, v99
    v_mfma_f32_32x32x16_bf16 v[16:31], a[224:227], v[184:187], v[16:31]
    s_waitcnt lgkmcnt(9)
    v_add_f32 v80, v80, v112
    v_add_f32 v81, v81, v113
    v_add_f32 v82, v82, v114
    v_add_f32 v83, v83, v115
    v_mfma_f32_32x32x16_bf16 v[16:31], a[240:243], v[188:191], v[16:31]
    s_waitcnt lgkmcnt(7)
    v_add_f32 v84, v84, v100
    v_add_f32 v85, v85, v101
    v_add_f32 v86, v86, v102
    v_add_f32 v87, v87, v103
    s_waitcnt vmcnt(4)
    v_mfma_f32_32x32x16_bf16 v[32:47], a[4:7], v[192:195], 0
    s_lshl_b32 s74, s13, 13
    s_add_u32 s74, s74, s21
    buffer_load_dwordx4 v[140:143], v2, s[52:55], s74 offen offset:0 sc1
    v_mfma_f32_32x32x16_bf16 v[32:47], a[20:23], v[196:199], v[32:47]
    buffer_load_dwordx4 v[144:147], v2, s[52:55], s74 offen offset:1024 sc1
    v_mfma_f32_32x32x16_bf16 v[32:47], a[36:39], v[200:203], v[32:47]
    s_waitcnt lgkmcnt(6)
    v_add_f32 v84, v84, v116
    v_add_f32 v85, v85, v117
    v_add_f32 v86, v86, v118
    v_add_f32 v87, v87, v119
    v_mfma_f32_32x32x16_bf16 v[32:47], a[52:55], v[204:207], v[32:47]
    s_waitcnt lgkmcnt(4)
    v_add_f32 v88, v88, v104
    v_add_f32 v89, v89, v105
    v_add_f32 v90, v90, v106
    v_add_f32 v91, v91, v107
    v_mfma_f32_32x32x16_bf16 v[32:47], a[68:71], v[208:211], v[32:47]
    s_waitcnt lgkmcnt(3)
    v_add_f32 v88, v88, v120
    v_add_f32 v89, v89, v121
    v_add_f32 v90, v90, v122
    v_add_f32 v91, v91, v123
    v_mfma_f32_32x32x16_bf16 v[32:47], a[84:87], v[212:215], v[32:47]
    s_waitcnt lgkmcnt(1)
    v_add_f32 v92, v92, v108
    v_add_f32 v93, v93, v109
    v_add_f32 v94, v94, v110
    v_add_f32 v95, v95, v111
    v_mfma_f32_32x32x16_bf16 v[32:47], a[100:103], v[216:219], v[32:47]
    s_waitcnt lgkmcnt(0)
    v_add_f32 v92, v92, v124
    v_add_f32 v93, v93, v125
    v_add_f32 v94, v94, v126
    v_add_f32 v95, v95, v127
    v_mfma_f32_32x32x16_bf16 v[32:47], a[116:119], v[220:223], v[32:47]
    v_add_f32 v80, v80, v16
    v_add_f32 v81, v81, v17
    v_add_f32 v82, v82, v18
    v_add_f32 v83, v83, v19
    v_mfma_f32_32x32x16_bf16 v[32:47], a[132:135], v[224:227], v[32:47]
    v_add_f32 v84, v84, v20
    v_add_f32 v85, v85, v21
    v_add_f32 v86, v86, v22
    v_add_f32 v87, v87, v23
    v_mfma_f32_32x32x16_bf16 v[32:47], a[148:151], v[228:231], v[32:47]
    v_add_f32 v88, v88, v24
    v_add_f32 v89, v89, v25
    v_add_f32 v90, v90, v26
    v_add_f32 v91, v91, v27
    v_mfma_f32_32x32x16_bf16 v[32:47], a[164:167], v[232:235], v[32:47]
    v_add_f32 v92, v92, v28
    v_add_f32 v93, v93, v29
    v_add_f32 v94, v94, v30
    v_add_f32 v95, v95, v31
    v_mfma_f32_32x32x16_bf16 v[32:47], a[180:183], v[236:239], v[32:47]
    v_perm_b32 v96, v81, v80, s97
    v_perm_b32 v97, v83, v82, s97
    v_perm_b32 v98, v85, v84, s97
    v_perm_b32 v99, v87, v86, s97
    v_mfma_f32_32x32x16_bf16 v[32:47], a[196:199], v[240:243], v[32:47]
    v_bfi_b32 v96, s96, v4, v96
    v_bfi_b32 v97, s96, v5, v97
    v_bfi_b32 v98, s96, v6, v98
    v_bfi_b32 v99, s96, v7, v99
    v_mfma_f32_32x32x16_bf16 v[32:47], a[212:215], v[244:247], v[32:47]
    s_lshl_b32 s73, s14, 15
    s_add_u32 s73, s73, s17
    buffer_store_dwordx4 v[96:99], v2, s[52:55], s73 offen offset:0 sc1
    v_mfma_f32_32x32x16_bf16 v[32:47], a[228:231], v[248:251], v[32:47]
    v_perm_b32 v100, v89, v88, s97
    v_perm_b32 v101, v91, v90, s97
    v_perm_b32 v102, v93, v92, s97
    v_perm_b32 v103, v95, v94, s97
    s_waitcnt vmcnt(3)
    ds_read_b128 v[152:155], v14 offset:0
    ds_read_b128 v[156:159], v14 offset:1024
    v_mfma_f32_32x32x16_bf16 v[32:47], a[244:247], v[252:255], v[32:47]
    v_bfi_b32 v100, s96, v4, v100
    v_bfi_b32 v101, s96, v5, v101
    v_bfi_b32 v102, s96, v6, v102
    v_bfi_b32 v103, s96, v7, v103
    v_mfma_f32_32x32x16_bf16 v[48:63], a[8:11], v[192:195], 0
    buffer_store_dwordx4 v[100:103], v2, s[52:55], s73 offen offset:1024 sc1
    v_mfma_f32_32x32x16_bf16 v[48:63], a[24:27], v[196:199], v[48:63]
    s_waitcnt lgkmcnt(0)
    v_xor_b32 v12, v4, v152
    v_bitop3_b32 v12, v12, v153, v5 bitop3:0xf6
    v_bitop3_b32 v12, v12, v154, v6 bitop3:0xf6
    v_bitop3_b32 v12, v12, v155, v7 bitop3:0xf6
    v_bitop3_b32 v12, v12, v156, v4 bitop3:0xf6
    v_mfma_f32_32x32x16_bf16 v[48:63], a[40:43], v[200:203], v[48:63]
    v_bitop3_b32 v12, v12, v157, v5 bitop3:0xf6
    v_bitop3_b32 v12, v12, v158, v6 bitop3:0xf6
    v_bitop3_b32 v12, v12, v159, v7 bitop3:0xf6
    v_and_b32 v12, s96, v12
    v_cmp_ne_u32 vcc, 0, v12
    v_mfma_f32_32x32x16_bf16 v[48:63], a[56:59], v[204:207], v[48:63]
    s_cmp_eq_u64 vcc, 0
    s_cselect_b32 s92, 0x01000c0c, s94
    s_cselect_b32 s93, 0x03020c0c, s94
    s_cselect_b32 s75, 4, 0
    s_or_b32 s86, s86, s75
    v_mfma_f32_32x32x16_bf16 v[48:63], a[72:75], v[208:211], v[48:63]
    v_or_b32 v152, s96, v152
    v_or_b32 v153, s96, v153
    v_or_b32 v154, s96, v154
    v_or_b32 v155, s96, v155
    v_mfma_f32_32x32x16_bf16 v[48:63], a[88:91], v[212:215], v[48:63]
    v_or_b32 v156, s96, v156
    v_or_b32 v157, s96, v157
    v_or_b32 v158, s96, v158
    v_or_b32 v159, s96, v159
    v_mfma_f32_32x32x16_bf16 v[48:63], a[104:107], v[216:219], v[48:63]
    v_perm_b32 v172, v152, v152, s92
    v_perm_b32 v173, v152, v152, s93
    v_perm_b32 v174, v153, v153, s92
    v_perm_b32 v175, v153, v153, s93
    v_mfma_f32_32x32x16_bf16 v[48:63], a[120:123], v[220:223], v[48:63]
    v_perm_b32 v176, v154, v154, s92
    v_perm_b32 v177, v154, v154, s93
    v_perm_b32 v178, v155, v155, s92
    v_perm_b32 v179, v155, v155, s93
    v_mfma_f32_32x32x16_bf16 v[48:63], a[136:139], v[224:227], v[48:63]
    v_perm_b32 v180, v156, v156, s92
    v_perm_b32 v181, v156, v156, s93
    v_perm_b32 v182, v157, v157, s92
    v_perm_b32 v183, v157, v157, s93
    v_mfma_f32_32x32x16_bf16 v[48:63], a[152:155], v[228:231], v[48:63]
    v_perm_b32 v184, v158, v158, s92
    v_perm_b32 v185, v158, v158, s93
    v_perm_b32 v186, v159, v159, s92
    v_perm_b32 v187, v159, v159, s93
    v_mfma_f32_32x32x16_bf16 v[48:63], a[168:171], v[232:235], v[48:63]
    v_mfma_f32_32x32x16_bf16 v[48:63], a[184:187], v[236:239], v[48:63]
    v_mfma_f32_32x32x16_bf16 v[48:63], a[200:203], v[240:243], v[48:63]
    s_waitcnt vmcnt(2)
    v_xor_b32 v12, v4, v140
    v_bitop3_b32 v12, v12, v141, v5 bitop3:0xf6
    v_bitop3_b32 v12, v12, v142, v6 bitop3:0xf6
    v_bitop3_b32 v12, v12, v143, v7 bitop3:0xf6
    v_bitop3_b32 v12, v12, v144, v4 bitop3:0xf6
    v_mfma_f32_32x32x16_bf16 v[48:63], a[216:219], v[244:247], v[48:63]
    v_bitop3_b32 v12, v12, v145, v5 bitop3:0xf6
    v_bitop3_b32 v12, v12, v146, v6 bitop3:0xf6
    v_bitop3_b32 v12, v12, v147, v7 bitop3:0xf6
    v_and_b32 v12, s96, v12
    v_cmp_ne_u32 vcc, 0, v12
    v_mfma_f32_32x32x16_bf16 v[48:63], a[232:235], v[248:251], v[48:63]
    s_cmp_eq_u64 vcc, 0
    s_cselect_b32 s92, 0x01000c0c, s94
    s_cselect_b32 s93, 0x03020c0c, s94
    s_cselect_b32 s75, 2, 0
    s_or_b32 s86, s86, s75
    v_mfma_f32_32x32x16_bf16 v[48:63], a[248:251], v[252:255], v[48:63]
    v_or_b32 v140, s96, v140
    v_or_b32 v141, s96, v141
    v_or_b32 v142, s96, v142
    v_or_b32 v143, s96, v143
    v_mfma_f32_32x32x16_bf16 v[64:79], a[12:15], v[192:195], 0
    ds_write_b128 v8, v[32:35] offset:49152
    v_mfma_f32_32x32x16_bf16 v[64:79], a[28:31], v[196:199], v[64:79]
    v_or_b32 v144, s96, v144
    v_or_b32 v145, s96, v145
    v_or_b32 v146, s96, v146
    v_or_b32 v147, s96, v147
    v_mfma_f32_32x32x16_bf16 v[64:79], a[44:47], v[200:203], v[64:79]
    ds_write_b128 v8, v[36:39] offset:50176
    v_mfma_f32_32x32x16_bf16 v[64:79], a[60:63], v[204:207], v[64:79]
    v_perm_b32 v168, v140, v140, s92
    v_perm_b32 v169, v140, v140, s93
    v_add_f32 v172, v172, v168
    v_add_f32 v173, v173, v169
    v_mfma_f32_32x32x16_bf16 v[64:79], a[76:79], v[208:211], v[64:79]
    ds_write_b128 v8, v[40:43] offset:51200
    v_mfma_f32_32x32x16_bf16 v[64:79], a[92:95], v[212:215], v[64:79]
    v_perm_b32 v168, v141, v141, s92
    v_perm_b32 v169, v141, v141, s93
    v_add_f32 v174, v174, v168
    v_add_f32 v175, v175, v169
    v_mfma_f32_32x32x16_bf16 v[64:79], a[108:111], v[216:219], v[64:79]
    ds_write_b128 v8, v[44:47] offset:52224
    v_mfma_f32_32x32x16_bf16 v[64:79], a[124:127], v[220:223], v[64:79]
    v_perm_b32 v168, v142, v142, s92
    v_perm_b32 v169, v142, v142, s93
    v_add_f32 v176, v176, v168
    v_add_f32 v177, v177, v169
    v_mfma_f32_32x32x16_bf16 v[64:79], a[140:143], v[224:227], v[64:79]
    v_perm_b32 v168, v143, v143, s92
    v_perm_b32 v169, v143, v143, s93
    v_add_f32 v178, v178, v168
    v_add_f32 v179, v179, v169
    v_mfma_f32_32x32x16_bf16 v[64:79], a[156:159], v[228:231], v[64:79]
    ds_write_b128 v9, v[48:51] offset:49152
    v_mfma_f32_32x32x16_bf16 v[64:79], a[172:175], v[232:235], v[64:79]
    v_perm_b32 v168, v144, v144, s92
    v_perm_b32 v169, v144, v144, s93
    v_add_f32 v180, v180, v168
    v_add_f32 v181, v181, v169
    v_mfma_f32_32x32x16_bf16 v[64:79], a[188:191], v[236:239], v[64:79]
    ds_write_b128 v9, v[52:55] offset:50176
    v_mfma_f32_32x32x16_bf16 v[64:79], a[204:207], v[240:243], v[64:79]
    v_perm_b32 v168, v145, v145, s92
    v_perm_b32 v169, v145, v145, s93
    v_add_f32 v182, v182, v168
    v_add_f32 v183, v183, v169
    v_mfma_f32_32x32x16_bf16 v[64:79], a[220:223], v[244:247], v[64:79]
    ds_write_b128 v9, v[56:59] offset:51200
    v_mfma_f32_32x32x16_bf16 v[64:79], a[236:239], v[248:251], v[64:79]
    v_perm_b32 v168, v146, v146, s92
    v_perm_b32 v169, v146, v146, s93
    v_add_f32 v184, v184, v168
    v_add_f32 v185, v185, v169
    v_mfma_f32_32x32x16_bf16 v[64:79], a[252:255], v[252:255], v[64:79]
    ds_write_b128 v9, v[60:63] offset:52224
    v_mfma_f32_32x32x16_bf16 v[16:31], a[0:3], v[192:195], 0
    s_nop 3
    v_perm_b32 v168, v147, v147, s92
    v_perm_b32 v169, v147, v147, s93
    v_add_f32 v186, v186, v168
    v_add_f32 v187, v187, v169
    v_mfma_f32_32x32x16_bf16 v[16:31], a[16:19], v[196:199], v[16:31]
    s_nop 3
    v_mfma_f32_32x32x16_bf16 v[16:31], a[32:35], v[200:203], v[16:31]
    ds_write_b128 v10, v[64:67] offset:49152
    v_mfma_f32_32x32x16_bf16 v[16:31], a[48:51], v[204:207], v[16:31]
    ds_write_b128 v10, v[68:71] offset:50176
    v_mfma_f32_32x32x16_bf16 v[16:31], a[64:67], v[208:211], v[16:31]
    ds_write_b128 v10, v[72:75] offset:51200
    v_mfma_f32_32x32x16_bf16 v[16:31], a[80:83], v[212:215], v[16:31]
    ds_write_b128 v10, v[76:79] offset:52224
    v_mfma_f32_32x32x16_bf16 v[16:31], a[96:99], v[216:219], v[16:31]
    v_mfma_f32_32x32x16_bf16 v[16:31], a[112:115], v[220:223], v[16:31]
    s_waitcnt lgkmcnt(0)
    s_barrier
    ds_read_b128 v[80:83], v3 offset:49152
    ds_read_b128 v[96:99], v3 offset:53248
    v_mfma_f32_32x32x16_bf16 v[16:31], a[128:131], v[224:227], v[16:31]
    ds_read_b128 v[112:115], v3 offset:57344
    ds_read_b128 v[84:87], v3 offset:50176
    s_lshl_b32 s74, s12, 13
    s_add_u32 s74, s74, s21
    buffer_load_dwordx4 v[128:131], v2, s[52:55], s74 offen offset:0 sc1
    v_mfma_f32_32x32x16_bf16 v[16:31], a[144:147], v[228:231], v[16:31]
    ds_read_b128 v[100:103], v3 offset:54272
    ds_read_b128 v[116:119], v3 offset:58368
    buffer_load_dwordx4 v[132:135], v2, s[52:55], s74 offen offset:1024 sc1
    v_mfma_f32_32x32x16_bf16 v[16:31], a[160:163], v[232:235], v[16:31]
    ds_read_b128 v[88:91], v3 offset:51200
    ds_read_b128 v[104:107], v3 offset:55296
    v_mfma_f32_32x32x16_bf16 v[16:31], a[176:179], v[236:239], v[16:31]
    ds_read_b128 v[120:123], v3 offset:59392
    ds_read_b128 v[92:95], v3 offset:52224
    v_mfma_f32_32x32x16_bf16 v[16:31], a[192:195], v[240:243], v[16:31]
    ds_read_b128 v[108:111], v3 offset:56320
    ds_read_b128 v[124:127], v3 offset:60416
    v_mfma_f32_32x32x16_bf16 v[16:31], a[208:211], v[244:247], v[16:31]
    s_waitcnt lgkmcnt(10)
    v_add_f32 v80, v80, v96
    v_add_f32 v81, v81, v97
    v_add_f32 v82, v82, v98
    v_add_f32 v83, v83, v99
    v_mfma_f32_32x32x16_bf16 v[16:31], a[224:227], v[248:251], v[16:31]
    s_waitcnt lgkmcnt(9)
    v_add_f32 v80, v80, v112
    v_add_f32 v81, v81, v113
    v_add_f32 v82, v82, v114
    v_add_f32 v83, v83, v115
    v_mfma_f32_32x32x16_bf16 v[16:31], a[240:243], v[252:255], v[16:31]
    s_waitcnt lgkmcnt(7)
    v_add_f32 v84, v84, v100
    v_add_f32 v85, v85, v101
    v_add_f32 v86, v86, v102
    v_add_f32 v87, v87, v103
    s_waitcnt lgkmcnt(6)
    v_add_f32 v84, v84, v116
    v_add_f32 v85, v85, v117
    v_add_f32 v86, v86, v118
    v_add_f32 v87, v87, v119
    s_waitcnt lgkmcnt(4)
    v_add_f32 v88, v88, v104
    v_add_f32 v89, v89, v105
    v_add_f32 v90, v90, v106
    v_add_f32 v91, v91, v107
    s_waitcnt lgkmcnt(3)
    v_add_f32 v88, v88, v120
    v_add_f32 v89, v89, v121
    v_add_f32 v90, v90, v122
    v_add_f32 v91, v91, v123
    s_waitcnt lgkmcnt(1)
    v_add_f32 v92, v92, v108
    v_add_f32 v93, v93, v109
    v_add_f32 v94, v94, v110
    v_add_f32 v95, v95, v111
    s_waitcnt lgkmcnt(0)
    v_add_f32 v92, v92, v124
    v_add_f32 v93, v93, v125
    v_add_f32 v94, v94, v126
    v_add_f32 v95, v95, v127
    v_add_f32 v80, v80, v16
    v_add_f32 v81, v81, v17
    v_add_f32 v82, v82, v18
    v_add_f32 v83, v83, v19
    v_add_f32 v84, v84, v20
    v_add_f32 v85, v85, v21
    v_add_f32 v86, v86, v22
    v_add_f32 v87, v87, v23
    v_add_f32 v88, v88, v24
    v_add_f32 v89, v89, v25
    v_add_f32 v90, v90, v26
    v_add_f32 v91, v91, v27
    v_add_f32 v92, v92, v28
    v_add_f32 v93, v93, v29
    v_add_f32 v94, v94, v30
    v_add_f32 v95, v95, v31
    s_mov_b32 s92, 0x00010000
    v_mov_b32 v64, 0xffff0000
    v_and_b32 v170, 31, v0
    v_mul_u32_u24 v170, 272, v170
    v_lshrrev_b32 v171, 5, v0
    v_lshl_add_u32 v170, v171, 4, v170
    s_lshl_b32 s76, s64, 6
    s_add_u32 s77, s76, 98304
    v_add_u32 v170, s77, v170
    v_lshrrev_b32 v168, 4, v0
    v_and_b32 v169, 15, v0
    v_lshlrev_b32 v169, 4, v169
    v_lshl_add_u32 v171, v168, 12, v169
    v_mul_u32_u24 v14, 272, v168
    v_add_u32 v14, v14, v169
    s_mul_i32 s77, s64, 2176
    s_add_u32 s77, s77, 98304
    v_add_u32 v14, s77, v14
    s_sub_u32 s76, s20, s76
    s_lshl_b32 s77, s64, 15
    s_add_u32 s76, s76, s77
    s_add_u32 s77, s76, 16384
    s_mov_b32 s85, 0
    s_waitcnt vmcnt(0)
L_chk0:
    v_xor_b32 v12, v4, v128
    v_bitop3_b32 v12, v12, v129, v5 bitop3:0xf6
    v_bitop3_b32 v12, v12, v130, v6 bitop3:0xf6
    v_bitop3_b32 v12, v12, v131, v7 bitop3:0xf6
    v_bitop3_b32 v12, v12, v132, v4 bitop3:0xf6
    v_bitop3_b32 v12, v12, v133, v5 bitop3:0xf6
    v_bitop3_b32 v12, v12, v134, v6 bitop3:0xf6
    v_bitop3_b32 v12, v12, v135, v7 bitop3:0xf6
    v_and_b32 v12, s96, v12
    v_cmp_ne_u32 vcc, 0, v12
    s_add_u32 s85, s85, 1
    s_cmp_gt_u32 s85, 100000
    s_cbranch_scc1 L_ok0
    s_nop 1
    s_cbranch_vccz L_ok0
L_rel0:
    s_lshl_b32 s74, s12, 13
    s_add_u32 s74, s74, s21
    buffer_load_dwordx4 v[128:131], v2, s[52:55], s74 offen offset:0 sc1
    buffer_load_dwordx4 v[132:135], v2, s[52:55], s74 offen offset:1024 sc1
    s_waitcnt vmcnt(0)
    s_branch L_chk0
L_ok0:
    v_lshl_or_b32 v48, v128, 16, s92
    v_and_or_b32 v49, v128, v64, s92
    v_lshl_or_b32 v50, v129, 16, s92
    v_and_or_b32 v51, v129, v64, s92
    v_lshl_or_b32 v52, v130, 16, s92
    v_and_or_b32 v53, v130, v64, s92
    v_lshl_or_b32 v54, v131, 16, s92
    v_and_or_b32 v55, v131, v64, s92
    v_lshl_or_b32 v56, v132, 16, s92
    v_and_or_b32 v57, v132, v64, s92
    v_lshl_or_b32 v58, v133, 16, s92
    v_and_or_b32 v59, v133, v64, s92
    v_lshl_or_b32 v60, v134, 16, s92
    v_and_or_b32 v61, v134, v64, s92
    v_lshl_or_b32 v62, v135, 16, s92
    v_and_or_b32 v63, v135, v64, s92
    v_pk_add_f32 v[172:173], v[172:173], v[48:49]
    v_pk_add_f32 v[174:175], v[174:175], v[50:51]
    v_pk_add_f32 v[176:177], v[176:177], v[52:53]
    v_pk_add_f32 v[178:179], v[178:179], v[54:55]
    v_pk_add_f32 v[180:181], v[180:181], v[56:57]
    v_pk_add_f32 v[182:183], v[182:183], v[58:59]
    v_pk_add_f32 v[184:185], v[184:185], v[60:61]
    v_pk_add_f32 v[186:187], v[186:187], v[62:63]
L_skip0:
    s_bitcmp1_b32 s86, 1
    s_cbranch_scc1 L_skip1
    s_branch L_rel1
L_chk1:
    v_xor_b32 v12, v4, v140
    v_bitop3_b32 v12, v12, v141, v5 bitop3:0xf6
    v_bitop3_b32 v12, v12, v142, v6 bitop3:0xf6
    v_bitop3_b32 v12, v12, v143, v7 bitop3:0xf6
    v_bitop3_b32 v12, v12, v144, v4 bitop3:0xf6
    v_bitop3_b32 v12, v12, v145, v5 bitop3:0xf6
    v_bitop3_b32 v12, v12, v146, v6 bitop3:0xf6
    v_bitop3_b32 v12, v12, v147, v7 bitop3:0xf6
    v_and_b32 v12, s96, v12
    v_cmp_ne_u32 vcc, 0, v12
    s_add_u32 s85, s85, 1
    s_cmp_gt_u32 s85, 100000
    s_cbranch_scc1 L_ok1
    s_nop 1
    s_cbranch_vccz L_ok1
L_rel1:
    s_lshl_b32 s74, s13, 13
    s_add_u32 s74, s74, s21
    buffer_load_dwordx4 v[140:143], v2, s[52:55], s74 offen offset:0 sc1
    buffer_load_dwordx4 v[144:147], v2, s[52:55], s74 offen offset:1024 sc1
    s_waitcnt vmcnt(0)
    s_branch L_chk1
L_ok1:
    v_lshl_or_b32 v48, v140, 16, s92
    v_and_or_b32 v49, v140, v64, s92
    v_lshl_or_b32 v50, v141, 16, s92
    v_and_or_b32 v51, v141, v64, s92
    v_lshl_or_b32 v52, v142, 16, s92
    v_and_or_b32 v53, v142, v64, s92
    v_lshl_or_b32 v54, v143, 16, s92
    v_and_or_b32 v55, v143, v64, s92
    v_lshl_or_b32 v56, v144, 16, s92
    v_and_or_b32 v57, v144, v64, s92
    v_lshl_or_b32 v58, v145, 16, s92
    v_and_or_b32 v59, v145, v64, s92
    v_lshl_or_b32 v60, v146, 16, s92
    v_and_or_b32 v61, v146, v64, s92
    v_lshl_or_b32 v62, v147, 16, s92
    v_and_or_b32 v63, v147, v64, s92
    v_pk_add_f32 v[172:173], v[172:173], v[48:49]
    v_pk_add_f32 v[174:175], v[174:175], v[50:51]
    v_pk_add_f32 v[176:177], v[176:177], v[52:53]
    v_pk_add_f32 v[178:179], v[178:179], v[54:55]
    v_pk_add_f32 v[180:181], v[180:181], v[56:57]
    v_pk_add_f32 v[182:183], v[182:183], v[58:59]
    v_pk_add_f32 v[184:185], v[184:185], v[60:61]
    v_pk_add_f32 v[186:187], v[186:187], v[62:63]
L_skip1:
    s_bitcmp1_b32 s86, 2
    s_cbranch_scc1 L_skip2
    s_branch L_rel2
L_chk2:
    v_xor_b32 v12, v4, v152
    v_bitop3_b32 v12, v12, v153, v5 bitop3:0xf6
    v_bitop3_b32 v12, v12, v154, v6 bitop3:0xf6
    v_bitop3_b32 v12, v12, v155, v7 bitop3:0xf6
    v_bitop3_b32 v12, v12, v156, v4 bitop3:0xf6
    v_bitop3_b32 v12, v12, v157, v5 bitop3:0xf6
    v_bitop3_b32 v12, v12, v158, v6 bitop3:0xf6
    v_bitop3_b32 v12, v12, v159, v7 bitop3:0xf6
    v_and_b32 v12, s96, v12
    v_cmp_ne_u32 vcc, 0, v12
    s_add_u32 s85, s85, 1
    s_cmp_gt_u32 s85, 100000
    s_cbranch_scc1 L_ok2
    s_nop 1
    s_cbranch_vccz L_ok2
L_rel2:
    s_lshl_b32 s74, s14, 13
    s_add_u32 s74, s74, s21
    buffer_load_dwordx4 v[152:155], v2, s[52:55], s74 offen offset:0 sc1
    buffer_load_dwordx4 v[156:159], v2, s[52:55], s74 offen offset:1024 sc1
    s_waitcnt vmcnt(0)
    s_branch L_chk2
L_ok2:
    v_lshl_or_b32 v48, v152, 16, s92
    v_and_or_b32 v49, v152, v64, s92
    v_lshl_or_b32 v50, v153, 16, s92
    v_and_or_b32 v51, v153, v64, s92
    v_lshl_or_b32 v52, v154, 16, s92
    v_and_or_b32 v53, v154, v64, s92
    v_lshl_or_b32 v54, v155, 16, s92
    v_and_or_b32 v55, v155, v64, s92
    v_lshl_or_b32 v56, v156, 16, s92
    v_and_or_b32 v57, v156, v64, s92
    v_lshl_or_b32 v58, v157, 16, s92
    v_and_or_b32 v59, v157, v64, s92
    v_lshl_or_b32 v60, v158, 16, s92
    v_and_or_b32 v61, v158, v64, s92
    v_lshl_or_b32 v62, v159, 16, s92
    v_and_or_b32 v63, v159, v64, s92
    v_pk_add_f32 v[172:173], v[172:173], v[48:49]
    v_pk_add_f32 v[174:175], v[174:175], v[50:51]
    v_pk_add_f32 v[176:177], v[176:177], v[52:53]
    v_pk_add_f32 v[178:179], v[178:179], v[54:55]
    v_pk_add_f32 v[180:181], v[180:181], v[56:57]
    v_pk_add_f32 v[182:183], v[182:183], v[58:59]
    v_pk_add_f32 v[184:185], v[184:185], v[60:61]
    v_pk_add_f32 v[186:187], v[186:187], v[62:63]
L_skip2:
    v_pk_add_f32 v[80:81], v[80:81], v[172:173]
    v_pk_add_f32 v[82:83], v[82:83], v[174:175]
    v_pk_add_f32 v[84:85], v[84:85], v[176:177]
    v_pk_add_f32 v[86:87], v[86:87], v[178:179]
    v_pk_add_f32 v[88:89], v[88:89], v[180:181]
    v_pk_add_f32 v[90:91], v[90:91], v[182:183]
    v_pk_add_f32 v[92:93], v[92:93], v[184:185]
    v_pk_add_f32 v[94:95], v[94:95], v[186:187]
    v_cvt_pk_bf16_f32 v16, v80, v81
    v_cvt_pk_bf16_f32 v17, v82, v83
    v_cvt_pk_bf16_f32 v18, v84, v85
    v_cvt_pk_bf16_f32 v19, v86, v87
    v_cvt_pk_bf16_f32 v20, v88, v89
    v_cvt_pk_bf16_f32 v21, v90, v91
    v_cvt_pk_bf16_f32 v22, v92, v93
    v_cvt_pk_bf16_f32 v23, v94, v95
    ds_write_b128 v170, v[16:19]
    ds_write_b128 v170, v[20:23] offset:32
    s_waitcnt lgkmcnt(0)
    s_barrier
    ds_read_b128 v[24:27], v14
    ds_read_b128 v[28:31], v14 offset:1088
    s_waitcnt lgkmcnt(1)
    buffer_store_dwordx4 v[24:27], v171, s[56:59], s76 offen sc1
    s_waitcnt lgkmcnt(0)
    buffer_store_dwordx4 v[28:31], v171, s[56:59], s77 offen sc1
L_end:
    s_endpgm
L_codeend:

.section .rodata,"a"
.p2align 6
.amdhsa_kernel concat_heads__mha_block_cached__gqa_block_cached__near_ridge_kernel
  .amdhsa_next_free_vgpr 512
  .amdhsa_next_free_sgpr 102
  .amdhsa_accum_offset 256
  .amdhsa_group_segment_fixed_size 0
  .amdhsa_kernarg_size 104
  .amdhsa_user_sgpr_count 2
  .amdhsa_user_sgpr_kernarg_segment_ptr 1
  .amdhsa_system_sgpr_workgroup_id_x 1
.end_amdhsa_kernel
```
